```python
import torch

def _softmax(x, axis=-1):
    return torch.softmax(x, dim=axis)
def _gelu(x):
    return torch.nn.functional.gelu(x, approximate="tanh")
def _silu(x):
    return torch.nn.functional.silu(x)
def _sigmoid(x):
    return torch.sigmoid(x)
def _layernorm(x, axis=-1, eps=1e-5):
    m = x.mean(dim=axis, keepdim=True)
    v = x.var(dim=axis, keepdim=True, unbiased=False)
    return (x - m) / torch.sqrt(v + eps)
def _scatter_add(tgt, idx, src, axis=0):
    return tgt.clone().index_add_(axis, idx, src)
def _segment_sum(src, seg, n):
    out = torch.zeros((n,) + src.shape[1:], dtype=src.dtype)
    return out.index_add_(0, seg, src)
def _pad(x, pw):
    flat = tuple(v for pair in reversed(pw) for v in pair)
    return torch.nn.functional.pad(x, flat)

kernel_name = 'standalone__self_sup_conv_stem_hubert__speech'

def setup_inputs():

    _w = (lambda a: (lambda t: t.to(torch.bfloat16) if t.is_floating_point() else t)(torch.as_tensor(a)))
    B, T, D, K = 2, 16000, 144, 31
    scale = (1.0 / (K * D)) ** 0.5
    return {
        "x": _w((lambda *s: torch.randn(*s, dtype=torch.bfloat16) * 0.05)(B, T, D)),
        "w": _w((lambda *s: torch.randn(*s, dtype=torch.bfloat16) * 0.05)(K, D, D) * scale),
        "b": _w((lambda *s: torch.randn(*s, dtype=torch.bfloat16) * 0.05)(D) * 0.1),
        "gamma": _w(torch.ones((D,), dtype=float)),
        "beta": _w(torch.zeros((D,), dtype=float)),
    }

def reference(x, w, b, gamma, beta):
    B, T, D = x.shape
    K = w.shape[0]
    s = 2
    L = (T - K) // s + 1
    y = torch.einsum('blc,cd->bld', x[:, 0 : s * L : s, :], w[0])
    for i in range(1, K):
        y = y + torch.einsum('blc,cd->bld', x[:, i : i + s * L : s, :], w[i])
    y = y + b[None, None, :]
    mu = y.mean(1, keepdims=True)
    var = ((y - mu) ** 2).mean(1, keepdims=True)
    yn = (y - mu) / torch.sqrt(var + 1e-5)
    yn = yn * gamma[None, None, :] + beta[None, None, :]
    return _gelu(yn)
```

```asm
; @launch grid=(253,1,1) block=(256,1,1) lds=163840
.amdgcn_target "amdgcn-amd-amdhsa--gfx950"
.text
.p2align 16
.globl standalone__self_sup_conv_stem_hubert__speech_kernel
.p2align 8
.type standalone__self_sup_conv_stem_hubert__speech_kernel,@function
standalone__self_sup_conv_stem_hubert__speech_kernel:
    s_load_dwordx16 s[36:51], s[0:1], 0
    s_cmp_ge_u32 s2, 252
    s_cbranch_scc1 Lsvc
    s_getpc_b64 s[4:5]
Lpc:
    s_mov_b32 s6, Lend-Lpc
    s_mov_b32 s7, 0x20000
    s_lshr_b32 s3, s2, 3
    v_mul_u32_u24 v39, 31, v0
    v_add_lshl_u32 v39, v39, s3, 7
    v_lshrrev_b32 v40, 6, v0
    buffer_load_dword v66, v39, s[4:7], 0 offen
    v_readfirstlane_b32 s30, v40
    v_and_b32 v1, 63, v0
    s_and_b32 s28, s2, 7
    s_mul_i32 s29, s28, 31
    s_add_u32 s3, s3, s29
    s_min_u32 s28, s28, 4
    s_add_u32 s3, s3, s28
    s_mul_i32 s28, s3, 21846
    s_lshr_b32 s28, s28, 16
    s_mul_i32 s29, s28, 3
    s_sub_u32 s31, s3, s29
    s_sub_u32 s61, s28, 11
    s_lshr_b32 s62, s61, 3
    s_and_b32 s63, s61, 7
    s_mov_b32 s60, s28
    s_mul_i32 s64, s63, 18
    s_add_u32 s64, s64, s62
    s_mul_i32 s64, s64, 96
    s_add_u32 s64, s64, s31
    s_mul_i32 s59, s64, 96
    s_cmp_lt_u32 s61, 72
    s_cselect_b32 s59, s59, 2.0
    s_add_u32 s65, s59, 82944
    s_lshl_b32 s66, s30, 10
    v_mul_u32_u24 v42, 10923, v0
    v_lshrrev_b32 v42, 16, v42
    v_mul_u32_u24 v42, 12, v42
    v_add_lshl_u32 v42, v42, v0, 4
    s_mov_b32 s6, 1285632
    s_add_u32 m0, s66, 136224
    s_cmp_eq_u32 s30, 3
    s_waitcnt lgkmcnt(0)
    s_mov_b32 s4, s38
    s_mov_b32 s5, s39
    s_cbranch_scc1 Lnow
    buffer_load_dwordx4 v42, s[4:7], s59 offen lds
    s_add_u32 m0, s66, 139296
    s_nop 0
    buffer_load_dwordx4 v42, s[4:7], s65 offen lds
Lnow:
    s_cmp_ge_u32 s28, 42
    s_cselect_b32 s67, 1, 0
    s_mul_i32 s29, s67, 42
    s_sub_u32 s34, s28, s29
    s_mul_i32 s68, s34, 191
    s_lshr_b32 s29, s68, 1
    s_mul_i32 s29, s29, 1152
    s_sub_u32 s10, 4607712, s29
    s_mul_i32 s8, s67, 4608000
    s_add_u32 s29, s29, s8
    s_mov_b32 s11, s7
    v_mul_u32_u24 v40, 57, v1
    v_lshrrev_b32 v40, 9, v40
    v_mul_u32_u24 v40, 1008, v40
    v_lshl_add_u32 v4, v1, 4, v40
    s_mul_i32 s69, s31, 5
    s_add_u32 s70, s69, s30
    s_mul_i32 s71, s70, 8064
    s_lshr_b32 s70, s71, 3
    s_add_u32 s8, s36, s29
    s_addc_u32 s9, s37, 0
    s_mov_b32 exec_lo, 0xfbfdfeff
    s_mov_b32 exec_hi, 0x3fdfeff7
    s_add_u32 m0, s70, 0
    s_nop 0
    buffer_load_dwordx4 v4, s[8:11], s71 offen offset:0  lds
    s_add_u32 m0, s70, 60032
    s_nop 0
    buffer_load_dwordx4 v4, s[8:11], s71 offen offset:512  lds
    s_add_u32 m0, s70, 75040
    s_nop 0
    buffer_load_dwordx4 v4, s[8:11], s71 offen offset:640  lds
    s_mov_b64 exec, -1
    s_cmp_eq_u32 s30, 1
    s_cbranch_scc1 Lw1
    s_cmp_eq_u32 s30, 2
    s_cbranch_scc1 Lw2
    s_cmp_eq_u32 s30, 0
    s_cbranch_scc1 Lw0
    s_mov_b32 exec_lo, 0xfbfdfeff
    s_mov_b32 exec_hi, 0x3fdfeff7
    s_add_u32 s71, s71, 8064
    s_add_u32 m0, s70, 1008
    s_nop 0
    buffer_load_dwordx4 v4, s[8:11], s71 offen offset:0  lds
    s_add_u32 m0, s70, 61040
    s_nop 0
    buffer_load_dwordx4 v4, s[8:11], s71 offen offset:512  lds
    s_add_u32 m0, s70, 76048
    s_nop 0
    buffer_load_dwordx4 v4, s[8:11], s71 offen offset:640  lds
    s_mov_b64 exec, -1
    s_branch Lw3
Lsvc:
    s_cmp_ge_u32 s2, 253
    s_cbranch_scc1 Lend
    s_cmp_gt_u32 s2, 252
    s_cbranch_scc1 Lsvd
    v_lshlrev_b32 v44, 4, v0
    v_mov_b32 v48, 0
    v_mov_b32 v49, 0
    v_mov_b32 v50, 0
    v_mov_b32 v51, 0
    v_mov_b32 v52, 1
    v_lshlrev_b32 v45, 2, v0
    s_movk_i32 s22, 32256
    s_mov_b32 s23, 0x20000
    s_movk_i32 s6, 128
    s_mov_b32 s7, s23
    s_mov_b32 s3, 0
    s_waitcnt lgkmcnt(0)
    s_add_u32 s20, s50, 3145728
    s_addc_u32 s21, s51, 0
    s_mov_b32 s4, s48
    s_mov_b32 s5, s49
Lclr:
    buffer_store_dwordx4 v[48:51], v44, s[20:23], s3 offen sc1
    s_addk_i32 s3, 4096
    s_cmp_lt_u32 s3, s22
    s_cbranch_scc1 Lclr
    s_waitcnt vmcnt(0)
    s_barrier
    buffer_store_dword v52, v45, s[4:7], 0 offen sc1
Lsvd:
    s_endpgm
Lw3:
    s_mul_i32 s3, s31, 24
    v_min_u32 v61, 23, v1
    v_add_lshl_u32 v61, v61, s3, 2
    global_load_dword v62, v61, s[40:41]
    global_load_dword v63, v61, s[42:43]
    global_load_dword v64, v61, s[44:45]
    s_add_u32 s3, s69, 0
    s_cmp_ge_u32 s3, 15
    s_cselect_b32 s29, 15, 0
    s_sub_u32 s3, s3, s29
    s_mul_i32 s52, s3, 1008
    s_mul_i32 s80, s3, 8064
    s_add_u32 s3, s69, 5
    s_cmp_ge_u32 s3, 15
    s_cselect_b32 s29, 15, 0
    s_sub_u32 s3, s3, s29
    s_mul_i32 s53, s3, 1008
    s_mul_i32 s81, s3, 8064
    s_add_u32 s3, s69, 10
    s_cmp_ge_u32 s3, 15
    s_cselect_b32 s29, 15, 0
    s_sub_u32 s3, s3, s29
    s_mul_i32 s54, s3, 1008
    s_mul_i32 s82, s3, 8064
    s_add_u32 s20, s50, 3145728
    s_addc_u32 s21, s51, 0
    s_movk_i32 s22, 32256
    s_mov_b32 s23, s7
    s_mul_i32 s3, s31, 663552
    s_add_u32 s12, s50, s3
    s_addc_u32 s13, s51, 0
    s_mov_b32 s14, 663552
    s_mov_b32 s15, 0x20000
    s_mul_i32 s35, s67, 3
    s_add_u32 s35, s35, s31
    s_mul_i32 s3, s35, 16128
    s_add_u32 s3, s3, 2097152
    s_add_u32 s24, s50, s3
    s_addc_u32 s25, s51, 0
    s_mov_b32 s26, 16128
    s_mov_b32 s27, 0x20000
    s_and_b32 s33, s68, 1
    s_sub_u32 s32, 7985, s68
    s_min_u32 s32, s32, 191
    s_mul_i32 s3, s67, 7985
    s_add_u32 s28, s68, s3
    s_mul_i32 s28, s28, 288
    s_mul_i32 s3, s31, 96
    s_add_u32 s28, s28, s3
    s_add_u32 s16, s46, s28
    s_addc_u32 s17, s47, 0
    s_mul_i32 s28, s32, 288
    s_sub_u32 s18, s28, s3
    s_mov_b32 s19, 0x20000
    s_mul_i32 s3, s31, 84
    s_add_u32 s3, s3, s60
    s_lshl_b32 s57, s3, 7
    s_mov_b32 s84, 0xffff0000
    s_mov_b32 s85, 2097152
    v_lshlrev_b32 v2, 4, v1
    v_and_b32 v40, 15, v1
    v_lshrrev_b32 v41, 4, v1
    s_mul_i32 s3, s31, 48
    v_add_lshl_u32 v42, v40, s3, 1
    v_mul_u32_u24 v44, 864, v40
    v_lshl_add_u32 v44, v41, 4, v44
    v_min_u32 v45, 6, v40
    v_mul_u32_u24 v45, 144, v45
    v_lshl_add_u32 v45, v41, 4, v45
    v_add_u32 v45, 13824, v45
    s_cmp_eq_u32 s33, 0
    s_mov_b32 s29, 75680
    s_cselect_b32 s3, 64, s29
    v_add_u32 v5, s3, v44
    v_add_u32 v9, s3, v45
    s_mov_b32 s29, 208
    s_cselect_b32 s3, 75680, s29
    v_add_u32 v7, s3, v44
    v_add_u32 v11, s3, v45
    s_mov_b32 s29, 75744
    s_cselect_b32 s3, 15136, s29
    v_add_u32 v6, s3, v44
    v_add_u32 v10, s3, v45
    s_mov_b32 s29, 15280
    s_cselect_b32 s3, 75744, s29
    v_add_u32 v8, s3, v44
    v_add_u32 v12, s3, v45
    s_mov_b32 s29, 91456
    s_cselect_b32 s3, 30848, s29
    v_add_u32 v33, s3, v44
    s_mov_b32 s29, 30992
    s_cselect_b32 s3, 91456, s29
    v_add_u32 v34, s3, v44
    v_lshlrev_b32 v22, 3, v1
    v_add_u32 v23, 61440, v22
    v_lshrrev_b32 v44, 5, v1
    v_lshlrev_b32 v44, 9, v44
    v_lshl_add_u32 v44, v40, 5, v44
    v_and_b32 v45, 1, v41
    v_lshl_add_u32 v44, v45, 2, v44
    v_add_u32 v24, 136248, v44
    v_and_b32 v44, 1, v1
    v_lshlrev_b32 v44, 9, v44
    v_bfe_u32 v45, v1, 1, 4
    v_lshl_add_u32 v44, v45, 5, v44
    v_add_u32 v25, 136224, v44
    v_mul_u32_u24 v44, 80, v40
    v_add_u32 v26, 139296, v44
    v_lshrrev_b32 v44, 5, v1
    v_lshlrev_b32 v44, 20, v44
    v_lshl_add_u32 v44, v1, 2, v44
    s_lshl_b32 s3, s34, 7
    v_add_u32 v27, s3, v44
    v_lshlrev_b32 v44, 7, v41
    v_lshl_add_u32 v44, v40, 3, v44
    v_add_u32 v28, 1536, v44
    v_add_u32 v3, 1048576, v28
    v_lshrrev_b32 v45, 3, v40
    v_mul_u32_u24 v45, 144, v45
    v_lshlrev_b32 v44, 3, v41
    v_xor_b32 v44, v44, v45
    v_and_b32 v45, 3, v40
    v_lshl_add_u32 v44, v45, 5, v44
    v_bfe_u32 v45, v40, 2, 1
    v_lshl_add_u32 v44, v45, 8, v44
    v_add_u32 v29, 156960, v44
    v_and_b32 v45, 1, v41
    v_mul_u32_u24 v45, 144, v45
    v_lshlrev_b32 v44, 3, v40
    v_xor_b32 v44, v44, v45
    v_lshrrev_b32 v45, 1, v41
    v_mul_u32_u24 v45, 1536, v45
    v_add_u32 v44, v44, v45
    v_add_u32 v116, 156960, v44
    v_mul_u32_u24 v44, 3456, v40
    v_lshl_add_u32 v31, v41, 4, v44
    s_barrier
    v_lshrrev_b32 v46, 5, v1
    v_lshlrev_b32 v46, 22, v46
    v_add_lshl_u32 v46, v46, v1, 2
    v_mov_b32 v47, 1
    v_mov_b32 v119, 0
    s_mul_i32 s60, s31, 84
    s_add_u32 s61, s60, 11
    v_add_lshl_u32 v126, v1, s61, 7
    v_add_u32 v127, 8192, v126
    v_mov_b32 v122, s57
    v_cmp_gt_u32 vcc, 8, v1
    s_nop 1
    v_cndmask_b32 v127, v122, v127, vcc
    v_mov_b32 v120, 1
    s_mul_i32 s61, s34, 6554
    s_lshr_b32 s61, s61, 16
    s_mul_i32 s61, s61, 10
    s_sub_u32 s61, s34, s61
    v_mul_u32_u24 v123, 10, v1
    v_add_u32 v123, s61, v123
    v_mul_u32_u24 v124, 683, v123
    v_lshrrev_b32 v124, 14, v124
    v_mul_u32_u24 v125, 24, v124
    v_sub_u32 v123, v123, v125
    v_lshlrev_b32 v123, 7, v123
    v_lshrrev_b32 v125, 2, v124
    v_cmp_le_u32 vcc, 4, v125
    v_mul_u32_u24 v125, 27648, v125
    v_add_u32 v123, v123, v125
    v_and_b32 v125, 1, v124
    v_mul_u32_u24 v125, 3072, v125
    v_add_u32 v123, v123, v125
    v_bfe_u32 v125, v124, 1, 1
    v_mul_u32_u24 v125, 221184, v125
    v_add_u32 v123, v123, v125
    v_add_u32 v123, 0, v123
    v_cndmask_b32 v123, v123, 2.0, vcc
    s_mov_b32 exec_lo, 0xfbfdfeff
    s_mov_b32 exec_hi, 0x3fdfeff7
    s_add_u32 m0, s53, 3024
    s_add_u32 s29, s81, 24192
    buffer_load_dwordx4 v4, s[8:11], s29 offen  lds
    s_add_u32 m0, s54, 2016
    s_add_u32 s29, s82, 16128
    buffer_load_dwordx4 v4, s[8:11], s29 offen  lds
    s_add_u32 m0, s53, 61552
    s_add_u32 s29, s81, 8576
    buffer_load_dwordx4 v4, s[8:11], s29 offen  lds
    s_add_u32 m0, s54, 60544
    s_add_u32 s29, s82, 512
    buffer_load_dwordx4 v4, s[8:11], s29 offen  lds
    s_add_u32 m0, s54, 64576
    s_add_u32 s29, s82, 32768
    buffer_load_dwordx4 v4, s[8:11], s29 offen  lds
    s_add_u32 m0, s53, 78704
    s_add_u32 s29, s81, 24832
    buffer_load_dwordx4 v4, s[8:11], s29 offen  lds
    s_add_u32 m0, s54, 77696
    s_add_u32 s29, s82, 16768
    buffer_load_dwordx4 v4, s[8:11], s29 offen  lds
    s_add_u32 m0, s52, 16144
    s_add_u32 s29, s80, 8192
    buffer_load_dwordx4 v4, s[8:11], s29 offen  lds
    s_add_u32 m0, s52, 90816
    s_add_u32 s29, s80, 768
    buffer_load_dwordx4 v4, s[8:11], s29 offen  lds
    s_add_u32 m0, s52, 94848
    s_add_u32 s29, s80, 33024
    buffer_load_dwordx4 v4, s[8:11], s29 offen  lds
    s_add_u32 m0, s52, 33296
    s_add_u32 s29, s80, 24448
    buffer_load_dwordx4 v4, s[8:11], s29 offen  lds
    s_mov_b64 exec, -1
    s_mul_i32 s3, s31, 84
    v_mov_b32 v39, 83
    v_cmp_gt_u32 vcc, 11, v1
    s_nop 1
    v_cndmask_b32 v39, v39, v1, vcc
    v_add_lshl_u32 v118, v39, s3, 7
    s_mov_b32 vcc_lo, 0x4020100
    s_mov_b32 vcc_hi, 0x40201008
    v_subrev_u32 v39, 16, v4
    v_cndmask_b32 v4, v4, v39, vcc
    v_bfe_u32 v39, v1, 4, 1
    v_lshl_add_u32 v117, v39, 5, v26
    v_lshrrev_b32 v39, 5, v1
    v_lshl_add_u32 v117, v39, 2, v117
    v_add_u32 v117, 24, v117
    s_mov_b32 s76, -1
    s_mov_b32 s78, -1
    s_mov_b32 s79, 0xffff
    s_cmp_eq_u32 s32, 191
    s_cselect_b32 s77, -1, s79
    v_add_u32 v35, 110592, v2
    v_add_u32 v2, 3072, v2
    s_mov_b32 s55, s54
    s_mov_b32 s83, s82
    s_bitcmp1_b32 s16, 5
    s_cselect_b32 s66, -1, 0
    s_cselect_b32 s67, 0, -1
    s_cselect_b32 s68, 0, -1
    s_cselect_b32 s69, 0, -1
    s_cselect_b32 s70, 0, -1
    s_cselect_b32 s71, -1, 0
    s_movk_i32 s74, 5376
    s_movk_i32 s75, 10752
    s_barrier
    buffer_store_dword v47, v46, s[20:23], s57 offen sc1
    s_load_dword s72, s[48:49], 0
    s_mov_b64 exec, 0
    s_branch Lq3
Lpr3:
    s_mov_b64 exec, -1
    s_waitcnt vmcnt(12)
    s_waitcnt vmcnt(5)
    s_barrier
    ds_read_b128 v[68:71], v5 offset:0
    ds_read_b128 v[72:75], v5 offset:144
    ds_read_b128 v[76:79], v5 offset:288
    ds_read_b128 v[80:83], v5 offset:432
    ds_read_b128 v[84:87], v5 offset:576
    ds_read_b128 v[88:91], v5 offset:720
    ds_read_b128 v[92:95], v5 offset:864
    ds_read_b128 v[96:99], v5 offset:1008
    v_mov_b32 v0, v42
    s_waitcnt lgkmcnt(0)
    s_cmp_eq_u32 s72, 0
    s_cbranch_scc1 Lsa
Lra:
    s_waitcnt vmcnt(0)
    buffer_load_dword v120, v126, s[20:23], 0 offen sc1
    buffer_load_dword v121, v127, s[20:23], 0 offen sc1
    buffer_load_dword v124, v123, s[12:15], 0 offen sc1
    v_add_u32 v48, -14560, v6
    v_add_u32 v49, -14560, v8
    s_waitcnt lgkmcnt(0)
    s_branch Lcom1
Lsa:
    global_load_dword v122, v119, s[48:49] sc1
    s_waitcnt vmcnt(0)
    v_cmp_ne_u32 vcc, 0, v122
    s_sub_u32 s85, s85, 1
    s_cmp_lt_i32 s85, 0
    s_cbranch_scc1 Lra
    s_cbranch_vccnz Lra
    s_branch Lsa
Lsf:
    v_cmp_eq_u32 s[62:63], 0, v120
    v_cmp_eq_u32 s[64:65], 0, v121
    s_nop 1
    s_bitcmp1_b32 s65, 31
    s_cbranch_scc0 Lsg
    buffer_store_dword v47, v46, s[20:23], s57 offen sc1
Lsg:
    s_mov_b64 exec, s[62:63]
    s_cbranch_execz Lsh
    buffer_load_dword v120, v126, s[20:23], 0 offen sc1
Lsh:
    s_mov_b64 exec, s[64:65]
    s_cbranch_execz Lsi
    buffer_load_dword v121, v127, s[20:23], 0 offen sc1
Lsi:
    s_mov_b64 exec, -1
    s_waitcnt vmcnt(0)
    v_min_u32 v122, v120, v121
    v_cmp_eq_u32 vcc, 0, v122
    s_sub_u32 s85, s85, 1
    s_cmp_lt_i32 s85, 0
    s_cbranch_scc1 Lrf
    s_cbranch_vccnz Lsf
    s_branch Lrf
Lsn:
    buffer_load_dword v119, v118, s[20:23], 0 offen sc1
    s_waitcnt vmcnt(0)
    v_cmp_ne_u32 vcc, 1, v119
    s_sub_u32 s85, s85, 1
    s_cmp_lt_i32 s85, 0
    s_cbranch_scc1 Lrn
    s_cbranch_vccnz Lsn
    s_branch Lrn
.p2align 12
Lw0:
    s_add_u32 s3, s69, 0
    s_cmp_ge_u32 s3, 15
    s_cselect_b32 s29, 15, 0
    s_sub_u32 s3, s3, s29
    s_mul_i32 s52, s3, 1008
    s_mul_i32 s80, s3, 8064
    s_add_u32 s3, s69, 5
    s_cmp_ge_u32 s3, 15
    s_cselect_b32 s29, 15, 0
    s_sub_u32 s3, s3, s29
    s_mul_i32 s53, s3, 1008
    s_mul_i32 s81, s3, 8064
    s_add_u32 s3, s69, 10
    s_cmp_ge_u32 s3, 15
    s_cselect_b32 s29, 15, 0
    s_sub_u32 s3, s3, s29
    s_mul_i32 s54, s3, 1008
    s_mul_i32 s82, s3, 8064
    s_mul_i32 s3, s31, 663552
    s_add_u32 s12, s50, s3
    s_addc_u32 s13, s51, 0
    s_mov_b32 s14, 663552
    s_mov_b32 s15, 0x20000
    s_mul_i32 s35, s67, 3
    s_add_u32 s35, s35, s31
    s_mul_i32 s3, s35, 16128
    s_add_u32 s3, s3, 2097152
    s_add_u32 s24, s50, s3
    s_addc_u32 s25, s51, 0
    s_mov_b32 s26, 16128
    s_mov_b32 s27, 0x20000
    s_and_b32 s33, s68, 1
    s_sub_u32 s32, 7985, s68
    s_min_u32 s32, s32, 191
    s_mul_i32 s3, s67, 7985
    s_add_u32 s28, s68, s3
    s_mul_i32 s28, s28, 288
    s_mul_i32 s3, s31, 96
    s_add_u32 s28, s28, s3
    s_add_u32 s16, s46, s28
    s_addc_u32 s17, s47, 0
    s_mul_i32 s28, s32, 288
    s_sub_u32 s18, s28, s3
    s_mov_b32 s19, 0x20000
    s_mul_i32 s3, s31, 84
    s_add_u32 s3, s3, s60
    s_lshl_b32 s57, s3, 7
    s_mov_b32 s84, 0xffff0000
    s_mov_b32 s85, 2097152
    v_lshlrev_b32 v2, 4, v1
    v_and_b32 v40, 15, v1
    v_lshrrev_b32 v41, 4, v1
    s_mul_i32 s3, s31, 48
    v_add_lshl_u32 v42, v40, s3, 1
    v_mul_u32_u24 v44, 864, v40
    v_lshl_add_u32 v44, v41, 4, v44
    v_min_u32 v45, 6, v40
    v_mul_u32_u24 v45, 144, v45
    v_lshl_add_u32 v45, v41, 4, v45
    v_add_u32 v45, 13824, v45
    s_cmp_eq_u32 s33, 0
    s_mov_b32 s29, 60608
    s_cselect_b32 s3, 0, s29
    v_add_u32 v5, s3, v44
    v_add_u32 v9, s3, v45
    s_mov_b32 s29, 144
    s_cselect_b32 s3, 60608, s29
    v_add_u32 v7, s3, v44
    v_add_u32 v11, s3, v45
    s_mov_b32 s29, 75680
    s_cselect_b32 s3, 64, s29
    v_add_u32 v6, s3, v44
    v_add_u32 v10, s3, v45
    s_mov_b32 s29, 208
    s_cselect_b32 s3, 75680, s29
    v_add_u32 v8, s3, v44
    v_add_u32 v12, s3, v45
    s_mov_b32 s29, 90880
    s_cselect_b32 s3, 30272, s29
    v_add_u32 v33, s3, v44
    s_mov_b32 s29, 30416
    s_cselect_b32 s3, 90880, s29
    v_add_u32 v34, s3, v44
    v_lshlrev_b32 v22, 3, v1
    v_add_u32 v23, 61440, v22
    v_lshrrev_b32 v44, 5, v1
    v_lshlrev_b32 v44, 9, v44
    v_lshl_add_u32 v44, v40, 5, v44
    v_and_b32 v45, 1, v41
    v_lshl_add_u32 v44, v45, 2, v44
    v_add_u32 v24, 136224, v44
    v_and_b32 v44, 1, v1
    v_lshlrev_b32 v44, 9, v44
    v_bfe_u32 v45, v1, 1, 4
    v_lshl_add_u32 v44, v45, 5, v44
    v_add_u32 v25, 136224, v44
    v_mul_u32_u24 v44, 80, v40
    v_add_u32 v26, 139296, v44
    v_lshrrev_b32 v44, 5, v1
    v_lshlrev_b32 v44, 20, v44
    v_lshl_add_u32 v44, v1, 2, v44
    s_lshl_b32 s3, s34, 7
    v_add_u32 v27, s3, v44
    v_lshlrev_b32 v44, 7, v41
    v_lshl_add_u32 v44, v40, 3, v44
    v_add_u32 v28, 0, v44
    v_add_u32 v3, 4096, v28
    v_lshrrev_b32 v45, 3, v40
    v_mul_u32_u24 v45, 144, v45
    v_lshlrev_b32 v44, 3, v41
    v_xor_b32 v44, v44, v45
    v_and_b32 v45, 3, v40
    v_lshl_add_u32 v44, v45, 5, v44
    v_bfe_u32 v45, v40, 2, 1
    v_lshl_add_u32 v44, v45, 8, v44
    v_add_u32 v29, 143136, v44
    v_and_b32 v45, 1, v41
    v_mul_u32_u24 v45, 144, v45
    v_lshlrev_b32 v44, 3, v40
    v_xor_b32 v44, v44, v45
    v_lshrrev_b32 v45, 1, v41
    v_mul_u32_u24 v45, 1536, v45
    v_add_u32 v44, v44, v45
    v_add_u32 v116, 143136, v44
    v_mul_u32_u24 v44, 3456, v40
    v_lshl_add_u32 v31, v41, 4, v44
    v_lshrrev_b32 v152, 3, v1
    v_lshl_add_u32 v152, v152, 20, v2
    s_lshl_b32 s3, s34, 7
    s_add_u32 s3, s3, 0
    v_mov_b32 v148, -1
    v_mov_b32 v149, -1
    v_mov_b32 v150, -1
    v_mov_b32 v151, -1
    buffer_store_dwordx4 v[148:151], v152, s[24:27], s3 offen sc1
    s_mul_i32 s3, s63, 9
    s_add_u32 s3, s3, s62
    s_mul_i32 s56, s3, 3072
    s_cmp_lt_u32 s61, 72
    s_cselect_b32 s56, s56, 2.0
    v_lshrrev_b32 v40, 4, v1
    v_mul_u32_u24 v40, 768, v40
    v_bfe_u32 v41, v1, 2, 2
    v_mul_u32_u24 v41, 96, v41
    v_and_b32 v43, 3, v1
    v_lshl_add_u32 v41, v43, 3, v41
    v_add_u32 v40, v40, v41
    v_add_u32 v40, 136224, v40
    s_add_u32 s64, s56, 221184
    s_add_u32 s65, s56, 442368
    s_waitcnt vmcnt(4)
    s_barrier
    ds_read_b64_tr_b16 v[120:121], v40
    ds_read_b64_tr_b16 v[122:123], v40 offset:384
    ds_read_b64_tr_b16 v[124:125], v40 offset:3072
    ds_read_b64_tr_b16 v[126:127], v40 offset:3456
    s_waitcnt lgkmcnt(2)
    buffer_store_dwordx4 v[120:123], v2, s[12:15], s56 offen offset:0 sc1
    s_waitcnt lgkmcnt(0)
    buffer_store_dwordx4 v[124:127], v2, s[12:15], s64 offen offset:0 sc1
    v_lshlrev_b32 v132, 16, v120
    v_and_b32 v133, s84, v120
    v_lshlrev_b32 v140, 16, v124
    v_and_b32 v141, s84, v124
    v_lshlrev_b32 v134, 16, v121
    v_and_b32 v135, s84, v121
    v_lshlrev_b32 v142, 16, v125
    v_and_b32 v143, s84, v125
    v_lshlrev_b32 v136, 16, v122
    v_and_b32 v137, s84, v122
    v_lshlrev_b32 v144, 16, v126
    v_and_b32 v145, s84, v126
    v_lshlrev_b32 v138, 16, v123
    v_and_b32 v139, s84, v123
    v_lshlrev_b32 v146, 16, v127
    v_and_b32 v147, s84, v127
    v_pk_add_f32 v[132:133], v[132:133], v[140:141]
    v_pk_add_f32 v[134:135], v[134:135], v[142:143]
    v_pk_add_f32 v[136:137], v[136:137], v[144:145]
    v_pk_add_f32 v[138:139], v[138:139], v[146:147]
    v_cvt_pk_bf16_f32 v128, -v132, -v133
    v_cvt_pk_bf16_f32 v129, -v134, -v135
    v_cvt_pk_bf16_f32 v130, -v136, -v137
    v_cvt_pk_bf16_f32 v131, -v138, -v139
    buffer_store_dwordx4 v[128:131], v2, s[12:15], s65 offen offset:0 sc1
    s_mov_b32 exec_lo, 0xfbfdfeff
    s_mov_b32 exec_hi, 0x3fdfeff7
    s_add_u32 m0, s53, 0
    s_add_u32 s29, s81, 0
    buffer_load_dwordx4 v4, s[8:11], s29 offen  lds
    s_add_u32 m0, s53, 4032
    s_add_u32 s29, s81, 32256
    buffer_load_dwordx4 v4, s[8:11], s29 offen  lds
    s_add_u32 m0, s54, 3024
    s_add_u32 s29, s82, 24192
    buffer_load_dwordx4 v4, s[8:11], s29 offen  lds
    s_add_u32 m0, s53, 62560
    s_add_u32 s29, s81, 16640
    buffer_load_dwordx4 v4, s[8:11], s29 offen  lds
    s_add_u32 m0, s54, 61552
    s_add_u32 s29, s82, 8576
    buffer_load_dwordx4 v4, s[8:11], s29 offen  lds
    s_add_u32 m0, s53, 75680
    s_add_u32 s29, s81, 640
    buffer_load_dwordx4 v4, s[8:11], s29 offen  lds
    s_add_u32 m0, s53, 79712
    s_add_u32 s29, s81, 32896
    buffer_load_dwordx4 v4, s[8:11], s29 offen  lds
    s_add_u32 m0, s54, 78704
    s_add_u32 s29, s82, 24832
    buffer_load_dwordx4 v4, s[8:11], s29 offen  lds
    s_add_u32 m0, s52, 17152
    s_add_u32 s29, s80, 16256
    buffer_load_dwordx4 v4, s[8:11], s29 offen  lds
    s_add_u32 m0, s52, 91824
    s_add_u32 s29, s80, 8832
    buffer_load_dwordx4 v4, s[8:11], s29 offen  lds
    s_add_u32 m0, s52, 30272
    s_add_u32 s29, s80, 256
    buffer_load_dwordx4 v4, s[8:11], s29 offen  lds
    s_add_u32 m0, s52, 34304
    s_add_u32 s29, s80, 32512
    buffer_load_dwordx4 v4, s[8:11], s29 offen  lds
    s_mov_b64 exec, -1
    s_mov_b64 exec, 0
    s_branch Lq0
Lpr0:
    s_mov_b64 exec, -1
    s_waitcnt vmcnt(12)
    s_barrier
    s_mov_b32 exec_lo, 0xfbfdfeff
    s_mov_b32 exec_hi, 0x3fdfeff7
    s_add_u32 m0, s52, 105952
    s_add_u32 s29, s80, 896
    buffer_load_dwordx4 v4, s[8:11], s29 offen  lds
    s_add_u32 m0, s52, 108976
    s_add_u32 s29, s80, 25088
    buffer_load_dwordx4 v4, s[8:11], s29 offen  lds
    s_add_u32 m0, s52, 46416
    s_add_u32 s29, s80, 8448
    buffer_load_dwordx4 v4, s[8:11], s29 offen  lds
    s_add_u32 m0, s52, 49440
    s_add_u32 s29, s80, 32640
    buffer_load_dwordx4 v4, s[8:11], s29 offen  lds
    s_add_u32 m0, s52, 123104
    s_add_u32 s29, s80, 17152
    buffer_load_dwordx4 v4, s[8:11], s29 offen  lds
    s_add_u32 m0, s53, 15136
    s_add_u32 s29, s81, 128
    buffer_load_dwordx4 v4, s[8:11], s29 offen  lds
    s_add_u32 m0, s53, 18160
    s_add_u32 s29, s81, 24320
    buffer_load_dwordx4 v4, s[8:11], s29 offen  lds
    s_add_u32 m0, s54, 16144
    s_add_u32 s29, s82, 8192
    buffer_load_dwordx4 v4, s[8:11], s29 offen  lds
    s_add_u32 m0, s54, 19168
    s_add_u32 s29, s82, 32384
    buffer_load_dwordx4 v4, s[8:11], s29 offen  lds
    s_add_u32 m0, s53, 92832
    s_add_u32 s29, s81, 16896
    buffer_load_dwordx4 v4, s[8:11], s29 offen  lds
    s_mov_b64 exec, -1
    s_waitcnt vmcnt(14)
    s_barrier
    ds_read_b128 v[68:71], v7 offset:0
    ds_read_b128 v[72:75], v7 offset:144
    ds_read_b128 v[76:79], v7 offset:288
    ds_read_b128 v[80:83], v7 offset:432
    ds_read_b128 v[84:87], v7 offset:576
    ds_read_b128 v[88:91], v7 offset:720
    ds_read_b128 v[92:95], v7 offset:864
    ds_read_b128 v[96:99], v7 offset:1008
    v_mov_b32 v0, v42
    s_mov_b32 exec_lo, 0xfbfdfeff
    s_mov_b32 exec_hi, 0x3fdfeff7
    s_add_u32 m0, s54, 90816
    s_add_u32 s29, s82, 768
    buffer_load_dwordx4 v4, s[8:11], s29 offen  lds
    s_add_u32 m0, s54, 93840
    s_add_u32 s29, s82, 24960
    buffer_load_dwordx4 v4, s[8:11], s29 offen  lds
    s_add_u32 m0, s53, 31280
    s_add_u32 s29, s81, 8320
    buffer_load_dwordx4 v4, s[8:11], s29 offen  lds
    s_add_u32 m0, s53, 34304
    s_add_u32 s29, s81, 32512
    buffer_load_dwordx4 v4, s[8:11], s29 offen  lds
    s_add_u32 m0, s54, 32288
    s_add_u32 s29, s82, 16384
    buffer_load_dwordx4 v4, s[8:11], s29 offen  lds
    s_mov_b64 exec, -1
    s_mov_b32 vcc_lo, 0x4020100
    s_mov_b32 vcc_hi, 0x40201008
    v_subrev_u32 v39, 16, v4
    v_cndmask_b32 v4, v4, v39, vcc
    v_bfe_u32 v39, v1, 4, 1
    v_lshl_add_u32 v117, v39, 5, v26
    v_lshrrev_b32 v39, 5, v1
    v_lshl_add_u32 v117, v39, 2, v117
    v_add_u32 v117, 0, v117
    s_mov_b32 s76, -1
    s_mov_b32 s78, -1
    s_mov_b32 s79, 0xffff
    s_cmp_eq_u32 s32, 191
    s_cselect_b32 s77, -1, s79
    v_add_u32 v35, 0, v2
    v_add_u32 v2, 0, v2
    s_mov_b32 s55, s53
    s_mov_b32 s83, s81
    s_bitcmp1_b32 s16, 5
    s_cselect_b32 s66, -1, 0
    s_cselect_b32 s67, -1, 0
    s_cselect_b32 s68, 0, -1
    s_cselect_b32 s69, 0, -1
    s_cselect_b32 s70, -1, 0
    s_cselect_b32 s71, -1, 0
    s_movk_i32 s74, 5376
    s_movk_i32 s75, 10752
    v_add_u32 v48, 0, v5
    v_add_u32 v49, 0, v7
    s_waitcnt lgkmcnt(0)
    s_branch Lcom0
Lw1:
    s_add_u32 s3, s69, 0
    s_cmp_ge_u32 s3, 15
    s_cselect_b32 s29, 15, 0
    s_sub_u32 s3, s3, s29
    s_mul_i32 s52, s3, 1008
    s_mul_i32 s80, s3, 8064
    s_add_u32 s3, s69, 5
    s_cmp_ge_u32 s3, 15
    s_cselect_b32 s29, 15, 0
    s_sub_u32 s3, s3, s29
    s_mul_i32 s53, s3, 1008
    s_mul_i32 s81, s3, 8064
    s_add_u32 s3, s69, 10
    s_cmp_ge_u32 s3, 15
    s_cselect_b32 s29, 15, 0
    s_sub_u32 s3, s3, s29
    s_mul_i32 s54, s3, 1008
    s_mul_i32 s82, s3, 8064
    s_mul_i32 s3, s31, 663552
    s_add_u32 s12, s50, s3
    s_addc_u32 s13, s51, 0
    s_mov_b32 s14, 663552
    s_mov_b32 s15, 0x20000
    s_mul_i32 s35, s67, 3
    s_add_u32 s35, s35, s31
    s_mul_i32 s3, s35, 16128
    s_add_u32 s3, s3, 2097152
    s_add_u32 s24, s50, s3
    s_addc_u32 s25, s51, 0
    s_mov_b32 s26, 16128
    s_mov_b32 s27, 0x20000
    s_and_b32 s33, s68, 1
    s_sub_u32 s32, 7985, s68
    s_min_u32 s32, s32, 191
    s_mul_i32 s3, s67, 7985
    s_add_u32 s28, s68, s3
    s_mul_i32 s28, s28, 288
    s_mul_i32 s3, s31, 96
    s_add_u32 s28, s28, s3
    s_add_u32 s16, s46, s28
    s_addc_u32 s17, s47, 0
    s_mul_i32 s28, s32, 288
    s_sub_u32 s18, s28, s3
    s_mov_b32 s19, 0x20000
    s_mul_i32 s3, s31, 84
    s_add_u32 s3, s3, s60
    s_lshl_b32 s57, s3, 7
    s_mov_b32 s84, 0xffff0000
    s_mov_b32 s85, 2097152
    v_lshlrev_b32 v2, 4, v1
    v_and_b32 v40, 15, v1
    v_lshrrev_b32 v41, 4, v1
    s_mul_i32 s3, s31, 48
    v_add_lshl_u32 v42, v40, s3, 1
    v_mul_u32_u24 v44, 864, v40
    v_lshl_add_u32 v44, v41, 4, v44
    v_min_u32 v45, 6, v40
    v_mul_u32_u24 v45, 144, v45
    v_lshl_add_u32 v45, v41, 4, v45
    v_add_u32 v45, 13824, v45
    s_cmp_eq_u32 s33, 0
    s_mov_b32 s29, 75680
    s_cselect_b32 s3, 64, s29
    v_add_u32 v5, s3, v44
    v_add_u32 v9, s3, v45
    s_mov_b32 s29, 208
    s_cselect_b32 s3, 75680, s29
    v_add_u32 v7, s3, v44
    v_add_u32 v11, s3, v45
    s_mov_b32 s29, 75744
    s_cselect_b32 s3, 15136, s29
    v_add_u32 v6, s3, v44
    v_add_u32 v10, s3, v45
    s_mov_b32 s29, 15280
    s_cselect_b32 s3, 75744, s29
    v_add_u32 v8, s3, v44
    v_add_u32 v12, s3, v45
    s_mov_b32 s29, 91456
    s_cselect_b32 s3, 30848, s29
    v_add_u32 v33, s3, v44
    s_mov_b32 s29, 30992
    s_cselect_b32 s3, 91456, s29
    v_add_u32 v34, s3, v44
    v_lshlrev_b32 v22, 3, v1
    v_add_u32 v23, 61440, v22
    v_lshrrev_b32 v44, 5, v1
    v_lshlrev_b32 v44, 9, v44
    v_lshl_add_u32 v44, v40, 5, v44
    v_and_b32 v45, 1, v41
    v_lshl_add_u32 v44, v45, 2, v44
    v_add_u32 v24, 136232, v44
    v_and_b32 v44, 1, v1
    v_lshlrev_b32 v44, 9, v44
    v_bfe_u32 v45, v1, 1, 4
    v_lshl_add_u32 v44, v45, 5, v44
    v_add_u32 v25, 136224, v44
    v_mul_u32_u24 v44, 80, v40
    v_add_u32 v26, 139296, v44
    v_lshrrev_b32 v44, 5, v1
    v_lshlrev_b32 v44, 20, v44
    v_lshl_add_u32 v44, v1, 2, v44
    s_lshl_b32 s3, s34, 7
    v_add_u32 v27, s3, v44
    v_lshlrev_b32 v44, 7, v41
    v_lshl_add_u32 v44, v40, 3, v44
    v_add_u32 v28, 512, v44
    v_add_u32 v3, 4096, v28
    v_lshrrev_b32 v45, 3, v40
    v_mul_u32_u24 v45, 144, v45
    v_lshlrev_b32 v44, 3, v41
    v_xor_b32 v44, v44, v45
    v_and_b32 v45, 3, v40
    v_lshl_add_u32 v44, v45, 5, v44
    v_bfe_u32 v45, v40, 2, 1
    v_lshl_add_u32 v44, v45, 8, v44
    v_add_u32 v29, 147744, v44
    v_and_b32 v45, 1, v41
    v_mul_u32_u24 v45, 144, v45
    v_lshlrev_b32 v44, 3, v40
    v_xor_b32 v44, v44, v45
    v_lshrrev_b32 v45, 1, v41
    v_mul_u32_u24 v45, 1536, v45
    v_add_u32 v44, v44, v45
    v_add_u32 v116, 147744, v44
    v_mul_u32_u24 v44, 3456, v40
    v_lshl_add_u32 v31, v41, 4, v44
    v_lshrrev_b32 v152, 3, v1
    v_lshl_add_u32 v152, v152, 20, v2
    s_lshl_b32 s3, s34, 7
    s_add_u32 s3, s3, 5376
    v_mov_b32 v148, -1
    v_mov_b32 v149, -1
    v_mov_b32 v150, -1
    v_mov_b32 v151, -1
    buffer_store_dwordx4 v[148:151], v152, s[24:27], s3 offen sc1
    s_mul_i32 s3, s63, 9
    s_add_u32 s3, s3, s62
    s_mul_i32 s56, s3, 3072
    s_cmp_lt_u32 s61, 72
    s_cselect_b32 s56, s56, 2.0
    v_lshrrev_b32 v40, 4, v1
    v_mul_u32_u24 v40, 768, v40
    v_bfe_u32 v41, v1, 2, 2
    v_mul_u32_u24 v41, 96, v41
    v_and_b32 v43, 3, v1
    v_lshl_add_u32 v41, v43, 3, v41
    v_add_u32 v40, v40, v41
    v_add_u32 v40, 136256, v40
    s_add_u32 s64, s56, 221184
    s_add_u32 s65, s56, 442368
    s_waitcnt vmcnt(4)
    s_barrier
    ds_read_b64_tr_b16 v[120:121], v40
    ds_read_b64_tr_b16 v[122:123], v40 offset:384
    ds_read_b64_tr_b16 v[124:125], v40 offset:3072
    ds_read_b64_tr_b16 v[126:127], v40 offset:3456
    s_waitcnt lgkmcnt(2)
    buffer_store_dwordx4 v[120:123], v2, s[12:15], s56 offen offset:1024 sc1
    s_waitcnt lgkmcnt(0)
    buffer_store_dwordx4 v[124:127], v2, s[12:15], s64 offen offset:1024 sc1
    v_lshlrev_b32 v132, 16, v120
    v_and_b32 v133, s84, v120
    v_lshlrev_b32 v140, 16, v124
    v_and_b32 v141, s84, v124
    v_lshlrev_b32 v134, 16, v121
    v_and_b32 v135, s84, v121
    v_lshlrev_b32 v142, 16, v125
    v_and_b32 v143, s84, v125
    v_lshlrev_b32 v136, 16, v122
    v_and_b32 v137, s84, v122
    v_lshlrev_b32 v144, 16, v126
    v_and_b32 v145, s84, v126
    v_lshlrev_b32 v138, 16, v123
    v_and_b32 v139, s84, v123
    v_lshlrev_b32 v146, 16, v127
    v_and_b32 v147, s84, v127
    v_pk_add_f32 v[132:133], v[132:133], v[140:141]
    v_pk_add_f32 v[134:135], v[134:135], v[142:143]
    v_pk_add_f32 v[136:137], v[136:137], v[144:145]
    v_pk_add_f32 v[138:139], v[138:139], v[146:147]
    v_cvt_pk_bf16_f32 v128, -v132, -v133
    v_cvt_pk_bf16_f32 v129, -v134, -v135
    v_cvt_pk_bf16_f32 v130, -v136, -v137
    v_cvt_pk_bf16_f32 v131, -v138, -v139
    buffer_store_dwordx4 v[128:131], v2, s[12:15], s65 offen offset:1024 sc1
    s_mov_b32 exec_lo, 0xfbfdfeff
    s_mov_b32 exec_hi, 0x3fdfeff7
    s_add_u32 m0, s53, 1008
    s_add_u32 s29, s81, 8064
    buffer_load_dwordx4 v4, s[8:11], s29 offen  lds
    s_add_u32 m0, s54, 0
    s_add_u32 s29, s82, 0
    buffer_load_dwordx4 v4, s[8:11], s29 offen  lds
    s_add_u32 m0, s54, 4032
    s_add_u32 s29, s82, 32256
    buffer_load_dwordx4 v4, s[8:11], s29 offen  lds
    s_add_u32 m0, s53, 63568
    s_add_u32 s29, s81, 24704
    buffer_load_dwordx4 v4, s[8:11], s29 offen  lds
    s_add_u32 m0, s54, 62560
    s_add_u32 s29, s82, 16640
    buffer_load_dwordx4 v4, s[8:11], s29 offen  lds
    s_add_u32 m0, s53, 76688
    s_add_u32 s29, s81, 8704
    buffer_load_dwordx4 v4, s[8:11], s29 offen  lds
    s_add_u32 m0, s54, 75680
    s_add_u32 s29, s82, 640
    buffer_load_dwordx4 v4, s[8:11], s29 offen  lds
    s_add_u32 m0, s54, 79712
    s_add_u32 s29, s82, 32896
    buffer_load_dwordx4 v4, s[8:11], s29 offen  lds
    s_add_u32 m0, s52, 18160
    s_add_u32 s29, s80, 24320
    buffer_load_dwordx4 v4, s[8:11], s29 offen  lds
    s_add_u32 m0, s52, 92832
    s_add_u32 s29, s80, 16896
    buffer_load_dwordx4 v4, s[8:11], s29 offen  lds
    s_add_u32 m0, s52, 31280
    s_add_u32 s29, s80, 8320
    buffer_load_dwordx4 v4, s[8:11], s29 offen  lds
    s_mov_b64 exec, -1
    s_mov_b64 exec, 0
    s_branch Lq1
Lpr1:
    s_mov_b64 exec, -1
    s_waitcnt vmcnt(11)
    s_barrier
    s_mov_b32 exec_lo, 0xfbfdfeff
    s_mov_b32 exec_hi, 0x3fdfeff7
    s_add_u32 m0, s52, 106960
    s_add_u32 s29, s80, 8960
    buffer_load_dwordx4 v4, s[8:11], s29 offen  lds
    s_add_u32 m0, s52, 109984
    s_add_u32 s29, s80, 33152
    buffer_load_dwordx4 v4, s[8:11], s29 offen  lds
    s_add_u32 m0, s52, 47424
    s_add_u32 s29, s80, 16512
    buffer_load_dwordx4 v4, s[8:11], s29 offen  lds
    s_add_u32 m0, s52, 121088
    s_add_u32 s29, s80, 1024
    buffer_load_dwordx4 v4, s[8:11], s29 offen  lds
    s_add_u32 m0, s52, 124112
    s_add_u32 s29, s80, 25216
    buffer_load_dwordx4 v4, s[8:11], s29 offen  lds
    s_add_u32 m0, s53, 16144
    s_add_u32 s29, s81, 8192
    buffer_load_dwordx4 v4, s[8:11], s29 offen  lds
    s_add_u32 m0, s53, 19168
    s_add_u32 s29, s81, 32384
    buffer_load_dwordx4 v4, s[8:11], s29 offen  lds
    s_add_u32 m0, s54, 17152
    s_add_u32 s29, s82, 16256
    buffer_load_dwordx4 v4, s[8:11], s29 offen  lds
    s_add_u32 m0, s53, 90816
    s_add_u32 s29, s81, 768
    buffer_load_dwordx4 v4, s[8:11], s29 offen  lds
    s_add_u32 m0, s53, 93840
    s_add_u32 s29, s81, 24960
    buffer_load_dwordx4 v4, s[8:11], s29 offen  lds
    s_mov_b64 exec, -1
    s_waitcnt vmcnt(13)
    s_barrier
    ds_read_b128 v[68:71], v7 offset:0
    ds_read_b128 v[72:75], v7 offset:144
    ds_read_b128 v[76:79], v7 offset:288
    ds_read_b128 v[80:83], v7 offset:432
    ds_read_b128 v[84:87], v7 offset:576
    ds_read_b128 v[88:91], v7 offset:720
    ds_read_b128 v[92:95], v7 offset:864
    ds_read_b128 v[96:99], v7 offset:1008
    v_mov_b32 v0, v42
    s_mov_b32 exec_lo, 0xfbfdfeff
    s_mov_b32 exec_hi, 0x3fdfeff7
    s_add_u32 m0, s54, 91824
    s_add_u32 s29, s82, 8832
    buffer_load_dwordx4 v4, s[8:11], s29 offen  lds
    s_add_u32 m0, s54, 94848
    s_add_u32 s29, s82, 33024
    buffer_load_dwordx4 v4, s[8:11], s29 offen  lds
    s_add_u32 m0, s53, 32288
    s_add_u32 s29, s81, 16384
    buffer_load_dwordx4 v4, s[8:11], s29 offen  lds
    s_add_u32 m0, s54, 30272
    s_add_u32 s29, s82, 256
    buffer_load_dwordx4 v4, s[8:11], s29 offen  lds
    s_add_u32 m0, s54, 33296
    s_add_u32 s29, s82, 24448
    buffer_load_dwordx4 v4, s[8:11], s29 offen  lds
    s_mov_b64 exec, -1
    s_mov_b32 vcc_lo, 0x4020100
    s_mov_b32 vcc_hi, 0x40201008
    v_subrev_u32 v39, 16, v4
    v_cndmask_b32 v4, v4, v39, vcc
    v_bfe_u32 v39, v1, 4, 1
    v_lshl_add_u32 v117, v39, 5, v26
    v_lshrrev_b32 v39, 5, v1
    v_lshl_add_u32 v117, v39, 2, v117
    v_add_u32 v117, 8, v117
    s_mov_b32 s76, -1
    s_mov_b32 s78, -1
    s_mov_b32 s79, 0xffff
    s_cmp_eq_u32 s32, 191
    s_cselect_b32 s77, -1, s79
    v_add_u32 v35, 110592, v2
    v_add_u32 v2, 3072, v2
    s_mov_b32 s55, s54
    s_mov_b32 s83, s82
    s_bitcmp1_b32 s16, 5
    s_cselect_b32 s66, -1, 0
    s_cselect_b32 s67, -1, 0
    s_cselect_b32 s68, 0, -1
    s_cselect_b32 s69, 0, -1
    s_cselect_b32 s70, -1, 0
    s_cselect_b32 s71, -1, 0
    s_movk_i32 s74, 5376
    s_movk_i32 s75, 10752
    v_add_u32 v48, -14560, v6
    v_add_u32 v49, -14560, v8
    s_waitcnt lgkmcnt(0)
    s_branch Lcom0
.p2align 12
Lw2:
    s_add_u32 s3, s69, 0
    s_cmp_ge_u32 s3, 15
    s_cselect_b32 s29, 15, 0
    s_sub_u32 s3, s3, s29
    s_mul_i32 s52, s3, 1008
    s_mul_i32 s80, s3, 8064
    s_add_u32 s3, s69, 5
    s_cmp_ge_u32 s3, 15
    s_cselect_b32 s29, 15, 0
    s_sub_u32 s3, s3, s29
    s_mul_i32 s53, s3, 1008
    s_mul_i32 s81, s3, 8064
    s_add_u32 s3, s69, 10
    s_cmp_ge_u32 s3, 15
    s_cselect_b32 s29, 15, 0
    s_sub_u32 s3, s3, s29
    s_mul_i32 s54, s3, 1008
    s_mul_i32 s82, s3, 8064
    s_add_u32 s20, s50, 3145728
    s_addc_u32 s21, s51, 0
    s_movk_i32 s22, 32256
    s_mov_b32 s23, s7
    s_mul_i32 s3, s31, 663552
    s_add_u32 s12, s50, s3
    s_addc_u32 s13, s51, 0
    s_mov_b32 s14, 663552
    s_mov_b32 s15, 0x20000
    s_mul_i32 s35, s67, 3
    s_add_u32 s35, s35, s31
    s_mul_i32 s3, s35, 16128
    s_add_u32 s3, s3, 2097152
    s_add_u32 s24, s50, s3
    s_addc_u32 s25, s51, 0
    s_mov_b32 s26, 16128
    s_mov_b32 s27, 0x20000
    s_and_b32 s33, s68, 1
    s_sub_u32 s32, 7985, s68
    s_min_u32 s32, s32, 191
    s_mul_i32 s3, s67, 7985
    s_add_u32 s28, s68, s3
    s_mul_i32 s28, s28, 288
    s_mul_i32 s3, s31, 96
    s_add_u32 s28, s28, s3
    s_add_u32 s16, s46, s28
    s_addc_u32 s17, s47, 0
    s_mul_i32 s28, s32, 288
    s_sub_u32 s18, s28, s3
    s_mov_b32 s19, 0x20000
    s_mul_i32 s3, s31, 84
    s_add_u32 s3, s3, s60
    s_lshl_b32 s57, s3, 7
    s_mov_b32 s84, 0xffff0000
    s_mov_b32 s85, 2097152
    v_lshlrev_b32 v2, 4, v1
    v_and_b32 v40, 15, v1
    v_lshrrev_b32 v41, 4, v1
    s_mul_i32 s3, s31, 48
    v_add_lshl_u32 v42, v40, s3, 1
    v_mul_u32_u24 v44, 864, v40
    v_lshl_add_u32 v44, v41, 4, v44
    v_min_u32 v45, 6, v40
    v_mul_u32_u24 v45, 144, v45
    v_lshl_add_u32 v45, v41, 4, v45
    v_add_u32 v45, 13824, v45
    s_cmp_eq_u32 s33, 0
    s_mov_b32 s29, 60608
    s_cselect_b32 s3, 0, s29
    v_add_u32 v5, s3, v44
    v_add_u32 v9, s3, v45
    s_mov_b32 s29, 144
    s_cselect_b32 s3, 60608, s29
    v_add_u32 v7, s3, v44
    v_add_u32 v11, s3, v45
    s_mov_b32 s29, 75680
    s_cselect_b32 s3, 64, s29
    v_add_u32 v6, s3, v44
    v_add_u32 v10, s3, v45
    s_mov_b32 s29, 208
    s_cselect_b32 s3, 75680, s29
    v_add_u32 v8, s3, v44
    v_add_u32 v12, s3, v45
    s_mov_b32 s29, 90880
    s_cselect_b32 s3, 30272, s29
    v_add_u32 v33, s3, v44
    s_mov_b32 s29, 30416
    s_cselect_b32 s3, 90880, s29
    v_add_u32 v34, s3, v44
    v_lshlrev_b32 v22, 3, v1
    v_add_u32 v23, 61440, v22
    v_lshrrev_b32 v44, 5, v1
    v_lshlrev_b32 v44, 9, v44
    v_lshl_add_u32 v44, v40, 5, v44
    v_and_b32 v45, 1, v41
    v_lshl_add_u32 v44, v45, 2, v44
    v_add_u32 v24, 136240, v44
    v_and_b32 v44, 1, v1
    v_lshlrev_b32 v44, 9, v44
    v_bfe_u32 v45, v1, 1, 4
    v_lshl_add_u32 v44, v45, 5, v44
    v_add_u32 v25, 136224, v44
    v_mul_u32_u24 v44, 80, v40
    v_add_u32 v26, 139296, v44
    v_lshrrev_b32 v44, 5, v1
    v_lshlrev_b32 v44, 20, v44
    v_lshl_add_u32 v44, v1, 2, v44
    s_lshl_b32 s3, s34, 7
    v_add_u32 v27, s3, v44
    v_lshlrev_b32 v44, 7, v41
    v_lshl_add_u32 v44, v40, 3, v44
    v_add_u32 v28, 1024, v44
    v_add_u32 v3, 4096, v28
    v_lshrrev_b32 v44, 5, v1
    v_lshl_add_u32 v3, v44, 20, v3
    v_lshrrev_b32 v45, 3, v40
    v_mul_u32_u24 v45, 144, v45
    v_lshlrev_b32 v44, 3, v41
    v_xor_b32 v44, v44, v45
    v_and_b32 v45, 3, v40
    v_lshl_add_u32 v44, v45, 5, v44
    v_bfe_u32 v45, v40, 2, 1
    v_lshl_add_u32 v44, v45, 8, v44
    v_add_u32 v29, 152352, v44
    v_and_b32 v45, 1, v41
    v_mul_u32_u24 v45, 144, v45
    v_lshlrev_b32 v44, 3, v40
    v_xor_b32 v44, v44, v45
    v_lshrrev_b32 v45, 1, v41
    v_mul_u32_u24 v45, 1536, v45
    v_add_u32 v44, v44, v45
    v_add_u32 v116, 152352, v44
    v_mul_u32_u24 v44, 3456, v40
    v_lshl_add_u32 v31, v41, 4, v44
    v_lshrrev_b32 v152, 3, v1
    v_lshl_add_u32 v152, v152, 20, v2
    s_lshl_b32 s3, s34, 7
    s_add_u32 s3, s3, 10752
    v_mov_b32 v148, -1
    v_mov_b32 v149, -1
    v_mov_b32 v150, -1
    v_mov_b32 v151, -1
    buffer_store_dwordx4 v[148:151], v152, s[24:27], s3 offen sc1
    s_mul_i32 s3, s63, 9
    s_add_u32 s3, s3, s62
    s_mul_i32 s56, s3, 3072
    s_cmp_lt_u32 s61, 72
    s_cselect_b32 s56, s56, 2.0
    v_lshrrev_b32 v40, 4, v1
    v_mul_u32_u24 v40, 768, v40
    v_bfe_u32 v41, v1, 2, 2
    v_mul_u32_u24 v41, 96, v41
    v_and_b32 v43, 3, v1
    v_lshl_add_u32 v41, v43, 3, v41
    v_add_u32 v40, v40, v41
    v_add_u32 v40, 136288, v40
    s_add_u32 s64, s56, 221184
    s_add_u32 s65, s56, 442368
    s_waitcnt vmcnt(4)
    s_barrier
    ds_read_b64_tr_b16 v[120:121], v40
    ds_read_b64_tr_b16 v[122:123], v40 offset:384
    ds_read_b64_tr_b16 v[124:125], v40 offset:3072
    ds_read_b64_tr_b16 v[126:127], v40 offset:3456
    s_waitcnt lgkmcnt(2)
    buffer_store_dwordx4 v[120:123], v2, s[12:15], s56 offen offset:2048 sc1
    s_waitcnt lgkmcnt(0)
    buffer_store_dwordx4 v[124:127], v2, s[12:15], s64 offen offset:2048 sc1
    v_lshlrev_b32 v132, 16, v120
    v_and_b32 v133, s84, v120
    v_lshlrev_b32 v140, 16, v124
    v_and_b32 v141, s84, v124
    v_lshlrev_b32 v134, 16, v121
    v_and_b32 v135, s84, v121
    v_lshlrev_b32 v142, 16, v125
    v_and_b32 v143, s84, v125
    v_lshlrev_b32 v136, 16, v122
    v_and_b32 v137, s84, v122
    v_lshlrev_b32 v144, 16, v126
    v_and_b32 v145, s84, v126
    v_lshlrev_b32 v138, 16, v123
    v_and_b32 v139, s84, v123
    v_lshlrev_b32 v146, 16, v127
    v_and_b32 v147, s84, v127
    v_pk_add_f32 v[132:133], v[132:133], v[140:141]
    v_pk_add_f32 v[134:135], v[134:135], v[142:143]
    v_pk_add_f32 v[136:137], v[136:137], v[144:145]
    v_pk_add_f32 v[138:139], v[138:139], v[146:147]
    v_cvt_pk_bf16_f32 v128, -v132, -v133
    v_cvt_pk_bf16_f32 v129, -v134, -v135
    v_cvt_pk_bf16_f32 v130, -v136, -v137
    v_cvt_pk_bf16_f32 v131, -v138, -v139
    buffer_store_dwordx4 v[128:131], v2, s[12:15], s65 offen offset:2048 sc1
    s_mov_b32 exec_lo, 0xfbfdfeff
    s_mov_b32 exec_hi, 0x3fdfeff7
    s_add_u32 m0, s53, 2016
    s_add_u32 s29, s81, 16128
    buffer_load_dwordx4 v4, s[8:11], s29 offen  lds
    s_add_u32 m0, s54, 1008
    s_add_u32 s29, s82, 8064
    buffer_load_dwordx4 v4, s[8:11], s29 offen  lds
    s_add_u32 m0, s53, 60544
    s_add_u32 s29, s81, 512
    buffer_load_dwordx4 v4, s[8:11], s29 offen  lds
    s_add_u32 m0, s53, 64576
    s_add_u32 s29, s81, 32768
    buffer_load_dwordx4 v4, s[8:11], s29 offen  lds
    s_add_u32 m0, s54, 63568
    s_add_u32 s29, s82, 24704
    buffer_load_dwordx4 v4, s[8:11], s29 offen  lds
    s_add_u32 m0, s53, 77696
    s_add_u32 s29, s81, 16768
    buffer_load_dwordx4 v4, s[8:11], s29 offen  lds
    s_add_u32 m0, s54, 76688
    s_add_u32 s29, s82, 8704
    buffer_load_dwordx4 v4, s[8:11], s29 offen  lds
    s_add_u32 m0, s52, 15136
    s_add_u32 s29, s80, 128
    buffer_load_dwordx4 v4, s[8:11], s29 offen  lds
    s_add_u32 m0, s52, 19168
    s_add_u32 s29, s80, 32384
    buffer_load_dwordx4 v4, s[8:11], s29 offen  lds
    s_add_u32 m0, s52, 93840
    s_add_u32 s29, s80, 24960
    buffer_load_dwordx4 v4, s[8:11], s29 offen  lds
    s_add_u32 m0, s52, 32288
    s_add_u32 s29, s80, 16384
    buffer_load_dwordx4 v4, s[8:11], s29 offen  lds
    s_mov_b64 exec, -1
    s_mov_b64 exec, 0
    s_branch Lq2
Lpr2:
    s_mov_b64 exec, -1
    s_waitcnt vmcnt(11)
    s_barrier
    s_mov_b32 exec_lo, 0xfbfdfeff
    s_mov_b32 exec_hi, 0x3fdfeff7
    s_add_u32 m0, s52, 107968
    s_add_u32 s29, s80, 17024
    buffer_load_dwordx4 v4, s[8:11], s29 offen  lds
    s_add_u32 m0, s52, 45408
    s_add_u32 s29, s80, 384
    buffer_load_dwordx4 v4, s[8:11], s29 offen  lds
    s_add_u32 m0, s52, 48432
    s_add_u32 s29, s80, 24576
    buffer_load_dwordx4 v4, s[8:11], s29 offen  lds
    s_add_u32 m0, s52, 122096
    s_add_u32 s29, s80, 9088
    buffer_load_dwordx4 v4, s[8:11], s29 offen  lds
    s_add_u32 m0, s52, 125120
    s_add_u32 s29, s80, 33280
    buffer_load_dwordx4 v4, s[8:11], s29 offen  lds
    s_add_u32 m0, s53, 17152
    s_add_u32 s29, s81, 16256
    buffer_load_dwordx4 v4, s[8:11], s29 offen  lds
    s_add_u32 m0, s54, 15136
    s_add_u32 s29, s82, 128
    buffer_load_dwordx4 v4, s[8:11], s29 offen  lds
    s_add_u32 m0, s54, 18160
    s_add_u32 s29, s82, 24320
    buffer_load_dwordx4 v4, s[8:11], s29 offen  lds
    s_add_u32 m0, s53, 91824
    s_add_u32 s29, s81, 8832
    buffer_load_dwordx4 v4, s[8:11], s29 offen  lds
    s_add_u32 m0, s53, 94848
    s_add_u32 s29, s81, 33024
    buffer_load_dwordx4 v4, s[8:11], s29 offen  lds
    s_mov_b64 exec, -1
    s_waitcnt vmcnt(14)
    s_barrier
    ds_read_b128 v[68:71], v5 offset:0
    ds_read_b128 v[72:75], v5 offset:144
    ds_read_b128 v[76:79], v5 offset:288
    ds_read_b128 v[80:83], v5 offset:432
    ds_read_b128 v[84:87], v5 offset:576
    ds_read_b128 v[88:91], v5 offset:720
    ds_read_b128 v[92:95], v5 offset:864
    ds_read_b128 v[96:99], v5 offset:1008
    v_mov_b32 v0, v42
    s_mov_b32 exec_lo, 0xfbfdfeff
    s_mov_b32 exec_hi, 0x3fdfeff7
    s_add_u32 m0, s54, 92832
    s_add_u32 s29, s82, 16896
    buffer_load_dwordx4 v4, s[8:11], s29 offen  lds
    s_add_u32 m0, s53, 30272
    s_add_u32 s29, s81, 256
    buffer_load_dwordx4 v4, s[8:11], s29 offen  lds
    s_add_u32 m0, s53, 33296
    s_add_u32 s29, s81, 24448
    buffer_load_dwordx4 v4, s[8:11], s29 offen  lds
    s_add_u32 m0, s54, 31280
    s_add_u32 s29, s82, 8320
    buffer_load_dwordx4 v4, s[8:11], s29 offen  lds
    s_add_u32 m0, s54, 34304
    s_add_u32 s29, s82, 32512
    buffer_load_dwordx4 v4, s[8:11], s29 offen  lds
    s_mov_b64 exec, -1
    s_mul_i32 s3, s31, 84
    v_mov_b32 v39, 83
    v_cmp_gt_u32 vcc, 11, v1
    s_nop 1
    v_cndmask_b32 v39, v39, v1, vcc
    v_add_lshl_u32 v118, v39, s3, 7
    s_mov_b32 vcc_lo, 0x4020100
    s_mov_b32 vcc_hi, 0x40201008
    v_subrev_u32 v39, 16, v4
    v_cndmask_b32 v4, v4, v39, vcc
    v_bfe_u32 v39, v1, 4, 1
    v_lshl_add_u32 v117, v39, 5, v26
    v_lshrrev_b32 v39, 5, v1
    v_lshl_add_u32 v117, v39, 2, v117
    v_add_u32 v117, 16, v117
    s_mov_b32 s76, -1
    s_mov_b32 s78, -1
    s_mov_b32 s79, 0xffff
    s_cmp_eq_u32 s32, 191
    s_cselect_b32 s77, -1, s79
    v_add_u32 v35, 0, v2
    v_add_u32 v2, 0, v2
    s_mov_b32 s55, s53
    s_mov_b32 s83, s81
    s_bitcmp1_b32 s16, 5
    s_cselect_b32 s66, -1, 0
    s_cselect_b32 s67, 0, -1
    s_cselect_b32 s68, 0, -1
    s_cselect_b32 s69, 0, -1
    s_cselect_b32 s70, 0, -1
    s_cselect_b32 s71, -1, 0
    s_movk_i32 s74, 5376
    s_movk_i32 s75, 10752
    v_add_u32 v48, 0, v5
    v_add_u32 v49, 0, v7
    v_mov_b32 v120, 1
    v_mov_b32 v121, 1
    v_mov_b32 v46, 2.0
    v_mov_b32 v126, 2.0
    v_mov_b32 v127, 2.0
    v_mov_b32 v119, 0
    s_waitcnt lgkmcnt(0)
    s_branch Lcom1
.p2align 12
Lcom0:
    ds_read_b128 v[132:135], v48 offset:0
    ds_read_b128 v[136:139], v49 offset:0
    ds_read_b128 v[140:143], v48 offset:144
    ds_read_b128 v[144:147], v49 offset:144
    ds_read_b128 v[148:151], v48 offset:288
    ds_read_b128 v[152:155], v49 offset:288
    ds_read_b128 v[156:159], v48 offset:432
    ds_read_b128 v[160:163], v49 offset:432
    s_waitcnt lgkmcnt(7)
    v_lshlrev_b32 v52, 16, v132
    v_and_b32 v53, s84, v132
    s_waitcnt lgkmcnt(6)
    v_lshlrev_b32 v54, 16, v136
    v_and_b32 v55, s84, v136
    v_pk_add_f32 v[52:53], v[52:53], v[54:55]
    v_cvt_pk_bf16_f32 v172, v52, v53
    v_lshlrev_b32 v56, 16, v133
    v_and_b32 v57, s84, v133
    v_lshlrev_b32 v58, 16, v137
    v_and_b32 v59, s84, v137
    v_pk_add_f32 v[56:57], v[56:57], v[58:59]
    v_cvt_pk_bf16_f32 v173, v56, v57
    v_lshlrev_b32 v52, 16, v134
    v_and_b32 v53, s84, v134
    v_lshlrev_b32 v54, 16, v138
    v_and_b32 v55, s84, v138
    v_pk_add_f32 v[52:53], v[52:53], v[54:55]
    v_cvt_pk_bf16_f32 v174, v52, v53
    v_lshlrev_b32 v56, 16, v135
    v_and_b32 v57, s84, v135
    v_lshlrev_b32 v58, 16, v139
    v_and_b32 v59, s84, v139
    v_pk_add_f32 v[56:57], v[56:57], v[58:59]
    v_cvt_pk_bf16_f32 v175, v56, v57
    ds_read_b128 v[208:211], v48 offset:576
    ds_read_b128 v[212:215], v49 offset:576
    s_waitcnt lgkmcnt(7)
    v_lshlrev_b32 v52, 16, v140
    v_and_b32 v53, s84, v140
    s_waitcnt lgkmcnt(6)
    v_lshlrev_b32 v54, 16, v144
    v_and_b32 v55, s84, v144
    v_pk_add_f32 v[52:53], v[52:53], v[54:55]
    v_cvt_pk_bf16_f32 v176, v52, v53
    v_lshlrev_b32 v56, 16, v141
    v_and_b32 v57, s84, v141
    v_lshlrev_b32 v58, 16, v145
    v_and_b32 v59, s84, v145
    v_pk_add_f32 v[56:57], v[56:57], v[58:59]
    v_cvt_pk_bf16_f32 v177, v56, v57
    v_lshlrev_b32 v52, 16, v142
    v_and_b32 v53, s84, v142
    v_lshlrev_b32 v54, 16, v146
    v_and_b32 v55, s84, v146
    v_pk_add_f32 v[52:53], v[52:53], v[54:55]
    v_cvt_pk_bf16_f32 v178, v52, v53
    v_lshlrev_b32 v56, 16, v143
    v_and_b32 v57, s84, v143
    v_lshlrev_b32 v58, 16, v147
    v_and_b32 v59, s84, v147
    v_pk_add_f32 v[56:57], v[56:57], v[58:59]
    v_cvt_pk_bf16_f32 v179, v56, v57
    ds_read_b128 v[216:219], v48 offset:720
    ds_read_b128 v[220:223], v49 offset:720
    s_waitcnt lgkmcnt(7)
    v_lshlrev_b32 v52, 16, v148
    v_and_b32 v53, s84, v148
    s_waitcnt lgkmcnt(6)
    v_lshlrev_b32 v54, 16, v152
    v_and_b32 v55, s84, v152
    v_pk_add_f32 v[52:53], v[52:53], v[54:55]
    v_cvt_pk_bf16_f32 v180, v52, v53
    v_lshlrev_b32 v56, 16, v149
    v_and_b32 v57, s84, v149
    v_lshlrev_b32 v58, 16, v153
    v_and_b32 v59, s84, v153
    v_pk_add_f32 v[56:57], v[56:57], v[58:59]
    v_cvt_pk_bf16_f32 v181, v56, v57
    v_lshlrev_b32 v52, 16, v150
    v_and_b32 v53, s84, v150
    v_lshlrev_b32 v54, 16, v154
    v_and_b32 v55, s84, v154
    v_pk_add_f32 v[52:53], v[52:53], v[54:55]
    v_cvt_pk_bf16_f32 v182, v52, v53
    v_lshlrev_b32 v56, 16, v151
    v_and_b32 v57, s84, v151
    v_lshlrev_b32 v58, 16, v155
    v_and_b32 v59, s84, v155
    v_pk_add_f32 v[56:57], v[56:57], v[58:59]
    v_cvt_pk_bf16_f32 v183, v56, v57
    s_waitcnt lgkmcnt(5)
    v_lshlrev_b32 v52, 16, v156
    v_and_b32 v53, s84, v156
    s_waitcnt lgkmcnt(4)
    v_lshlrev_b32 v54, 16, v160
    v_and_b32 v55, s84, v160
    v_pk_add_f32 v[52:53], v[52:53], v[54:55]
    v_cvt_pk_bf16_f32 v184, v52, v53
    v_lshlrev_b32 v56, 16, v157
    v_and_b32 v57, s84, v157
    v_lshlrev_b32 v58, 16, v161
    v_and_b32 v59, s84, v161
    v_pk_add_f32 v[56:57], v[56:57], v[58:59]
    v_cvt_pk_bf16_f32 v185, v56, v57
    v_lshlrev_b32 v52, 16, v158
    v_and_b32 v53, s84, v158
    v_lshlrev_b32 v54, 16, v162
    v_and_b32 v55, s84, v162
    v_pk_add_f32 v[52:53], v[52:53], v[54:55]
    v_cvt_pk_bf16_f32 v186, v52, v53
    v_lshlrev_b32 v56, 16, v159
    v_and_b32 v57, s84, v159
    v_lshlrev_b32 v58, 16, v163
    v_and_b32 v59, s84, v163
    v_pk_add_f32 v[56:57], v[56:57], v[58:59]
    v_cvt_pk_bf16_f32 v187, v56, v57
    s_waitcnt lgkmcnt(3)
    v_lshlrev_b32 v52, 16, v208
    v_and_b32 v53, s84, v208
    s_waitcnt lgkmcnt(2)
    v_lshlrev_b32 v54, 16, v212
    v_and_b32 v55, s84, v212
    v_pk_add_f32 v[52:53], v[52:53], v[54:55]
    v_cvt_pk_bf16_f32 v188, v52, v53
    v_lshlrev_b32 v56, 16, v209
    v_and_b32 v57, s84, v209
    v_lshlrev_b32 v58, 16, v213
    v_and_b32 v59, s84, v213
    v_pk_add_f32 v[56:57], v[56:57], v[58:59]
    v_cvt_pk_bf16_f32 v189, v56, v57
    v_lshlrev_b32 v52, 16, v210
    v_and_b32 v53, s84, v210
    v_lshlrev_b32 v54, 16, v214
    v_and_b32 v55, s84, v214
    v_pk_add_f32 v[52:53], v[52:53], v[54:55]
    v_cvt_pk_bf16_f32 v190, v52, v53
    v_lshlrev_b32 v56, 16, v211
    v_and_b32 v57, s84, v211
    v_lshlrev_b32 v58, 16, v215
    v_and_b32 v59, s84, v215
    v_pk_add_f32 v[56:57], v[56:57], v[58:59]
    v_cvt_pk_bf16_f32 v191, v56, v57
    s_waitcnt lgkmcnt(1)
    v_lshlrev_b32 v52, 16, v216
    v_and_b32 v53, s84, v216
    s_waitcnt lgkmcnt(0)
    v_lshlrev_b32 v54, 16, v220
    v_and_b32 v55, s84, v220
    v_pk_add_f32 v[52:53], v[52:53], v[54:55]
    v_cvt_pk_bf16_f32 v192, v52, v53
    v_lshlrev_b32 v56, 16, v217
    v_and_b32 v57, s84, v217
    v_lshlrev_b32 v58, 16, v221
    v_and_b32 v59, s84, v221
    v_pk_add_f32 v[56:57], v[56:57], v[58:59]
    v_cvt_pk_bf16_f32 v193, v56, v57
    v_lshlrev_b32 v52, 16, v218
    v_and_b32 v53, s84, v218
    v_lshlrev_b32 v54, 16, v222
    v_and_b32 v55, s84, v222
    v_pk_add_f32 v[52:53], v[52:53], v[54:55]
    v_cvt_pk_bf16_f32 v194, v52, v53
    v_lshlrev_b32 v56, 16, v219
    v_and_b32 v57, s84, v219
    v_lshlrev_b32 v58, 16, v223
    v_and_b32 v59, s84, v223
    v_pk_add_f32 v[56:57], v[56:57], v[58:59]
    v_cvt_pk_bf16_f32 v195, v56, v57
    s_waitcnt vmcnt(0)
    s_setprio 3
    s_barrier
    s_mov_b32 s28, 0
    buffer_load_dwordx4 a[144:147], v2, s[12:15], s28 offen offset:0 sc1
    s_mov_b32 s36, 27648
    buffer_load_dwordx4 a[148:151], v2, s[12:15], s36 offen offset:0 sc1
    s_setprio 2
    buffer_load_dwordx4 a[152:155], v2, s[12:15], s36 offen offset:1024 sc1
    buffer_load_dwordx4 a[156:159], v2, s[12:15], s28 offen offset:1024 sc1
    s_setprio 1
    buffer_load_dwordx4 a[160:163], v2, s[12:15], s28 offen offset:2048 sc1
    buffer_load_dwordx4 a[164:167], v2, s[12:15], s36 offen offset:2048 sc1
    s_setprio 0
    s_waitcnt vmcnt(5)
    v_mfma_f32_16x16x32_bf16 a[0:3], v[68:71], a[144:147], 0
    s_waitcnt vmcnt(4)
    s_mov_b32 s37, 55296
    v_mfma_f32_16x16x32_bf16 a[0:3], v[72:75], a[148:151], a[0:3]
    buffer_load_dwordx4 a[168:171], v2, s[12:15], s37 offen offset:0 sc1
    v_mfma_f32_16x16x32_bf16 a[4:7], v[72:75], a[144:147], 0
    ds_read_b128 v[48:51], v10 offset:0
    v_mfma_f32_16x16x32_bf16 a[4:7], v[76:79], a[148:151], a[4:7]
    ds_read_b128 v[52:55], v12 offset:0
    v_mfma_f32_16x16x32_bf16 a[8:11], v[76:79], a[144:147], 0
    s_mov_b32 s28, 82944
    v_mfma_f32_16x16x32_bf16 a[8:11], v[80:83], a[148:151], a[8:11]
    buffer_load_dwordx4 a[172:175], v2, s[12:15], s28 offen offset:0 sc1
    v_mfma_f32_16x16x32_bf16 a[12:15], v[80:83], a[144:147], 0
    v_mfma_f32_16x16x32_bf16 a[12:15], v[84:87], a[148:151], a[12:15]
    ds_read_b128 v[100:103], v7 offset:1152
    v_mfma_f32_16x16x32_bf16 a[16:19], v[84:87], a[144:147], 0
    v_mfma_f32_16x16x32_bf16 a[16:19], v[88:91], a[148:151], a[16:19]
    s_waitcnt lgkmcnt(2)
    v_lshlrev_b32 v40, 16, v48
    v_and_b32 v41, s84, v48
    v_mfma_f32_16x16x32_bf16 a[20:23], v[88:91], a[144:147], 0
    buffer_load_dwordx4 a[176:179], v2, s[12:15], s28 offen offset:1024 sc1
    v_mfma_f32_16x16x32_bf16 a[20:23], v[92:95], a[148:151], a[20:23]
    s_waitcnt vmcnt(6) lgkmcnt(1)
    ds_read_b128 v[56:59], v6 offset:0
    v_lshlrev_b32 v42, 16, v52
    v_mfma_f32_16x16x32_bf16 a[44:47], v[92:95], a[152:155], 0
    s_waitcnt vmcnt(5)
    ds_read_b128 v[60:63], v8 offset:0
    v_and_b32 v43, s84, v52
    v_mfma_f32_16x16x32_bf16 a[44:47], v[88:91], a[156:159], a[44:47]
    v_add_f32 v40, v40, v42
    v_add_f32 v41, v41, v43
    v_mfma_f32_16x16x32_bf16 a[40:43], v[88:91], a[152:155], 0
    v_lshlrev_b32 v44, 16, v49
    v_and_b32 v45, s84, v49
    v_mfma_f32_16x16x32_bf16 a[40:43], v[84:87], a[156:159], a[40:43]
    buffer_load_dwordx4 a[180:183], v2, s[12:15], s37 offen offset:1024 sc1
    v_mfma_f32_16x16x32_bf16 a[36:39], v[84:87], a[152:155], 0
    v_lshlrev_b32 v46, 16, v53
    v_and_b32 v47, s84, v53
    v_mfma_f32_16x16x32_bf16 a[36:39], v[80:83], a[156:159], a[36:39]
    v_add_f32 v44, v44, v46
    v_mfma_f32_16x16x32_bf16 a[32:35], v[80:83], a[152:155], 0
    v_add_f32 v45, v45, v47
    v_mfma_f32_16x16x32_bf16 a[32:35], v[76:79], a[156:159], a[32:35]
    v_cvt_pk_bf16_f32 v64, v40, v41
    v_mfma_f32_16x16x32_bf16 a[28:31], v[76:79], a[152:155], 0
    buffer_load_dwordx4 a[184:187], v2, s[12:15], s37 offen offset:2048 sc1
    v_mfma_f32_16x16x32_bf16 a[28:31], v[72:75], a[156:159], a[28:31]
    v_cvt_pk_bf16_f32 v65, v44, v45
    v_lshlrev_b32 v40, 16, v50
    v_mfma_f32_16x16x32_bf16 a[24:27], v[72:75], a[152:155], 0
    v_mfma_f32_16x16x32_bf16 a[24:27], v[68:71], a[156:159], a[24:27]
    s_waitcnt vmcnt(6)
    v_and_b32 v41, s84, v50
    v_mfma_f32_16x16x32_bf16 a[48:51], v[68:71], a[160:163], 0
    s_waitcnt vmcnt(5)
    v_lshlrev_b32 v42, 16, v54
    v_mfma_f32_16x16x32_bf16 a[48:51], v[72:75], a[164:167], a[48:51]
    buffer_load_dwordx4 a[188:191], v2, s[12:15], s28 offen offset:2048 sc1
    v_mfma_f32_16x16x32_bf16 a[52:55], v[72:75], a[160:163], 0
    v_and_b32 v43, s84, v54
    v_add_f32 v40, v40, v42
    v_mfma_f32_16x16x32_bf16 a[52:55], v[76:79], a[164:167], a[52:55]
    v_add_f32 v41, v41, v43
    v_mfma_f32_16x16x32_bf16 a[56:59], v[76:79], a[160:163], 0
    v_lshlrev_b32 v44, 16, v51
    v_mfma_f32_16x16x32_bf16 a[56:59], v[80:83], a[164:167], a[56:59]
    s_mov_b32 s36, 110592
    v_and_b32 v45, s84, v51
    v_mfma_f32_16x16x32_bf16 a[60:63], v[80:83], a[160:163], 0
    buffer_load_dwordx4 a[192:195], v2, s[12:15], s36 offen offset:0 sc1
    v_mfma_f32_16x16x32_bf16 a[60:63], v[84:87], a[164:167], a[60:63]
    v_lshlrev_b32 v46, 16, v55
    v_and_b32 v47, s84, v55
    v_mfma_f32_16x16x32_bf16 a[64:67], v[84:87], a[160:163], 0
    v_mfma_f32_16x16x32_bf16 a[64:67], v[88:91], a[164:167], a[64:67]
    s_mov_b32 s37, 138240
    v_add_f32 v44, v44, v46
    v_mfma_f32_16x16x32_bf16 a[68:71], v[88:91], a[160:163], 0
    buffer_load_dwordx4 a[196:199], v2, s[12:15], s37 offen offset:0 sc1
    v_mfma_f32_16x16x32_bf16 a[68:71], v[92:95], a[164:167], a[68:71]
    s_waitcnt vmcnt(7)
    v_add_f32 v45, v45, v47
    v_cvt_pk_bf16_f32 v66, v40, v41
    v_mfma_f32_16x16x32_bf16 a[0:3], v[76:79], a[168:171], a[0:3]
    s_waitcnt vmcnt(6)
    v_cvt_pk_bf16_f32 v67, v44, v45
    v_mfma_f32_16x16x32_bf16 a[0:3], v[80:83], a[172:175], a[0:3]
    s_waitcnt lgkmcnt(1)
    v_lshlrev_b32 v40, 16, v56
    v_mfma_f32_16x16x32_bf16 a[4:7], v[80:83], a[168:171], a[4:7]
    v_and_b32 v41, s84, v56
    v_mfma_f32_16x16x32_bf16 a[4:7], v[84:87], a[172:175], a[4:7]
    buffer_load_dwordx4 a[200:203], v2, s[12:15], s37 offen offset:1024 sc1
    v_mfma_f32_16x16x32_bf16 a[8:11], v[84:87], a[168:171], a[8:11]
    s_waitcnt lgkmcnt(0)
    ds_read_b128 v[48:51], v6 offset:144
    v_lshlrev_b32 v42, 16, v60
    v_mfma_f32_16x16x32_bf16 a[8:11], v[88:91], a[172:175], a[8:11]
    ds_read_b128 v[104:107], v7 offset:1296
    ds_read_b128 v[52:55], v8 offset:144
    v_mfma_f32_16x16x32_bf16 a[12:15], v[88:91], a[168:171], a[12:15]
    v_mfma_f32_16x16x32_bf16 a[12:15], v[92:95], a[172:175], a[12:15]
    ds_read_b128 v[108:111], v7 offset:1440
    v_and_b32 v43, s84, v60
    v_mfma_f32_16x16x32_bf16 a[16:19], v[92:95], a[168:171], a[16:19]
    buffer_load_dwordx4 a[204:207], v2, s[12:15], s36 offen offset:1024 sc1
    v_mfma_f32_16x16x32_bf16 a[16:19], v[96:99], a[172:175], a[16:19]
    v_add_f32 v40, v40, v42
    v_add_f32 v41, v41, v43
    v_mfma_f32_16x16x32_bf16 a[20:23], v[96:99], a[168:171], a[20:23]
    v_lshlrev_b32 v44, 16, v57
    v_mfma_f32_16x16x32_bf16 a[20:23], v[100:103], a[172:175], a[20:23]
    s_waitcnt vmcnt(7)
    v_and_b32 v45, s84, v57
    v_mfma_f32_16x16x32_bf16 a[44:47], v[100:103], a[176:179], a[44:47]
    s_waitcnt vmcnt(6)
    v_lshlrev_b32 v46, 16, v61
    v_mfma_f32_16x16x32_bf16 a[44:47], v[96:99], a[180:183], a[44:47]
    buffer_load_dwordx4 a[208:211], v2, s[12:15], s36 offen offset:2048 sc1
    v_mfma_f32_16x16x32_bf16 a[40:43], v[96:99], a[176:179], a[40:43]
    v_and_b32 v47, s84, v61
    v_add_f32 v44, v44, v46
    v_mfma_f32_16x16x32_bf16 a[40:43], v[92:95], a[180:183], a[40:43]
    v_add_f32 v45, v45, v47
    v_mfma_f32_16x16x32_bf16 a[36:39], v[92:95], a[176:179], a[36:39]
    v_mfma_f32_16x16x32_bf16 a[36:39], v[88:91], a[180:183], a[36:39]
    v_cvt_pk_bf16_f32 v120, v40, v41
    v_mfma_f32_16x16x32_bf16 a[32:35], v[88:91], a[176:179], a[32:35]
    buffer_load_dwordx4 a[212:215], v2, s[12:15], s37 offen offset:2048 sc1
    v_mfma_f32_16x16x32_bf16 a[32:35], v[84:87], a[180:183], a[32:35]
    v_cvt_pk_bf16_f32 v121, v44, v45
    v_lshlrev_b32 v40, 16, v58
    v_mfma_f32_16x16x32_bf16 a[28:31], v[84:87], a[176:179], a[28:31]
    v_and_b32 v41, s84, v58
    v_mfma_f32_16x16x32_bf16 a[28:31], v[80:83], a[180:183], a[28:31]
    s_add_u32 s29, s83, 896
    v_lshlrev_b32 v42, 16, v62
    v_mfma_f32_16x16x32_bf16 a[24:27], v[80:83], a[176:179], a[24:27]
    s_mov_b32 s28, 165888
    s_add_u32 m0, s55, 105952
    v_and_b32 v43, s84, v62
    v_mfma_f32_16x16x32_bf16 a[24:27], v[76:79], a[180:183], a[24:27]
    s_waitcnt vmcnt(7)
    buffer_load_dwordx4 a[216:219], v2, s[12:15], s28 offen offset:0 sc1
    v_mfma_f32_16x16x32_bf16 a[48:51], v[76:79], a[184:187], a[48:51]
    s_waitcnt vmcnt(7)
    buffer_load_dwordx4 v4, s[8:11], s29 offen  lds
    v_mfma_f32_16x16x32_bf16 a[48:51], v[80:83], a[188:191], a[48:51]
    v_add_f32 v40, v40, v42
    v_add_f32 v41, v41, v43
    v_mfma_f32_16x16x32_bf16 a[52:55], v[80:83], a[184:187], a[52:55]
    v_lshlrev_b32 v44, 16, v59
    v_and_b32 v45, s84, v59
    v_mfma_f32_16x16x32_bf16 a[52:55], v[84:87], a[188:191], a[52:55]
    s_mov_b32 s36, 193536
    v_mfma_f32_16x16x32_bf16 a[56:59], v[84:87], a[184:187], a[56:59]
    buffer_load_dwordx4 a[220:223], v2, s[12:15], s36 offen offset:0 sc1
    v_mfma_f32_16x16x32_bf16 a[56:59], v[88:91], a[188:191], a[56:59]
    v_lshlrev_b32 v46, 16, v63
    v_and_b32 v47, s84, v63
    v_mfma_f32_16x16x32_bf16 a[60:63], v[88:91], a[184:187], a[60:63]
    v_add_f32 v44, v44, v46
    v_mfma_f32_16x16x32_bf16 a[60:63], v[92:95], a[188:191], a[60:63]
    v_add_f32 v45, v45, v47
    v_mfma_f32_16x16x32_bf16 a[64:67], v[92:95], a[184:187], a[64:67]
    buffer_load_dwordx4 a[224:227], v2, s[12:15], s36 offen offset:1024 sc1
    v_mfma_f32_16x16x32_bf16 a[64:67], v[96:99], a[188:191], a[64:67]
    v_cvt_pk_bf16_f32 v122, v40, v41
    v_cvt_pk_bf16_f32 v123, v44, v45
    v_mfma_f32_16x16x32_bf16 a[68:71], v[96:99], a[184:187], a[68:71]
    s_waitcnt lgkmcnt(3)
    v_lshlrev_b32 v40, 16, v48
    v_mfma_f32_16x16x32_bf16 a[68:71], v[100:103], a[188:191], a[68:71]
    s_waitcnt vmcnt(9)
    v_and_b32 v41, s84, v48
    v_mfma_f32_16x16x32_bf16 a[0:3], v[84:87], a[192:195], a[0:3]
    s_waitcnt vmcnt(8) lgkmcnt(1)
    v_lshlrev_b32 v42, 16, v52
    v_mfma_f32_16x16x32_bf16 a[0:3], v[88:91], a[196:199], a[0:3]
    buffer_load_dwordx4 a[228:231], v2, s[12:15], s28 offen offset:1024 sc1
    v_mfma_f32_16x16x32_bf16 a[4:7], v[88:91], a[192:195], a[4:7]
    ds_read_b128 v[56:59], v6 offset:288
    v_mfma_f32_16x16x32_bf16 a[4:7], v[92:95], a[196:199], a[4:7]
    ds_read_b128 v[60:63], v8 offset:288
    v_mfma_f32_16x16x32_bf16 a[8:11], v[92:95], a[192:195], a[8:11]
    v_and_b32 v43, s84, v52
    v_mfma_f32_16x16x32_bf16 a[8:11], v[96:99], a[196:199], a[8:11]
    ds_read_b128 v[112:115], v7 offset:1584
    v_add_f32 v40, v40, v42
    v_mfma_f32_16x16x32_bf16 a[12:15], v[96:99], a[192:195], a[12:15]
    buffer_load_dwordx4 a[232:235], v2, s[12:15], s28 offen offset:2048 sc1
    v_mfma_f32_16x16x32_bf16 a[12:15], v[100:103], a[196:199], a[12:15]
    ds_read_b128 v[68:71], v7 offset:1728
    v_add_f32 v41, v41, v43
    v_mfma_f32_16x16x32_bf16 a[16:19], v[100:103], a[192:195], a[16:19]
    v_lshlrev_b32 v44, 16, v49
    v_and_b32 v45, s84, v49
    v_mfma_f32_16x16x32_bf16 a[16:19], v[104:107], a[196:199], a[16:19]
    v_lshlrev_b32 v46, 16, v53
    v_mfma_f32_16x16x32_bf16 a[20:23], v[104:107], a[192:195], a[20:23]
    s_waitcnt lgkmcnt(4)
    v_and_b32 v47, s84, v53
    v_mfma_f32_16x16x32_bf16 a[20:23], v[108:111], a[196:199], a[20:23]
    s_waitcnt vmcnt(9)
    buffer_load_dwordx4 a[236:239], v2, s[12:15], s36 offen offset:2048 sc1
    v_mfma_f32_16x16x32_bf16 a[44:47], v[108:111], a[200:203], a[44:47]
    s_waitcnt vmcnt(9)
    v_add_f32 v44, v44, v46
    v_mfma_f32_16x16x32_bf16 a[44:47], v[104:107], a[204:207], a[44:47]
    s_add_u32 m0, s55, 107968
    s_add_u32 s29, s83, 17024
    v_add_f32 v45, v45, v47
    v_mfma_f32_16x16x32_bf16 a[40:43], v[104:107], a[200:203], a[40:43]
    buffer_load_dwordx4 v4, s[8:11], s29 offen  lds
    v_mfma_f32_16x16x32_bf16 a[40:43], v[100:103], a[204:207], a[40:43]
    s_mov_b32 s37, 6144
    v_cvt_pk_bf16_f32 v124, v40, v41
    v_cvt_pk_bf16_f32 v125, v44, v45
    v_mfma_f32_16x16x32_bf16 a[36:39], v[100:103], a[200:203], a[36:39]
    buffer_load_dwordx4 a[240:243], v2, s[12:15], s37 offen offset:0 sc1
    v_mfma_f32_16x16x32_bf16 a[36:39], v[96:99], a[204:207], a[36:39]
    v_lshlrev_b32 v40, 16, v50
    v_and_b32 v41, s84, v50
    v_mfma_f32_16x16x32_bf16 a[32:35], v[96:99], a[200:203], a[32:35]
    v_lshlrev_b32 v42, 16, v54
    v_mfma_f32_16x16x32_bf16 a[32:35], v[92:95], a[204:207], a[32:35]
    v_and_b32 v43, s84, v54
    v_mfma_f32_16x16x32_bf16 a[28:31], v[92:95], a[200:203], a[28:31]
    s_mov_b32 s28, 33792
    v_add_f32 v40, v40, v42
    v_mfma_f32_16x16x32_bf16 a[28:31], v[88:91], a[204:207], a[28:31]
    buffer_load_dwordx4 a[244:247], v2, s[12:15], s28 offen offset:0 sc1
    v_mfma_f32_16x16x32_bf16 a[24:27], v[88:91], a[200:203], a[24:27]
    v_add_f32 v41, v41, v43
    v_mfma_f32_16x16x32_bf16 a[24:27], v[84:87], a[204:207], a[24:27]
    s_waitcnt vmcnt(11)
    v_lshlrev_b32 v44, 16, v51
    v_mfma_f32_16x16x32_bf16 a[48:51], v[84:87], a[208:211], a[48:51]
    s_waitcnt vmcnt(10)
    v_and_b32 v45, s84, v51
    v_mfma_f32_16x16x32_bf16 a[48:51], v[88:91], a[212:215], a[48:51]
    v_lshlrev_b32 v46, 16, v55
    v_mfma_f32_16x16x32_bf16 a[52:55], v[88:91], a[208:211], a[52:55]
    buffer_load_dwordx4 a[248:251], v2, s[12:15], s28 offen offset:1024 sc1
    v_mfma_f32_16x16x32_bf16 a[52:55], v[92:95], a[212:215], a[52:55]
    v_and_b32 v47, s84, v55
    v_add_f32 v44, v44, v46
    v_mfma_f32_16x16x32_bf16 a[56:59], v[92:95], a[208:211], a[56:59]
    v_add_f32 v45, v45, v47
    v_mfma_f32_16x16x32_bf16 a[56:59], v[96:99], a[212:215], a[56:59]
    v_cvt_pk_bf16_f32 v126, v40, v41
    v_mfma_f32_16x16x32_bf16 a[60:63], v[96:99], a[208:211], a[60:63]
    v_cvt_pk_bf16_f32 v127, v44, v45
    v_mfma_f32_16x16x32_bf16 a[60:63], v[100:103], a[212:215], a[60:63]
    v_mfma_f32_16x16x32_bf16 a[64:67], v[100:103], a[208:211], a[64:67]
    buffer_load_dwordx4 a[252:255], v2, s[12:15], s37 offen offset:1024 sc1
    v_mfma_f32_16x16x32_bf16 a[64:67], v[104:107], a[212:215], a[64:67]
    s_waitcnt lgkmcnt(3)
    ds_read_b128 v[72:75], v7 offset:15136
    v_lshlrev_b32 v40, 16, v56
    v_mfma_f32_16x16x32_bf16 a[68:71], v[104:107], a[208:211], a[68:71]
    s_waitcnt lgkmcnt(3)
    v_and_b32 v41, s84, v56
    v_lshlrev_b32 v42, 16, v60
    v_mfma_f32_16x16x32_bf16 a[68:71], v[108:111], a[212:215], a[68:71]
    s_waitcnt vmcnt(11)
    ds_read_b128 v[76:79], v7 offset:15280
    ds_read_b128 v[48:51], v6 offset:432
    v_mfma_f32_16x16x32_bf16 a[0:3], v[92:95], a[216:219], a[0:3]
    s_waitcnt vmcnt(9)
    ds_read_b128 v[52:55], v8 offset:432
    v_mfma_f32_16x16x32_bf16 a[0:3], v[96:99], a[220:223], a[0:3]
    s_add_u32 s29, s83, 33152
    ds_read_b128 v[80:83], v7 offset:15424
    v_and_b32 v43, s84, v60
    v_mfma_f32_16x16x32_bf16 a[4:7], v[96:99], a[216:219], a[4:7]
    buffer_load_dwordx4 a[144:147], v2, s[12:15], s37 offen offset:2048 sc1
    v_mfma_f32_16x16x32_bf16 a[4:7], v[100:103], a[220:223], a[4:7]
    s_add_u32 m0, s55, 109984
    ds_read_b128 v[84:87], v7 offset:15568
    v_add_f32 v40, v40, v42
    v_mfma_f32_16x16x32_bf16 a[8:11], v[100:103], a[216:219], a[8:11]
    buffer_load_dwordx4 v4, s[8:11], s29 offen  lds
    v_mfma_f32_16x16x32_bf16 a[8:11], v[104:107], a[220:223], a[8:11]
    ds_read_b128 v[88:91], v7 offset:15712
    v_add_f32 v41, v41, v43
    v_mfma_f32_16x16x32_bf16 a[12:15], v[104:107], a[216:219], a[12:15]
    v_lshlrev_b32 v44, 16, v57
    v_and_b32 v45, s84, v57
    v_mfma_f32_16x16x32_bf16 a[12:15], v[108:111], a[220:223], a[12:15]
    v_lshlrev_b32 v46, 16, v61
    v_mfma_f32_16x16x32_bf16 a[16:19], v[108:111], a[216:219], a[16:19]
    s_waitcnt lgkmcnt(8)
    buffer_load_dwordx4 a[148:151], v2, s[12:15], s28 offen offset:2048 sc1
    v_mfma_f32_16x16x32_bf16 a[16:19], v[112:115], a[220:223], a[16:19]
    v_and_b32 v47, s84, v61
    v_add_f32 v44, v44, v46
    v_mfma_f32_16x16x32_bf16 a[20:23], v[112:115], a[216:219], a[20:23]
    s_waitcnt lgkmcnt(7)
    v_add_f32 v45, v45, v47
    v_mfma_f32_16x16x32_bf16 a[20:23], v[68:71], a[220:223], a[20:23]
    s_waitcnt vmcnt(11)
    v_cvt_pk_bf16_f32 v128, v40, v41
    v_mfma_f32_16x16x32_bf16 a[44:47], v[68:71], a[224:227], a[44:47]
    s_waitcnt vmcnt(10)
    v_cvt_pk_bf16_f32 v129, v44, v45
    v_mfma_f32_16x16x32_bf16 a[44:47], v[112:115], a[228:231], a[44:47]
    s_mov_b32 s36, 61440
    v_lshlrev_b32 v40, 16, v58
    v_mfma_f32_16x16x32_bf16 a[40:43], v[112:115], a[224:227], a[40:43]
    buffer_load_dwordx4 a[152:155], v2, s[12:15], s36 offen offset:0 sc1
    v_mfma_f32_16x16x32_bf16 a[40:43], v[108:111], a[228:231], a[40:43]
    v_and_b32 v41, s84, v58
    v_lshlrev_b32 v42, 16, v62
    v_mfma_f32_16x16x32_bf16 a[36:39], v[108:111], a[224:227], a[36:39]
    v_mfma_f32_16x16x32_bf16 a[36:39], v[104:107], a[228:231], a[36:39]
    v_and_b32 v43, s84, v62
    v_mfma_f32_16x16x32_bf16 a[32:35], v[104:107], a[224:227], a[32:35]
    v_add_f32 v40, v40, v42
    v_mfma_f32_16x16x32_bf16 a[32:35], v[100:103], a[228:231], a[32:35]
    s_mov_b32 s37, 89088
    v_add_f32 v41, v41, v43
    v_mfma_f32_16x16x32_bf16 a[28:31], v[100:103], a[224:227], a[28:31]
    buffer_load_dwordx4 a[156:159], v2, s[12:15], s37 offen offset:0 sc1
    v_mfma_f32_16x16x32_bf16 a[28:31], v[96:99], a[228:231], a[28:31]
    v_lshlrev_b32 v44, 16, v59
    v_and_b32 v45, s84, v59
    v_mfma_f32_16x16x32_bf16 a[24:27], v[96:99], a[224:227], a[24:27]
    v_lshlrev_b32 v46, 16, v63
    v_mfma_f32_16x16x32_bf16 a[24:27], v[92:95], a[228:231], a[24:27]
    s_waitcnt vmcnt(11)
    v_and_b32 v47, s84, v63
    v_mfma_f32_16x16x32_bf16 a[48:51], v[92:95], a[232:235], a[48:51]
    s_waitcnt vmcnt(10)
    ds_read_b128 v[92:95], v7 offset:15856
    v_add_f32 v44, v44, v46
    v_mfma_f32_16x16x32_bf16 a[48:51], v[96:99], a[236:239], a[48:51]
    v_add_f32 v45, v45, v47
    v_mfma_f32_16x16x32_bf16 a[52:55], v[96:99], a[232:235], a[52:55]
    buffer_load_dwordx4 a[160:163], v2, s[12:15], s37 offen offset:1024 sc1
    v_mfma_f32_16x16x32_bf16 a[52:55], v[100:103], a[236:239], a[52:55]
    ds_read_b128 v[96:99], v7 offset:16000
    v_cvt_pk_bf16_f32 v130, v40, v41
    v_mfma_f32_16x16x32_bf16 a[56:59], v[100:103], a[232:235], a[56:59]
    s_add_u32 s29, s83, 8448
    v_cvt_pk_bf16_f32 v131, v44, v45
    v_mfma_f32_16x16x32_bf16 a[56:59], v[104:107], a[236:239], a[56:59]
    s_waitcnt lgkmcnt(6)
    s_add_u32 m0, s55, 46416
    v_lshlrev_b32 v40, 16, v48
    v_mfma_f32_16x16x32_bf16 a[60:63], v[104:107], a[232:235], a[60:63]
    buffer_load_dwordx4 v4, s[8:11], s29 offen  lds
    v_mfma_f32_16x16x32_bf16 a[60:63], v[108:111], a[236:239], a[60:63]
    s_waitcnt lgkmcnt(5)
    v_and_b32 v41, s84, v48
    v_lshlrev_b32 v42, 16, v52
    v_mfma_f32_16x16x32_bf16 a[64:67], v[108:111], a[232:235], a[64:67]
    buffer_load_dwordx4 a[164:167], v2, s[12:15], s36 offen offset:1024 sc1
    v_mfma_f32_16x16x32_bf16 a[64:67], v[112:115], a[236:239], a[64:67]
    ds_read_b128 v[56:59], v6 offset:576
    ds_read_b128 v[60:63], v8 offset:576
    v_mfma_f32_16x16x32_bf16 a[68:71], v[112:115], a[232:235], a[68:71]
    v_and_b32 v43, s84, v52
    v_mfma_f32_16x16x32_bf16 a[68:71], v[68:71], a[236:239], a[68:71]
    s_waitcnt vmcnt(11)
    v_add_f32 v40, v40, v42
    v_mfma_f32_16x16x32_bf16 a[0:3], v[72:75], a[240:243], a[0:3]
    s_waitcnt vmcnt(10)
    v_mfma_f32_16x16x32_bf16 a[0:3], v[76:79], a[244:247], a[0:3]
    v_add_f32 v41, v41, v43
    v_mfma_f32_16x16x32_bf16 a[4:7], v[76:79], a[240:243], a[4:7]
    s_waitcnt lgkmcnt(6)
    buffer_load_dwordx4 a[168:171], v2, s[12:15], s36 offen offset:2048 sc1
    v_mfma_f32_16x16x32_bf16 a[4:7], v[80:83], a[244:247], a[4:7]
    v_lshlrev_b32 v44, 16, v49
    v_and_b32 v45, s84, v49
    v_mfma_f32_16x16x32_bf16 a[8:11], v[80:83], a[240:243], a[8:11]
    s_waitcnt lgkmcnt(5)
    v_lshlrev_b32 v46, 16, v53
    v_mfma_f32_16x16x32_bf16 a[8:11], v[84:87], a[244:247], a[8:11]
    ds_read_b128 v[100:103], v7 offset:16144
    v_and_b32 v47, s84, v53
    v_mfma_f32_16x16x32_bf16 a[12:15], v[84:87], a[240:243], a[12:15]
    s_waitcnt lgkmcnt(5)
    v_add_f32 v44, v44, v46
    v_mfma_f32_16x16x32_bf16 a[12:15], v[88:91], a[244:247], a[12:15]
    ds_read_b128 v[104:107], v7 offset:16288
    v_add_f32 v45, v45, v47
    v_mfma_f32_16x16x32_bf16 a[16:19], v[88:91], a[240:243], a[16:19]
    s_waitcnt lgkmcnt(5)
    buffer_load_dwordx4 a[172:175], v2, s[12:15], s37 offen offset:2048 sc1
    v_mfma_f32_16x16x32_bf16 a[16:19], v[92:95], a[244:247], a[16:19]
    v_cvt_pk_bf16_f32 v132, v40, v41
    v_cvt_pk_bf16_f32 v133, v44, v45
    v_mfma_f32_16x16x32_bf16 a[20:23], v[92:95], a[240:243], a[20:23]
    s_waitcnt lgkmcnt(4)
    v_mfma_f32_16x16x32_bf16 a[20:23], v[96:99], a[244:247], a[20:23]
    s_waitcnt vmcnt(11)
    v_lshlrev_b32 v40, 16, v50
    v_mfma_f32_16x16x32_bf16 a[44:47], v[96:99], a[248:251], a[44:47]
    s_waitcnt vmcnt(10)
    v_and_b32 v41, s84, v50
    v_mfma_f32_16x16x32_bf16 a[44:47], v[92:95], a[252:255], a[44:47]
    s_mov_b32 s28, 116736
    v_lshlrev_b32 v42, 16, v54
    v_mfma_f32_16x16x32_bf16 a[40:43], v[92:95], a[248:251], a[40:43]
    buffer_load_dwordx4 a[176:179], v2, s[12:15], s28 offen offset:0 sc1
    v_mfma_f32_16x16x32_bf16 a[40:43], v[88:91], a[252:255], a[40:43]
    v_and_b32 v43, s84, v54
    v_add_f32 v40, v40, v42
    v_mfma_f32_16x16x32_bf16 a[36:39], v[88:91], a[248:251], a[36:39]
    v_add_f32 v41, v41, v43
    v_mfma_f32_16x16x32_bf16 a[36:39], v[84:87], a[252:255], a[36:39]
    v_lshlrev_b32 v44, 16, v51
    v_mfma_f32_16x16x32_bf16 a[32:35], v[84:87], a[248:251], a[32:35]
    s_add_u32 s29, s83, 24576
    v_and_b32 v45, s84, v51
    v_mfma_f32_16x16x32_bf16 a[32:35], v[80:83], a[252:255], a[32:35]
    s_mov_b32 s36, 144384
    s_add_u32 m0, s55, 48432
    v_lshlrev_b32 v46, 16, v55
    v_mfma_f32_16x16x32_bf16 a[28:31], v[80:83], a[248:251], a[28:31]
    buffer_load_dwordx4 a[180:183], v2, s[12:15], s36 offen offset:0 sc1
    v_mfma_f32_16x16x32_bf16 a[28:31], v[76:79], a[252:255], a[28:31]
    buffer_load_dwordx4 v4, s[8:11], s29 offen  lds
    v_mfma_f32_16x16x32_bf16 a[24:27], v[76:79], a[248:251], a[24:27]
    v_and_b32 v47, s84, v55
    v_add_f32 v44, v44, v46
    v_mfma_f32_16x16x32_bf16 a[24:27], v[72:75], a[252:255], a[24:27]
    s_waitcnt vmcnt(12)
    v_add_f32 v45, v45, v47
    v_mfma_f32_16x16x32_bf16 a[48:51], v[72:75], a[144:147], a[48:51]
    s_waitcnt vmcnt(10)
    v_cvt_pk_bf16_f32 v134, v40, v41
    v_mfma_f32_16x16x32_bf16 a[48:51], v[76:79], a[148:151], a[48:51]
    v_cvt_pk_bf16_f32 v135, v44, v45
    v_mfma_f32_16x16x32_bf16 a[52:55], v[76:79], a[144:147], a[52:55]
    buffer_load_dwordx4 a[184:187], v2, s[12:15], s36 offen offset:1024 sc1
    v_mfma_f32_16x16x32_bf16 a[52:55], v[80:83], a[148:151], a[52:55]
    s_waitcnt lgkmcnt(3)
    v_lshlrev_b32 v40, 16, v56
    v_and_b32 v41, s84, v56
    v_mfma_f32_16x16x32_bf16 a[56:59], v[80:83], a[144:147], a[56:59]
    s_waitcnt lgkmcnt(2)
    v_lshlrev_b32 v42, 16, v60
    v_mfma_f32_16x16x32_bf16 a[56:59], v[84:87], a[148:151], a[56:59]
    ds_read_b128 v[48:51], v6 offset:720
    v_mfma_f32_16x16x32_bf16 a[60:63], v[84:87], a[144:147], a[60:63]
    v_mfma_f32_16x16x32_bf16 a[60:63], v[88:91], a[148:151], a[60:63]
    ds_read_b128 v[52:55], v8 offset:720
    v_mfma_f32_16x16x32_bf16 a[64:67], v[88:91], a[144:147], a[64:67]
    buffer_load_dwordx4 a[188:191], v2, s[12:15], s28 offen offset:1024 sc1
    v_mfma_f32_16x16x32_bf16 a[64:67], v[92:95], a[148:151], a[64:67]
    v_and_b32 v43, s84, v60
    v_add_f32 v40, v40, v42
    v_mfma_f32_16x16x32_bf16 a[68:71], v[92:95], a[144:147], a[68:71]
    v_add_f32 v41, v41, v43
    v_mfma_f32_16x16x32_bf16 a[68:71], v[96:99], a[148:151], a[68:71]
    s_waitcnt vmcnt(11)
    v_lshlrev_b32 v44, 16, v57
    v_mfma_f32_16x16x32_bf16 a[0:3], v[80:83], a[152:155], a[0:3]
    s_waitcnt vmcnt(10)
    v_and_b32 v45, s84, v57
    v_mfma_f32_16x16x32_bf16 a[0:3], v[84:87], a[156:159], a[0:3]
    v_lshlrev_b32 v46, 16, v61
    v_mfma_f32_16x16x32_bf16 a[4:7], v[84:87], a[152:155], a[4:7]
    buffer_load_dwordx4 a[192:195], v2, s[12:15], s28 offen offset:2048 sc1
    v_mfma_f32_16x16x32_bf16 a[4:7], v[88:91], a[156:159], a[4:7]
    v_and_b32 v47, s84, v61
    v_add_f32 v44, v44, v46
    v_mfma_f32_16x16x32_bf16 a[8:11], v[88:91], a[152:155], a[8:11]
    v_add_f32 v45, v45, v47
    v_mfma_f32_16x16x32_bf16 a[8:11], v[92:95], a[156:159], a[8:11]
    ds_read_b128 v[108:111], v7 offset:16432
    v_mfma_f32_16x16x32_bf16 a[12:15], v[92:95], a[152:155], a[12:15]
Lq0:
    s_cbranch_execz Lt1
    v_cvt_pk_bf16_f32 v136, v40, v41
    v_mfma_f32_16x16x32_bf16 a[12:15], v[96:99], a[156:159], a[12:15]
    ds_read_b128 v[112:115], v7 offset:16576
    v_cvt_pk_bf16_f32 v137, v44, v45
    v_mfma_f32_16x16x32_bf16 a[16:19], v[96:99], a[152:155], a[16:19]
    s_waitcnt lgkmcnt(5)
    buffer_load_dwordx4 a[196:199], v2, s[12:15], s36 offen offset:2048 sc1
    v_mfma_f32_16x16x32_bf16 a[16:19], v[100:103], a[156:159], a[16:19]
    s_add_u32 s29, s83, 1024
    v_lshlrev_b32 v40, 16, v58
    v_and_b32 v41, s84, v58
    v_mfma_f32_16x16x32_bf16 a[20:23], v[100:103], a[152:155], a[20:23]
    s_waitcnt lgkmcnt(4)
    s_add_u32 m0, s55, 121088
    v_lshlrev_b32 v42, 16, v62
    v_mfma_f32_16x16x32_bf16 a[20:23], v[104:107], a[156:159], a[20:23]
    s_waitcnt vmcnt(11)
    buffer_load_dwordx4 v4, s[8:11], s29 offen  lds
    v_mfma_f32_16x16x32_bf16 a[44:47], v[104:107], a[160:163], a[44:47]
    s_waitcnt vmcnt(10)
    v_and_b32 v43, s84, v62
    v_add_f32 v40, v40, v42
    v_mfma_f32_16x16x32_bf16 a[44:47], v[100:103], a[164:167], a[44:47]
    s_mov_b32 s37, 172032
    v_add_f32 v41, v41, v43
    v_mfma_f32_16x16x32_bf16 a[40:43], v[100:103], a[160:163], a[40:43]
    buffer_load_dwordx4 a[200:203], v2, s[12:15], s37 offen offset:0 sc1
    v_mfma_f32_16x16x32_bf16 a[40:43], v[96:99], a[164:167], a[40:43]
    v_lshlrev_b32 v44, 16, v59
    v_mfma_f32_16x16x32_bf16 a[36:39], v[96:99], a[160:163], a[36:39]
    v_and_b32 v45, s84, v59
    v_mfma_f32_16x16x32_bf16 a[36:39], v[92:95], a[164:167], a[36:39]
    v_lshlrev_b32 v46, 16, v63
    v_mfma_f32_16x16x32_bf16 a[32:35], v[92:95], a[160:163], a[32:35]
    v_and_b32 v47, s84, v63
    v_mfma_f32_16x16x32_bf16 a[32:35], v[88:91], a[164:167], a[32:35]
    s_mov_b32 s28, 199680
    v_add_f32 v44, v44, v46
    v_mfma_f32_16x16x32_bf16 a[28:31], v[88:91], a[160:163], a[28:31]
    buffer_load_dwordx4 a[204:207], v2, s[12:15], s28 offen offset:0 sc1
    v_mfma_f32_16x16x32_bf16 a[28:31], v[84:87], a[164:167], a[28:31]
    v_add_f32 v45, v45, v47
    v_cvt_pk_bf16_f32 v138, v40, v41
    v_mfma_f32_16x16x32_bf16 a[24:27], v[84:87], a[160:163], a[24:27]
    v_cvt_pk_bf16_f32 v139, v44, v45
    v_mfma_f32_16x16x32_bf16 a[24:27], v[80:83], a[164:167], a[24:27]
    s_waitcnt vmcnt(11) lgkmcnt(3)
    v_lshlrev_b32 v40, 16, v48
    v_mfma_f32_16x16x32_bf16 a[48:51], v[80:83], a[168:171], a[48:51]
    s_waitcnt vmcnt(10)
    v_and_b32 v41, s84, v48
    v_mfma_f32_16x16x32_bf16 a[48:51], v[84:87], a[172:175], a[48:51]
    v_mfma_f32_16x16x32_bf16 a[52:55], v[84:87], a[168:171], a[52:55]
    buffer_load_dwordx4 a[208:211], v2, s[12:15], s28 offen offset:1024 sc1
    v_mfma_f32_16x16x32_bf16 a[52:55], v[88:91], a[172:175], a[52:55]
    s_waitcnt lgkmcnt(2)
    v_lshlrev_b32 v42, 16, v52
    v_and_b32 v43, s84, v52
    v_mfma_f32_16x16x32_bf16 a[56:59], v[88:91], a[168:171], a[56:59]
    v_add_f32 v40, v40, v42
    v_mfma_f32_16x16x32_bf16 a[56:59], v[92:95], a[172:175], a[56:59]
    v_add_f32 v41, v41, v43
    v_mfma_f32_16x16x32_bf16 a[60:63], v[92:95], a[168:171], a[60:63]
    v_lshlrev_b32 v44, 16, v49
    v_mfma_f32_16x16x32_bf16 a[60:63], v[96:99], a[172:175], a[60:63]
    v_and_b32 v45, s84, v49
    v_mfma_f32_16x16x32_bf16 a[64:67], v[96:99], a[168:171], a[64:67]
    buffer_load_dwordx4 a[212:215], v2, s[12:15], s37 offen offset:1024 sc1
    v_mfma_f32_16x16x32_bf16 a[64:67], v[100:103], a[172:175], a[64:67]
    v_lshlrev_b32 v46, 16, v53
    v_and_b32 v47, s84, v53
    v_mfma_f32_16x16x32_bf16 a[68:71], v[100:103], a[168:171], a[68:71]
    v_add_f32 v44, v44, v46
    v_mfma_f32_16x16x32_bf16 a[68:71], v[104:107], a[172:175], a[68:71]
    s_waitcnt vmcnt(11)
    s_add_u32 s29, s83, 17152
    v_mfma_f32_16x16x32_bf16 a[0:3], v[88:91], a[176:179], a[0:3]
    s_waitcnt vmcnt(10)
    s_add_u32 m0, s55, 123104
    v_add_f32 v45, v45, v47
    v_mfma_f32_16x16x32_bf16 a[0:3], v[92:95], a[180:183], a[0:3]
    buffer_load_dwordx4 v4, s[8:11], s29 offen  lds
    v_mfma_f32_16x16x32_bf16 a[4:7], v[92:95], a[176:179], a[4:7]
    buffer_load_dwordx4 a[216:219], v2, s[12:15], s37 offen offset:2048 sc1
    v_mfma_f32_16x16x32_bf16 a[4:7], v[96:99], a[180:183], a[4:7]
    v_cvt_pk_bf16_f32 v140, v40, v41
    v_cvt_pk_bf16_f32 v141, v44, v45
    v_mfma_f32_16x16x32_bf16 a[8:11], v[96:99], a[176:179], a[8:11]
    v_lshlrev_b32 v40, 16, v50
    v_and_b32 v41, s84, v50
    v_mfma_f32_16x16x32_bf16 a[8:11], v[100:103], a[180:183], a[8:11]
    ds_read_b128 v[68:71], v7 offset:16720
    v_lshlrev_b32 v42, 16, v54
    v_mfma_f32_16x16x32_bf16 a[12:15], v[100:103], a[176:179], a[12:15]
    v_and_b32 v43, s84, v54
    v_mfma_f32_16x16x32_bf16 a[12:15], v[104:107], a[180:183], a[12:15]
    ds_read_b128 v[72:75], v7 offset:16864
    v_add_f32 v40, v40, v42
    v_mfma_f32_16x16x32_bf16 a[16:19], v[104:107], a[176:179], a[16:19]
    s_waitcnt lgkmcnt(3)
    buffer_load_dwordx4 a[220:223], v2, s[12:15], s28 offen offset:2048 sc1
    v_mfma_f32_16x16x32_bf16 a[16:19], v[108:111], a[180:183], a[16:19]
    v_add_f32 v41, v41, v43
    v_mfma_f32_16x16x32_bf16 a[20:23], v[108:111], a[176:179], a[20:23]
    s_waitcnt lgkmcnt(2)
    v_lshlrev_b32 v44, 16, v51
    v_mfma_f32_16x16x32_bf16 a[20:23], v[112:115], a[180:183], a[20:23]
    s_waitcnt vmcnt(11)
    v_and_b32 v45, s84, v51
    v_mfma_f32_16x16x32_bf16 a[44:47], v[112:115], a[184:187], a[44:47]
    s_waitcnt vmcnt(10)
    v_lshlrev_b32 v46, 16, v55
    v_mfma_f32_16x16x32_bf16 a[44:47], v[108:111], a[188:191], a[44:47]
    s_mov_b32 s36, 12288
    v_and_b32 v47, s84, v55
    v_mfma_f32_16x16x32_bf16 a[40:43], v[108:111], a[184:187], a[40:43]
    buffer_load_dwordx4 a[224:227], v35, s[12:15], s36 offen offset:0 sc1
    v_mfma_f32_16x16x32_bf16 a[40:43], v[104:107], a[188:191], a[40:43]
    v_add_f32 v44, v44, v46
    v_add_f32 v45, v45, v47
    v_mfma_f32_16x16x32_bf16 a[36:39], v[104:107], a[184:187], a[36:39]
    v_cvt_pk_bf16_f32 v142, v40, v41
    v_mfma_f32_16x16x32_bf16 a[36:39], v[100:103], a[188:191], a[36:39]
    v_cvt_pk_bf16_f32 v143, v44, v45
    v_mfma_f32_16x16x32_bf16 a[32:35], v[100:103], a[184:187], a[32:35]
    v_mov_b32_dpp v144, v64 row_shr:15 row_mask:0xf bank_mask:0xf
    v_mfma_f32_16x16x32_bf16 a[32:35], v[96:99], a[188:191], a[32:35]
    s_mov_b32 s37, 39936
    v_mfma_f32_16x16x32_bf16 a[28:31], v[96:99], a[184:187], a[28:31]
    buffer_load_dwordx4 a[228:231], v35, s[12:15], s37 offen offset:0 sc1
    v_mfma_f32_16x16x32_bf16 a[28:31], v[92:95], a[188:191], a[28:31]
    v_mov_b32_dpp v145, v65 row_shr:15 row_mask:0xf bank_mask:0xf
    v_mov_b32_dpp v146, v66 row_shr:15 row_mask:0xf bank_mask:0xf
    v_mfma_f32_16x16x32_bf16 a[24:27], v[92:95], a[184:187], a[24:27]
    v_mov_b32_dpp v147, v67 row_shr:15 row_mask:0xf bank_mask:0xf
    v_mfma_f32_16x16x32_bf16 a[24:27], v[88:91], a[188:191], a[24:27]
    s_waitcnt vmcnt(11)
    v_mov_b32_dpp v144, v120 row_shl:1 row_mask:0xf bank_mask:0xf
    v_mfma_f32_16x16x32_bf16 a[48:51], v[88:91], a[192:195], a[48:51]
    s_waitcnt vmcnt(10)
    v_mov_b32_dpp v145, v121 row_shl:1 row_mask:0xf bank_mask:0xf
    v_mfma_f32_16x16x32_bf16 a[48:51], v[92:95], a[196:199], a[48:51]
    s_add_u32 m0, s55, 125120
    s_add_u32 s29, s83, 33280
    v_mov_b32_dpp v146, v122 row_shl:1 row_mask:0xf bank_mask:0xf
    v_mfma_f32_16x16x32_bf16 a[52:55], v[92:95], a[192:195], a[52:55]
    buffer_load_dwordx4 a[232:235], v35, s[12:15], s37 offen offset:1024 sc1
    v_mfma_f32_16x16x32_bf16 a[52:55], v[96:99], a[196:199], a[52:55]
    buffer_load_dwordx4 v4, s[8:11], s29 offen  lds
    v_mfma_f32_16x16x32_bf16 a[56:59], v[96:99], a[192:195], a[56:59]
    v_mov_b32_dpp v147, v123 row_shl:1 row_mask:0xf bank_mask:0xf
    v_mov_b32_dpp v148, v64 row_shr:14 row_mask:0xf bank_mask:0xf
    v_mfma_f32_16x16x32_bf16 a[56:59], v[100:103], a[196:199], a[56:59]
    v_mov_b32_dpp v149, v65 row_shr:14 row_mask:0xf bank_mask:0xf
    v_mov_b32_dpp v150, v66 row_shr:14 row_mask:0xf bank_mask:0xf
    v_mfma_f32_16x16x32_bf16 a[60:63], v[100:103], a[192:195], a[60:63]
    v_mfma_f32_16x16x32_bf16 a[60:63], v[104:107], a[196:199], a[60:63]
    v_mov_b32_dpp v151, v67 row_shr:14 row_mask:0xf bank_mask:0xf
    v_mfma_f32_16x16x32_bf16 a[64:67], v[104:107], a[192:195], a[64:67]
    buffer_load_dwordx4 a[236:239], v35, s[12:15], s36 offen offset:1024 sc1
    v_mfma_f32_16x16x32_bf16 a[64:67], v[108:111], a[196:199], a[64:67]
    ds_read_b128 v[76:79], v34 offset:0
    v_mov_b32_dpp v148, v124 row_shl:1 row_mask:0xf bank_mask:0xf
    v_mfma_f32_16x16x32_bf16 a[68:71], v[108:111], a[192:195], a[68:71]
    v_mov_b32_dpp v149, v125 row_shl:1 row_mask:0xf bank_mask:0xf
    v_mov_b32_dpp v150, v126 row_shl:1 row_mask:0xf bank_mask:0xf
    v_mfma_f32_16x16x32_bf16 a[68:71], v[112:115], a[196:199], a[68:71]
    s_waitcnt vmcnt(11)
    ds_read_b128 v[80:83], v34 offset:144
    v_mov_b32_dpp v151, v127 row_shl:1 row_mask:0xf bank_mask:0xf
    v_mfma_f32_16x16x32_bf16 a[0:3], v[96:99], a[200:203], a[0:3]
    s_waitcnt vmcnt(10)
    v_mov_b32_dpp v152, v64 row_shr:13 row_mask:0xf bank_mask:0xf
    v_mfma_f32_16x16x32_bf16 a[0:3], v[100:103], a[204:207], a[0:3]
    ds_read_b128 v[84:87], v34 offset:288
    v_mov_b32_dpp v153, v65 row_shr:13 row_mask:0xf bank_mask:0xf
    v_mfma_f32_16x16x32_bf16 a[4:7], v[100:103], a[200:203], a[4:7]
    buffer_load_dwordx4 a[240:243], v35, s[12:15], s36 offen offset:2048 sc1
    v_mfma_f32_16x16x32_bf16 a[4:7], v[104:107], a[204:207], a[4:7]
    ds_read_b128 v[88:91], v34 offset:432
    v_mov_b32_dpp v154, v66 row_shr:13 row_mask:0xf bank_mask:0xf
    v_mfma_f32_16x16x32_bf16 a[8:11], v[104:107], a[200:203], a[8:11]
    v_mov_b32_dpp v155, v67 row_shr:13 row_mask:0xf bank_mask:0xf
    v_mfma_f32_16x16x32_bf16 a[8:11], v[108:111], a[204:207], a[8:11]
    ds_read_b128 v[92:95], v34 offset:576
    v_mov_b32_dpp v152, v128 row_shl:1 row_mask:0xf bank_mask:0xf
    v_mfma_f32_16x16x32_bf16 a[12:15], v[108:111], a[200:203], a[12:15]
    v_mov_b32_dpp v153, v129 row_shl:1 row_mask:0xf bank_mask:0xf
    v_mfma_f32_16x16x32_bf16 a[12:15], v[112:115], a[204:207], a[12:15]
    v_mov_b32_dpp v154, v130 row_shl:1 row_mask:0xf bank_mask:0xf
    v_mfma_f32_16x16x32_bf16 a[16:19], v[112:115], a[200:203], a[16:19]
    s_waitcnt lgkmcnt(6)
    buffer_load_dwordx4 a[244:247], v35, s[12:15], s37 offen offset:2048 sc1
    v_mfma_f32_16x16x32_bf16 a[16:19], v[68:71], a[204:207], a[16:19]
    v_mov_b32_dpp v155, v131 row_shl:1 row_mask:0xf bank_mask:0xf
    v_mov_b32_dpp v156, v64 row_shr:12 row_mask:0xf bank_mask:0xf
    v_mfma_f32_16x16x32_bf16 a[20:23], v[68:71], a[200:203], a[20:23]
    s_waitcnt lgkmcnt(5)
    v_mov_b32_dpp v157, v65 row_shr:12 row_mask:0xf bank_mask:0xf
    v_mfma_f32_16x16x32_bf16 a[20:23], v[72:75], a[204:207], a[20:23]
    s_waitcnt vmcnt(11)
    v_mov_b32_dpp v158, v66 row_shr:12 row_mask:0xf bank_mask:0xf
    v_mfma_f32_16x16x32_bf16 a[44:47], v[72:75], a[208:211], a[44:47]
    s_waitcnt vmcnt(10)
    v_mov_b32_dpp v159, v67 row_shr:12 row_mask:0xf bank_mask:0xf
    v_mfma_f32_16x16x32_bf16 a[44:47], v[68:71], a[212:215], a[44:47]
    s_mov_b32 s28, 67584
    v_mov_b32_dpp v156, v132 row_shl:1 row_mask:0xf bank_mask:0xf
    v_mfma_f32_16x16x32_bf16 a[40:43], v[68:71], a[208:211], a[40:43]
    buffer_load_dwordx4 a[248:251], v35, s[12:15], s28 offen offset:0 sc1
    v_mfma_f32_16x16x32_bf16 a[40:43], v[112:115], a[212:215], a[40:43]
    v_mov_b32_dpp v157, v133 row_shl:1 row_mask:0xf bank_mask:0xf
    v_mfma_f32_16x16x32_bf16 a[36:39], v[112:115], a[208:211], a[36:39]
    v_mov_b32_dpp v158, v134 row_shl:1 row_mask:0xf bank_mask:0xf
    v_mfma_f32_16x16x32_bf16 a[36:39], v[108:111], a[212:215], a[36:39]
    v_mov_b32_dpp v159, v135 row_shl:1 row_mask:0xf bank_mask:0xf
    v_mfma_f32_16x16x32_bf16 a[32:35], v[108:111], a[208:211], a[32:35]
    v_mov_b32_dpp v160, v64 row_shr:11 row_mask:0xf bank_mask:0xf
    v_mfma_f32_16x16x32_bf16 a[32:35], v[104:107], a[212:215], a[32:35]
    s_mov_b32 s36, 95232
    v_mov_b32_dpp v161, v65 row_shr:11 row_mask:0xf bank_mask:0xf
    v_mfma_f32_16x16x32_bf16 a[28:31], v[104:107], a[208:211], a[28:31]
    buffer_load_dwordx4 a[252:255], v35, s[12:15], s36 offen offset:0 sc1
    v_mfma_f32_16x16x32_bf16 a[28:31], v[100:103], a[212:215], a[28:31]
    v_mov_b32_dpp v162, v66 row_shr:11 row_mask:0xf bank_mask:0xf
    v_mov_b32_dpp v163, v67 row_shr:11 row_mask:0xf bank_mask:0xf
    v_mfma_f32_16x16x32_bf16 a[24:27], v[100:103], a[208:211], a[24:27]
    v_mov_b32_dpp v160, v136 row_shl:1 row_mask:0xf bank_mask:0xf
    v_mfma_f32_16x16x32_bf16 a[24:27], v[96:99], a[212:215], a[24:27]
    s_waitcnt vmcnt(10)
    v_mov_b32_dpp v161, v137 row_shl:1 row_mask:0xf bank_mask:0xf
    v_mfma_f32_16x16x32_bf16 a[48:51], v[96:99], a[216:219], a[48:51]
    s_waitcnt vmcnt(9)
    ds_read_b128 v[96:99], v34 offset:720
    v_mfma_f32_16x16x32_bf16 a[48:51], v[100:103], a[220:223], a[48:51]
    v_mov_b32_dpp v162, v138 row_shl:1 row_mask:0xf bank_mask:0xf
    v_mfma_f32_16x16x32_bf16 a[52:55], v[100:103], a[216:219], a[52:55]
    buffer_load_dwordx4 a[144:147], v35, s[12:15], s36 offen offset:1024 sc1
    v_mfma_f32_16x16x32_bf16 a[52:55], v[104:107], a[220:223], a[52:55]
    ds_read_b128 v[100:103], v34 offset:864
    v_mov_b32_dpp v163, v139 row_shl:1 row_mask:0xf bank_mask:0xf
    v_mfma_f32_16x16x32_bf16 a[56:59], v[104:107], a[216:219], a[56:59]
    v_mov_b32 v13, 0
    v_mov_b32_dpp v164, v64 row_shr:10 row_mask:0xf bank_mask:0xf
    v_mfma_f32_16x16x32_bf16 a[56:59], v[108:111], a[220:223], a[56:59]
    v_mov_b32_dpp v165, v65 row_shr:10 row_mask:0xf bank_mask:0xf
    v_mov_b32_dpp v166, v66 row_shr:10 row_mask:0xf bank_mask:0xf
    v_mfma_f32_16x16x32_bf16 a[60:63], v[108:111], a[216:219], a[60:63]
    v_mov_b32 v14, 0
    v_mov_b32_dpp v167, v67 row_shr:10 row_mask:0xf bank_mask:0xf
    v_mfma_f32_16x16x32_bf16 a[60:63], v[112:115], a[220:223], a[60:63]
    v_mov_b32_dpp v164, v140 row_shl:1 row_mask:0xf bank_mask:0xf
    v_mfma_f32_16x16x32_bf16 a[64:67], v[112:115], a[216:219], a[64:67]
    buffer_load_dwordx4 a[148:151], v35, s[12:15], s28 offen offset:1024 sc1
    v_mfma_f32_16x16x32_bf16 a[64:67], v[68:71], a[220:223], a[64:67]
    v_mov_b32 v15, 0
    v_mov_b32_dpp v165, v141 row_shl:1 row_mask:0xf bank_mask:0xf
    v_mfma_f32_16x16x32_bf16 a[68:71], v[68:71], a[216:219], a[68:71]
    v_mov_b32 v16, 0
    v_mov_b32_dpp v166, v142 row_shl:1 row_mask:0xf bank_mask:0xf
    v_mfma_f32_16x16x32_bf16 a[68:71], v[72:75], a[220:223], a[68:71]
    s_waitcnt vmcnt(10) lgkmcnt(6)
    v_mov_b32_dpp v167, v143 row_shl:1 row_mask:0xf bank_mask:0xf
    v_mfma_f32_16x16x32_bf16 a[0:3], v[76:79], a[224:227], a[0:3]
    s_waitcnt vmcnt(9) lgkmcnt(5)
    v_mov_b32 v17, 0
    v_mov_b32_dpp v168, v64 row_shr:9 row_mask:0xf bank_mask:0xf
    v_mfma_f32_16x16x32_bf16 a[0:3], v[80:83], a[228:231], a[0:3]
    v_mov_b32_dpp v169, v65 row_shr:9 row_mask:0xf bank_mask:0xf
    v_mfma_f32_16x16x32_bf16 a[4:7], v[80:83], a[224:227], a[4:7]
    s_waitcnt lgkmcnt(4)
    buffer_load_dwordx4 a[152:155], v35, s[12:15], s28 offen offset:2048 sc1
    v_mfma_f32_16x16x32_bf16 a[4:7], v[84:87], a[228:231], a[4:7]
    v_mov_b32 v18, 0
    v_mov_b32_dpp v170, v66 row_shr:9 row_mask:0xf bank_mask:0xf
    v_mfma_f32_16x16x32_bf16 a[8:11], v[84:87], a[224:227], a[8:11]
    s_waitcnt lgkmcnt(3)
    v_mov_b32 v19, 0
    v_mov_b32_dpp v171, v67 row_shr:9 row_mask:0xf bank_mask:0xf
    v_mfma_f32_16x16x32_bf16 a[8:11], v[88:91], a[228:231], a[8:11]
    ds_read_b128 v[104:107], v34 offset:1008
    v_mov_b32_dpp v168, v144 row_shl:1 row_mask:0xf bank_mask:0xf
    v_mfma_f32_16x16x32_bf16 a[12:15], v[88:91], a[224:227], a[12:15]
    s_waitcnt lgkmcnt(3)
    v_mov_b32 v20, 0
    v_mov_b32_dpp v169, v145 row_shl:1 row_mask:0xf bank_mask:0xf
    v_mfma_f32_16x16x32_bf16 a[12:15], v[92:95], a[228:231], a[12:15]
    ds_read_b128 v[108:111], v34 offset:1152
    v_mov_b32_dpp v170, v146 row_shl:1 row_mask:0xf bank_mask:0xf
    v_mfma_f32_16x16x32_bf16 a[16:19], v[92:95], a[224:227], a[16:19]
    s_waitcnt lgkmcnt(3)
    buffer_load_dwordx4 a[156:159], v35, s[12:15], s36 offen offset:2048 sc1
    v_mfma_f32_16x16x32_bf16 a[16:19], v[96:99], a[228:231], a[16:19]
    v_mov_b32 v21, 0
    v_mov_b32_dpp v171, v147 row_shl:1 row_mask:0xf bank_mask:0xf
    v_mfma_f32_16x16x32_bf16 a[20:23], v[96:99], a[224:227], a[20:23]
    s_waitcnt lgkmcnt(2)
    v_mfma_f32_16x16x32_bf16 a[20:23], v[100:103], a[228:231], a[20:23]
    s_waitcnt vmcnt(10)
    v_mfma_f32_16x16x32_bf16 a[44:47], v[100:103], a[232:235], a[44:47]
    s_waitcnt vmcnt(8)
    s_barrier
    v_mfma_f32_16x16x32_bf16 a[44:47], v[96:99], a[236:239], a[44:47]
    s_mov_b32 s37, 15360
    ds_read_b128 v[56:59], v10 offset:45408
    v_mfma_f32_16x16x32_bf16 a[40:43], v[96:99], a[232:235], a[40:43]
    buffer_load_dwordx4 a[160:163], v2, s[12:15], s37 offen offset:0 sc1
    v_mfma_f32_16x16x32_bf16 a[40:43], v[92:95], a[236:239], a[40:43]
    ds_read_b128 v[60:63], v12 offset:45408
    v_mfma_f32_16x16x32_bf16 a[36:39], v[92:95], a[232:235], a[36:39]
    v_mfma_f32_16x16x32_bf16 a[36:39], v[88:91], a[236:239], a[36:39]
    s_mov_b32 s28, 43008
    v_mfma_f32_16x16x32_bf16 a[32:35], v[88:91], a[232:235], a[32:35]
    buffer_load_dwordx4 a[164:167], v2, s[12:15], s28 offen offset:0 sc1
    v_mfma_f32_16x16x32_bf16 a[32:35], v[84:87], a[236:239], a[32:35]
    v_mfma_f32_16x16x32_bf16 a[28:31], v[84:87], a[232:235], a[28:31]
    v_mfma_f32_16x16x32_bf16 a[28:31], v[80:83], a[236:239], a[28:31]
    s_waitcnt lgkmcnt(1)
    v_lshlrev_b32 v40, 16, v56
    v_and_b32 v41, s84, v56
    v_mfma_f32_16x16x32_bf16 a[24:27], v[80:83], a[232:235], a[24:27]
    s_waitcnt lgkmcnt(0)
    ds_read_b128 v[48:51], v6 offset:45408
    v_lshlrev_b32 v42, 16, v60
    v_mfma_f32_16x16x32_bf16 a[24:27], v[76:79], a[236:239], a[24:27]
    s_waitcnt vmcnt(9)
    buffer_load_dwordx4 a[168:171], v2, s[12:15], s28 offen offset:1024 sc1
    v_mfma_f32_16x16x32_bf16 a[48:51], v[76:79], a[240:243], a[48:51]
    s_waitcnt vmcnt(9)
    ds_read_b128 v[52:55], v8 offset:45408
    v_and_b32 v43, s84, v60
    v_mfma_f32_16x16x32_bf16 a[48:51], v[80:83], a[244:247], a[48:51]
    v_add_f32 v40, v40, v42
    v_add_f32 v41, v41, v43
    v_mfma_f32_16x16x32_bf16 a[52:55], v[80:83], a[240:243], a[52:55]
    v_lshlrev_b32 v44, 16, v57
    v_and_b32 v45, s84, v57
    v_mfma_f32_16x16x32_bf16 a[52:55], v[84:87], a[244:247], a[52:55]
    v_lshlrev_b32 v46, 16, v61
    v_and_b32 v47, s84, v61
    v_mfma_f32_16x16x32_bf16 a[56:59], v[84:87], a[240:243], a[56:59]
    buffer_load_dwordx4 a[172:175], v2, s[12:15], s37 offen offset:1024 sc1
    v_mfma_f32_16x16x32_bf16 a[56:59], v[88:91], a[244:247], a[56:59]
    v_add_f32 v44, v44, v46
    v_add_f32 v45, v45, v47
    v_mfma_f32_16x16x32_bf16 a[60:63], v[88:91], a[240:243], a[60:63]
    v_cvt_pk_bf16_f32 v64, v40, v41
    v_cvt_pk_bf16_f32 v65, v44, v45
    v_mfma_f32_16x16x32_bf16 a[60:63], v[92:95], a[244:247], a[60:63]
    v_lshlrev_b32 v40, 16, v58
    v_mfma_f32_16x16x32_bf16 a[64:67], v[92:95], a[240:243], a[64:67]
    ds_read_b128 v[112:115], v8 offset:30272
    v_and_b32 v41, s84, v58
    v_mfma_f32_16x16x32_bf16 a[64:67], v[96:99], a[244:247], a[64:67]
    buffer_load_dwordx4 a[176:179], v2, s[12:15], s37 offen offset:2048 sc1
    v_mfma_f32_16x16x32_bf16 a[68:71], v[96:99], a[240:243], a[68:71]
    ds_read_b128 v[68:71], v8 offset:30416
    v_lshlrev_b32 v42, 16, v62
    v_mfma_f32_16x16x32_bf16 a[68:71], v[100:103], a[244:247], a[68:71]
    s_waitcnt vmcnt(10)
    v_and_b32 v43, s84, v62
    v_add_f32 v40, v40, v42
    v_mfma_f32_16x16x32_bf16 a[0:3], v[84:87], a[248:251], a[0:3]
    s_waitcnt vmcnt(9)
    ds_read_b128 v[72:75], v8 offset:30560
    v_add_f32 v41, v41, v43
    v_mfma_f32_16x16x32_bf16 a[0:3], v[88:91], a[252:255], a[0:3]
    v_lshlrev_b32 v44, 16, v59
    v_mfma_f32_16x16x32_bf16 a[4:7], v[88:91], a[248:251], a[4:7]
    buffer_load_dwordx4 a[180:183], v2, s[12:15], s28 offen offset:2048 sc1
    v_mfma_f32_16x16x32_bf16 a[4:7], v[92:95], a[252:255], a[4:7]
    ds_read_b128 v[76:79], v8 offset:30704
    v_and_b32 v45, s84, v59
    v_mfma_f32_16x16x32_bf16 a[8:11], v[92:95], a[248:251], a[8:11]
    v_lshlrev_b32 v46, 16, v63
    v_and_b32 v47, s84, v63
    v_mfma_f32_16x16x32_bf16 a[8:11], v[96:99], a[252:255], a[8:11]
    ds_read_b128 v[80:83], v8 offset:30848
    v_add_f32 v44, v44, v46
    v_mfma_f32_16x16x32_bf16 a[12:15], v[96:99], a[248:251], a[12:15]
    s_mov_b32 s36, 70656
    v_add_f32 v45, v45, v47
    v_mfma_f32_16x16x32_bf16 a[12:15], v[100:103], a[252:255], a[12:15]
    buffer_load_dwordx4 a[184:187], v2, s[12:15], s36 offen offset:0 sc1
    v_mfma_f32_16x16x32_bf16 a[16:19], v[100:103], a[248:251], a[16:19]
    v_cvt_pk_bf16_f32 v66, v40, v41
    v_cvt_pk_bf16_f32 v67, v44, v45
    v_mfma_f32_16x16x32_bf16 a[16:19], v[104:107], a[252:255], a[16:19]
    s_waitcnt lgkmcnt(6)
    v_lshlrev_b32 v40, 16, v48
    v_mfma_f32_16x16x32_bf16 a[20:23], v[104:107], a[248:251], a[20:23]
    v_and_b32 v41, s84, v48
    v_mfma_f32_16x16x32_bf16 a[20:23], v[108:111], a[252:255], a[20:23]
    s_waitcnt vmcnt(10) lgkmcnt(5)
    s_mov_b32 s37, 98304
    v_lshlrev_b32 v42, 16, v52
    v_mfma_f32_16x16x32_bf16 a[44:47], v[108:111], a[144:147], a[44:47]
    s_waitcnt vmcnt(9)
    buffer_load_dwordx4 a[188:191], v2, s[12:15], s37 offen offset:0 sc1
    v_mfma_f32_16x16x32_bf16 a[44:47], v[104:107], a[148:151], a[44:47]
    ds_read_b128 v[56:59], v6 offset:45552
    ds_read_b128 v[60:63], v8 offset:45552
    v_mfma_f32_16x16x32_bf16 a[40:43], v[104:107], a[144:147], a[40:43]
    v_and_b32 v43, s84, v52
    v_mfma_f32_16x16x32_bf16 a[40:43], v[100:103], a[148:151], a[40:43]
    v_add_f32 v40, v40, v42
    v_mfma_f32_16x16x32_bf16 a[36:39], v[100:103], a[144:147], a[36:39]
    v_add_f32 v41, v41, v43
    v_mfma_f32_16x16x32_bf16 a[36:39], v[96:99], a[148:151], a[36:39]
    buffer_load_dwordx4 a[192:195], v2, s[12:15], s37 offen offset:1024 sc1
    v_mfma_f32_16x16x32_bf16 a[32:35], v[96:99], a[144:147], a[32:35]
    v_lshlrev_b32 v44, 16, v49
    v_and_b32 v45, s84, v49
    v_mfma_f32_16x16x32_bf16 a[32:35], v[92:95], a[148:151], a[32:35]
    v_lshlrev_b32 v46, 16, v53
    v_mfma_f32_16x16x32_bf16 a[28:31], v[92:95], a[144:147], a[28:31]
    v_and_b32 v47, s84, v53
    v_mfma_f32_16x16x32_bf16 a[28:31], v[88:91], a[148:151], a[28:31]
    v_add_f32 v44, v44, v46
    v_mfma_f32_16x16x32_bf16 a[24:27], v[88:91], a[144:147], a[24:27]
    buffer_load_dwordx4 a[196:199], v2, s[12:15], s36 offen offset:1024 sc1
    v_mfma_f32_16x16x32_bf16 a[24:27], v[84:87], a[148:151], a[24:27]
    s_waitcnt vmcnt(11)
    v_add_f32 v45, v45, v47
    v_cvt_pk_bf16_f32 v196, v40, v41
    v_mfma_f32_16x16x32_bf16 a[48:51], v[84:87], a[152:155], a[48:51]
    s_waitcnt vmcnt(10)
    ds_read_b128 v[84:87], v8 offset:30992
    v_cvt_pk_bf16_f32 v197, v44, v45
    v_mfma_f32_16x16x32_bf16 a[48:51], v[88:91], a[156:159], a[48:51]
    v_lshlrev_b32 v40, 16, v50
    v_mfma_f32_16x16x32_bf16 a[52:55], v[88:91], a[152:155], a[52:55]
    ds_read_b128 v[88:91], v8 offset:31136
    v_and_b32 v41, s84, v50
    v_mfma_f32_16x16x32_bf16 a[52:55], v[92:95], a[156:159], a[52:55]
    buffer_load_dwordx4 a[200:203], v2, s[12:15], s36 offen offset:2048 sc1
    v_mfma_f32_16x16x32_bf16 a[56:59], v[92:95], a[152:155], a[56:59]
    v_lshlrev_b32 v42, 16, v54
    v_and_b32 v43, s84, v54
    v_mfma_f32_16x16x32_bf16 a[56:59], v[96:99], a[156:159], a[56:59]
    v_add_f32 v40, v40, v42
    v_mfma_f32_16x16x32_bf16 a[60:63], v[96:99], a[152:155], a[60:63]
    v_add_f32 v41, v41, v43
    v_mfma_f32_16x16x32_bf16 a[60:63], v[100:103], a[156:159], a[60:63]
    v_lshlrev_b32 v44, 16, v51
    v_mfma_f32_16x16x32_bf16 a[64:67], v[100:103], a[152:155], a[64:67]
    buffer_load_dwordx4 a[204:207], v2, s[12:15], s37 offen offset:2048 sc1
    v_mfma_f32_16x16x32_bf16 a[64:67], v[104:107], a[156:159], a[64:67]
    v_and_b32 v45, s84, v51
    v_lshlrev_b32 v46, 16, v55
    v_mfma_f32_16x16x32_bf16 a[68:71], v[104:107], a[152:155], a[68:71]
    v_and_b32 v47, s84, v55
    v_mfma_f32_16x16x32_bf16 a[68:71], v[108:111], a[156:159], a[68:71]
    s_waitcnt vmcnt(11) lgkmcnt(8)
    v_add_f32 v44, v44, v46
    v_mfma_f32_16x16x32_bf16 a[0:3], v[112:115], a[160:163], a[0:3]
    s_waitcnt vmcnt(10) lgkmcnt(7)
    s_mov_b32 s28, 125952
    v_add_f32 v45, v45, v47
    v_mfma_f32_16x16x32_bf16 a[0:3], v[68:71], a[164:167], a[0:3]
    buffer_load_dwordx4 a[208:211], v2, s[12:15], s28 offen offset:0 sc1
    v_mfma_f32_16x16x32_bf16 a[4:7], v[68:71], a[160:163], a[4:7]
    s_waitcnt lgkmcnt(6)
    v_cvt_pk_bf16_f32 v198, v40, v41
    v_cvt_pk_bf16_f32 v199, v44, v45
    v_mfma_f32_16x16x32_bf16 a[4:7], v[72:75], a[164:167], a[4:7]
    s_waitcnt lgkmcnt(3)
    v_lshlrev_b32 v40, 16, v56
    v_mfma_f32_16x16x32_bf16 a[8:11], v[72:75], a[160:163], a[8:11]
    s_mov_b32 s36, 153600
    v_and_b32 v41, s84, v56
    v_mfma_f32_16x16x32_bf16 a[8:11], v[76:79], a[164:167], a[8:11]
    s_waitcnt lgkmcnt(2)
    ds_read_b128 v[92:95], v8 offset:31280
    v_lshlrev_b32 v42, 16, v60
    v_mfma_f32_16x16x32_bf16 a[12:15], v[76:79], a[160:163], a[12:15]
    buffer_load_dwordx4 a[212:215], v2, s[12:15], s36 offen offset:0 sc1
    v_mfma_f32_16x16x32_bf16 a[12:15], v[80:83], a[164:167], a[12:15]
    ds_read_b128 v[96:99], v8 offset:31424
    ds_read_b128 v[48:51], v6 offset:45696
    v_mfma_f32_16x16x32_bf16 a[16:19], v[80:83], a[160:163], a[16:19]
    s_waitcnt lgkmcnt(4)
    ds_read_b128 v[52:55], v8 offset:45696
    v_and_b32 v43, s84, v60
    v_mfma_f32_16x16x32_bf16 a[16:19], v[84:87], a[164:167], a[16:19]
    v_add_f32 v40, v40, v42
    v_mfma_f32_16x16x32_bf16 a[20:23], v[84:87], a[160:163], a[20:23]
    s_waitcnt lgkmcnt(4)
    v_add_f32 v41, v41, v43
    v_mfma_f32_16x16x32_bf16 a[20:23], v[88:91], a[164:167], a[20:23]
    s_waitcnt vmcnt(11)
    buffer_load_dwordx4 a[216:219], v2, s[12:15], s36 offen offset:1024 sc1
    v_mfma_f32_16x16x32_bf16 a[44:47], v[88:91], a[168:171], a[44:47]
    s_waitcnt vmcnt(11)
    v_lshlrev_b32 v44, 16, v57
    v_and_b32 v45, s84, v57
    v_mfma_f32_16x16x32_bf16 a[44:47], v[84:87], a[172:175], a[44:47]
    v_lshlrev_b32 v46, 16, v61
    v_mfma_f32_16x16x32_bf16 a[40:43], v[84:87], a[168:171], a[40:43]
    v_and_b32 v47, s84, v61
    v_mfma_f32_16x16x32_bf16 a[40:43], v[80:83], a[172:175], a[40:43]
    buffer_load_dwordx4 a[220:223], v2, s[12:15], s28 offen offset:1024 sc1
    v_mfma_f32_16x16x32_bf16 a[36:39], v[80:83], a[168:171], a[36:39]
    v_add_f32 v44, v44, v46
    v_add_f32 v45, v45, v47
    v_mfma_f32_16x16x32_bf16 a[36:39], v[76:79], a[172:175], a[36:39]
    v_cvt_pk_bf16_f32 v200, v40, v41
    v_mfma_f32_16x16x32_bf16 a[32:35], v[76:79], a[168:171], a[32:35]
    v_cvt_pk_bf16_f32 v201, v44, v45
    v_mfma_f32_16x16x32_bf16 a[32:35], v[72:75], a[172:175], a[32:35]
    v_lshlrev_b32 v40, 16, v58
    v_mfma_f32_16x16x32_bf16 a[28:31], v[72:75], a[168:171], a[28:31]
    buffer_load_dwordx4 a[224:227], v2, s[12:15], s28 offen offset:2048 sc1
    v_mfma_f32_16x16x32_bf16 a[28:31], v[68:71], a[172:175], a[28:31]
    v_and_b32 v41, s84, v58
    v_lshlrev_b32 v42, 16, v62
    v_mfma_f32_16x16x32_bf16 a[24:27], v[68:71], a[168:171], a[24:27]
    v_and_b32 v43, s84, v62
    v_mfma_f32_16x16x32_bf16 a[24:27], v[112:115], a[172:175], a[24:27]
    s_waitcnt vmcnt(12)
    v_add_f32 v40, v40, v42
    v_mfma_f32_16x16x32_bf16 a[48:51], v[112:115], a[176:179], a[48:51]
    s_waitcnt vmcnt(11)
    v_add_f32 v41, v41, v43
    v_mfma_f32_16x16x32_bf16 a[48:51], v[68:71], a[180:183], a[48:51]
    buffer_load_dwordx4 a[228:231], v2, s[12:15], s36 offen offset:2048 sc1
    v_mfma_f32_16x16x32_bf16 a[52:55], v[68:71], a[176:179], a[52:55]
    v_lshlrev_b32 v44, 16, v59
    v_and_b32 v45, s84, v59
    v_mfma_f32_16x16x32_bf16 a[52:55], v[72:75], a[180:183], a[52:55]
    v_lshlrev_b32 v46, 16, v63
    v_mfma_f32_16x16x32_bf16 a[56:59], v[72:75], a[176:179], a[56:59]
    v_and_b32 v47, s84, v63
    v_mfma_f32_16x16x32_bf16 a[56:59], v[76:79], a[180:183], a[56:59]
    s_mov_b32 s37, 181248
    v_add_f32 v44, v44, v46
    v_mfma_f32_16x16x32_bf16 a[60:63], v[76:79], a[176:179], a[60:63]
    buffer_load_dwordx4 a[232:235], v2, s[12:15], s37 offen offset:0 sc1
    v_mfma_f32_16x16x32_bf16 a[60:63], v[80:83], a[180:183], a[60:63]
    v_add_f32 v45, v45, v47
    v_mfma_f32_16x16x32_bf16 a[64:67], v[80:83], a[176:179], a[64:67]
    v_cvt_pk_bf16_f32 v202, v40, v41
    v_mfma_f32_16x16x32_bf16 a[64:67], v[84:87], a[180:183], a[64:67]
    v_cvt_pk_bf16_f32 v203, v44, v45
    v_mfma_f32_16x16x32_bf16 a[68:71], v[84:87], a[176:179], a[68:71]
    s_waitcnt lgkmcnt(1)
    s_mov_b32 s28, 208896
    v_lshlrev_b32 v40, 16, v48
    v_mfma_f32_16x16x32_bf16 a[68:71], v[88:91], a[180:183], a[68:71]
    s_waitcnt vmcnt(12)
    buffer_load_dwordx4 a[236:239], v2, s[12:15], s28 offen offset:0 sc1
    v_mfma_f32_16x16x32_bf16 a[0:3], v[72:75], a[184:187], a[0:3]
    s_waitcnt vmcnt(12) lgkmcnt(0)
    v_and_b32 v41, s84, v48
    v_lshlrev_b32 v42, 16, v52
    v_mfma_f32_16x16x32_bf16 a[0:3], v[76:79], a[188:191], a[0:3]
    ds_read_b128 v[56:59], v6 offset:45840
    v_mfma_f32_16x16x32_bf16 a[4:7], v[76:79], a[184:187], a[4:7]
    ds_read_b128 v[60:63], v8 offset:45840
    v_mfma_f32_16x16x32_bf16 a[4:7], v[80:83], a[188:191], a[4:7]
    v_and_b32 v43, s84, v52
    v_mfma_f32_16x16x32_bf16 a[8:11], v[80:83], a[184:187], a[8:11]
    buffer_load_dwordx4 a[240:243], v2, s[12:15], s28 offen offset:1024 sc1
    v_mfma_f32_16x16x32_bf16 a[8:11], v[84:87], a[188:191], a[8:11]
    ds_read_b128 v[100:103], v8 offset:31568
    v_add_f32 v40, v40, v42
    v_mfma_f32_16x16x32_bf16 a[12:15], v[84:87], a[184:187], a[12:15]
    v_add_f32 v41, v41, v43
    v_lshlrev_b32 v44, 16, v49
    v_mfma_f32_16x16x32_bf16 a[12:15], v[88:91], a[188:191], a[12:15]
    ds_read_b128 v[104:107], v8 offset:31712
    v_and_b32 v45, s84, v49
    v_mfma_f32_16x16x32_bf16 a[16:19], v[88:91], a[184:187], a[16:19]
    v_lshlrev_b32 v46, 16, v53
    v_mfma_f32_16x16x32_bf16 a[16:19], v[92:95], a[188:191], a[16:19]
    buffer_load_dwordx4 a[244:247], v2, s[12:15], s37 offen offset:1024 sc1
    v_mfma_f32_16x16x32_bf16 a[20:23], v[92:95], a[184:187], a[20:23]
    v_and_b32 v47, s84, v53
    v_add_f32 v44, v44, v46
    v_mfma_f32_16x16x32_bf16 a[20:23], v[96:99], a[188:191], a[20:23]
    s_waitcnt vmcnt(13)
    v_add_f32 v45, v45, v47
    v_mfma_f32_16x16x32_bf16 a[44:47], v[96:99], a[192:195], a[44:47]
    s_waitcnt vmcnt(12)
    v_cvt_pk_bf16_f32 v204, v40, v41
    v_mfma_f32_16x16x32_bf16 a[44:47], v[92:95], a[196:199], a[44:47]
    v_cvt_pk_bf16_f32 v205, v44, v45
    v_mfma_f32_16x16x32_bf16 a[40:43], v[92:95], a[192:195], a[40:43]
    buffer_load_dwordx4 a[248:251], v2, s[12:15], s37 offen offset:2048 sc1
    v_mfma_f32_16x16x32_bf16 a[40:43], v[88:91], a[196:199], a[40:43]
    v_lshlrev_b32 v40, 16, v50
    v_and_b32 v41, s84, v50
    v_mfma_f32_16x16x32_bf16 a[36:39], v[88:91], a[192:195], a[36:39]
    v_lshlrev_b32 v42, 16, v54
    v_mfma_f32_16x16x32_bf16 a[36:39], v[84:87], a[196:199], a[36:39]
    v_and_b32 v43, s84, v54
    v_mfma_f32_16x16x32_bf16 a[32:35], v[84:87], a[192:195], a[32:35]
    v_add_f32 v40, v40, v42
    v_mfma_f32_16x16x32_bf16 a[32:35], v[80:83], a[196:199], a[32:35]
    buffer_load_dwordx4 a[252:255], v2, s[12:15], s28 offen offset:2048 sc1
    v_mfma_f32_16x16x32_bf16 a[28:31], v[80:83], a[192:195], a[28:31]
    v_add_f32 v41, v41, v43
    v_lshlrev_b32 v44, 16, v51
    v_mfma_f32_16x16x32_bf16 a[28:31], v[76:79], a[196:199], a[28:31]
    v_and_b32 v45, s84, v51
    v_mfma_f32_16x16x32_bf16 a[24:27], v[76:79], a[192:195], a[24:27]
    v_lshlrev_b32 v46, 16, v55
    v_mfma_f32_16x16x32_bf16 a[24:27], v[72:75], a[196:199], a[24:27]
    s_waitcnt vmcnt(13)
    s_mov_b32 s36, 21504
    v_and_b32 v47, s84, v55
    v_mfma_f32_16x16x32_bf16 a[48:51], v[72:75], a[200:203], a[48:51]
    s_waitcnt vmcnt(12)
    buffer_load_dwordx4 a[144:147], v2, s[12:15], s36 offen offset:0 sc1
    v_mfma_f32_16x16x32_bf16 a[48:51], v[76:79], a[204:207], a[48:51]
Lt1:
    s_cbranch_execz Lt2
    v_add_f32 v44, v44, v46
    v_add_f32 v45, v45, v47
    v_mfma_f32_16x16x32_bf16 a[52:55], v[76:79], a[200:203], a[52:55]
    v_cvt_pk_bf16_f32 v206, v40, v41
    v_mfma_f32_16x16x32_bf16 a[52:55], v[80:83], a[204:207], a[52:55]
    v_cvt_pk_bf16_f32 v207, v44, v45
    v_mfma_f32_16x16x32_bf16 a[56:59], v[80:83], a[200:203], a[56:59]
    s_waitcnt lgkmcnt(3)
    s_mov_b32 s37, 49152
    v_lshlrev_b32 v40, 16, v56
    v_mfma_f32_16x16x32_bf16 a[56:59], v[84:87], a[204:207], a[56:59]
    buffer_load_dwordx4 a[148:151], v2, s[12:15], s37 offen offset:0 sc1
    v_mfma_f32_16x16x32_bf16 a[60:63], v[84:87], a[200:203], a[60:63]
    s_waitcnt lgkmcnt(2)
    v_and_b32 v41, s84, v56
    v_lshlrev_b32 v42, 16, v60
    v_mfma_f32_16x16x32_bf16 a[60:63], v[88:91], a[204:207], a[60:63]
    ds_read_b128 v[48:51], v6 offset:45984
    v_mfma_f32_16x16x32_bf16 a[64:67], v[88:91], a[200:203], a[64:67]
    ds_read_b128 v[52:55], v8 offset:45984
    v_mfma_f32_16x16x32_bf16 a[64:67], v[92:95], a[204:207], a[64:67]
    v_and_b32 v43, s84, v60
    v_mfma_f32_16x16x32_bf16 a[68:71], v[92:95], a[200:203], a[68:71]
    buffer_load_dwordx4 a[152:155], v2, s[12:15], s37 offen offset:1024 sc1
    v_mfma_f32_16x16x32_bf16 a[68:71], v[96:99], a[204:207], a[68:71]
    s_waitcnt vmcnt(14)
    v_add_f32 v40, v40, v42
    v_add_f32 v41, v41, v43
    v_mfma_f32_16x16x32_bf16 a[0:3], v[80:83], a[208:211], a[0:3]
    s_waitcnt vmcnt(13)
    v_lshlrev_b32 v44, 16, v57
    v_mfma_f32_16x16x32_bf16 a[0:3], v[84:87], a[212:215], a[0:3]
    v_and_b32 v45, s84, v57
    v_mfma_f32_16x16x32_bf16 a[4:7], v[84:87], a[208:211], a[4:7]
    v_lshlrev_b32 v46, 16, v61
    v_mfma_f32_16x16x32_bf16 a[4:7], v[88:91], a[212:215], a[4:7]
    buffer_load_dwordx4 a[156:159], v2, s[12:15], s36 offen offset:1024 sc1
    v_mfma_f32_16x16x32_bf16 a[8:11], v[88:91], a[208:211], a[8:11]
    v_and_b32 v47, s84, v61
    v_add_f32 v44, v44, v46
    v_mfma_f32_16x16x32_bf16 a[8:11], v[92:95], a[212:215], a[8:11]
    ds_read_b128 v[108:111], v8 offset:31856
    v_add_f32 v45, v45, v47
    v_mfma_f32_16x16x32_bf16 a[12:15], v[92:95], a[208:211], a[12:15]
    v_cvt_pk_bf16_f32 v208, v40, v41
    v_mfma_f32_16x16x32_bf16 a[12:15], v[96:99], a[212:215], a[12:15]
    ds_read_b128 v[112:115], v8 offset:32000
    v_cvt_pk_bf16_f32 v209, v44, v45
    v_mfma_f32_16x16x32_bf16 a[16:19], v[96:99], a[208:211], a[16:19]
    s_waitcnt lgkmcnt(5)
    buffer_load_dwordx4 a[160:163], v2, s[12:15], s36 offen offset:2048 sc1
    v_mfma_f32_16x16x32_bf16 a[16:19], v[100:103], a[212:215], a[16:19]
    v_lshlrev_b32 v40, 16, v58
    v_and_b32 v41, s84, v58
    v_mfma_f32_16x16x32_bf16 a[20:23], v[100:103], a[208:211], a[20:23]
    s_waitcnt lgkmcnt(4)
    v_lshlrev_b32 v42, 16, v62
    v_mfma_f32_16x16x32_bf16 a[20:23], v[104:107], a[212:215], a[20:23]
    s_waitcnt vmcnt(14)
    v_and_b32 v43, s84, v62
    v_mfma_f32_16x16x32_bf16 a[44:47], v[104:107], a[216:219], a[44:47]
    s_waitcnt vmcnt(13)
    buffer_load_dwordx4 a[164:167], v2, s[12:15], s37 offen offset:2048 sc1
    v_mfma_f32_16x16x32_bf16 a[44:47], v[100:103], a[220:223], a[44:47]
    v_add_f32 v40, v40, v42
    v_add_f32 v41, v41, v43
    v_mfma_f32_16x16x32_bf16 a[40:43], v[100:103], a[216:219], a[40:43]
    v_lshlrev_b32 v44, 16, v59
    v_mfma_f32_16x16x32_bf16 a[40:43], v[96:99], a[220:223], a[40:43]
    v_and_b32 v45, s84, v59
    v_mfma_f32_16x16x32_bf16 a[36:39], v[96:99], a[216:219], a[36:39]
    s_mov_b32 s28, 76800
    v_lshlrev_b32 v46, 16, v63
    v_mfma_f32_16x16x32_bf16 a[36:39], v[92:95], a[220:223], a[36:39]
    buffer_load_dwordx4 a[168:171], v2, s[12:15], s28 offen offset:0 sc1
    v_mfma_f32_16x16x32_bf16 a[32:35], v[92:95], a[216:219], a[32:35]
    v_and_b32 v47, s84, v63
    v_add_f32 v44, v44, v46
    v_mfma_f32_16x16x32_bf16 a[32:35], v[88:91], a[220:223], a[32:35]
    v_add_f32 v45, v45, v47
    v_mfma_f32_16x16x32_bf16 a[28:31], v[88:91], a[216:219], a[28:31]
    v_cvt_pk_bf16_f32 v210, v40, v41
    v_mfma_f32_16x16x32_bf16 a[28:31], v[84:87], a[220:223], a[28:31]
    s_mov_b32 s36, 104448
    v_cvt_pk_bf16_f32 v211, v44, v45
    v_mfma_f32_16x16x32_bf16 a[24:27], v[84:87], a[216:219], a[24:27]
    buffer_load_dwordx4 a[172:175], v2, s[12:15], s36 offen offset:0 sc1
    v_mfma_f32_16x16x32_bf16 a[24:27], v[80:83], a[220:223], a[24:27]
    s_waitcnt vmcnt(15) lgkmcnt(3)
    v_lshlrev_b32 v40, 16, v48
    v_and_b32 v41, s84, v48
    v_mfma_f32_16x16x32_bf16 a[48:51], v[80:83], a[224:227], a[48:51]
    s_waitcnt vmcnt(14) lgkmcnt(2)
    v_lshlrev_b32 v42, 16, v52
    v_mfma_f32_16x16x32_bf16 a[48:51], v[84:87], a[228:231], a[48:51]
    ds_read_b128 v[56:59], v6 offset:46128
    v_mfma_f32_16x16x32_bf16 a[52:55], v[84:87], a[224:227], a[52:55]
    s_mov_b32 s37, 159744
    ds_read_b128 v[60:63], v8 offset:46128
    v_mfma_f32_16x16x32_bf16 a[52:55], v[88:91], a[228:231], a[52:55]
    buffer_load_dwordx4 a[176:179], v2, s[12:15], s37 offen offset:0 sc1
    v_mfma_f32_16x16x32_bf16 a[56:59], v[88:91], a[224:227], a[56:59]
    v_and_b32 v43, s84, v52
    v_add_f32 v40, v40, v42
    v_mfma_f32_16x16x32_bf16 a[56:59], v[92:95], a[228:231], a[56:59]
    v_add_f32 v41, v41, v43
    v_mfma_f32_16x16x32_bf16 a[60:63], v[92:95], a[224:227], a[60:63]
    v_lshlrev_b32 v44, 16, v49
    v_mfma_f32_16x16x32_bf16 a[60:63], v[96:99], a[228:231], a[60:63]
    s_mov_b32 s28, 132096
    v_and_b32 v45, s84, v49
    v_mfma_f32_16x16x32_bf16 a[64:67], v[96:99], a[224:227], a[64:67]
    buffer_load_dwordx4 a[180:183], v2, s[12:15], s28 offen offset:0 sc1
    v_mfma_f32_16x16x32_bf16 a[64:67], v[100:103], a[228:231], a[64:67]
    ds_read_b128 v[68:71], v8 offset:45408
    v_lshlrev_b32 v46, 16, v53
    v_mfma_f32_16x16x32_bf16 a[68:71], v[100:103], a[224:227], a[68:71]
    v_and_b32 v47, s84, v53
    v_add_f32 v44, v44, v46
    v_mfma_f32_16x16x32_bf16 a[68:71], v[104:107], a[228:231], a[68:71]
    s_waitcnt vmcnt(15)
    ds_read_b128 v[72:75], v8 offset:45552
    v_add_f32 v45, v45, v47
    v_mfma_f32_16x16x32_bf16 a[0:3], v[88:91], a[232:235], a[0:3]
    s_waitcnt vmcnt(14)
    s_mov_b32 s36, 187392
    v_cvt_pk_bf16_f32 v212, v40, v41
    v_mfma_f32_16x16x32_bf16 a[0:3], v[92:95], a[236:239], a[0:3]
    buffer_load_dwordx4 a[184:187], v2, s[12:15], s36 offen offset:0 sc1
    v_mfma_f32_16x16x32_bf16 a[4:7], v[92:95], a[232:235], a[4:7]
    ds_read_b128 v[76:79], v8 offset:45696
    v_cvt_pk_bf16_f32 v213, v44, v45
    v_mfma_f32_16x16x32_bf16 a[4:7], v[96:99], a[236:239], a[4:7]
    v_lshlrev_b32 v40, 16, v50
    v_and_b32 v41, s84, v50
    v_mfma_f32_16x16x32_bf16 a[8:11], v[96:99], a[232:235], a[8:11]
    ds_read_b128 v[80:83], v8 offset:45840
    v_lshlrev_b32 v42, 16, v54
    v_mfma_f32_16x16x32_bf16 a[8:11], v[100:103], a[236:239], a[8:11]
    s_mov_b32 s37, 215040
    v_and_b32 v43, s84, v54
    v_mfma_f32_16x16x32_bf16 a[12:15], v[100:103], a[232:235], a[12:15]
    buffer_load_dwordx4 a[188:191], v2, s[12:15], s37 offen offset:0 sc1
    v_mfma_f32_16x16x32_bf16 a[12:15], v[104:107], a[236:239], a[12:15]
    ds_read_b128 v[84:87], v8 offset:45984
    v_add_f32 v40, v40, v42
    v_mfma_f32_16x16x32_bf16 a[16:19], v[104:107], a[232:235], a[16:19]
    s_waitcnt lgkmcnt(8)
    v_add_f32 v41, v41, v43
    v_lshlrev_b32 v44, 16, v51
    v_mfma_f32_16x16x32_bf16 a[16:19], v[108:111], a[236:239], a[16:19]
    v_and_b32 v45, s84, v51
    v_mfma_f32_16x16x32_bf16 a[20:23], v[108:111], a[232:235], a[20:23]
    s_waitcnt lgkmcnt(7)
    s_mov_b32 s28, 76800
    v_lshlrev_b32 v46, 16, v55
    v_mfma_f32_16x16x32_bf16 a[20:23], v[112:115], a[236:239], a[20:23]
    s_waitcnt vmcnt(15)
    buffer_load_dwordx4 a[192:195], v2, s[12:15], s28 offen offset:1024 sc1
    v_mfma_f32_16x16x32_bf16 a[44:47], v[112:115], a[240:243], a[44:47]
    s_waitcnt vmcnt(15)
    v_and_b32 v47, s84, v55
    v_mfma_f32_16x16x32_bf16 a[44:47], v[108:111], a[244:247], a[44:47]
    v_add_f32 v44, v44, v46
    v_mfma_f32_16x16x32_bf16 a[40:43], v[108:111], a[240:243], a[40:43]
    v_add_f32 v45, v45, v47
    v_mfma_f32_16x16x32_bf16 a[40:43], v[104:107], a[244:247], a[40:43]
    s_mov_b32 s36, 104448
    v_cvt_pk_bf16_f32 v214, v40, v41
    v_mfma_f32_16x16x32_bf16 a[36:39], v[104:107], a[240:243], a[36:39]
    buffer_load_dwordx4 a[196:199], v2, s[12:15], s36 offen offset:1024 sc1
    v_mfma_f32_16x16x32_bf16 a[36:39], v[100:103], a[244:247], a[36:39]
    s_waitcnt lgkmcnt(6)
    v_cvt_pk_bf16_f32 v215, v44, v45
    v_lshlrev_b32 v40, 16, v56
    v_mfma_f32_16x16x32_bf16 a[32:35], v[100:103], a[240:243], a[32:35]
    v_and_b32 v41, s84, v56
    v_mfma_f32_16x16x32_bf16 a[32:35], v[96:99], a[244:247], a[32:35]
    s_waitcnt lgkmcnt(5)
    v_lshlrev_b32 v42, 16, v60
    v_mfma_f32_16x16x32_bf16 a[28:31], v[96:99], a[240:243], a[28:31]
    s_mov_b32 s37, 159744
    v_and_b32 v43, s84, v60
    v_mfma_f32_16x16x32_bf16 a[28:31], v[92:95], a[244:247], a[28:31]
    buffer_load_dwordx4 a[200:203], v2, s[12:15], s37 offen offset:1024 sc1
    v_mfma_f32_16x16x32_bf16 a[24:27], v[92:95], a[240:243], a[24:27]
    v_add_f32 v40, v40, v42
    v_add_f32 v41, v41, v43
    v_mfma_f32_16x16x32_bf16 a[24:27], v[88:91], a[244:247], a[24:27]
    s_waitcnt vmcnt(16)
    v_lshlrev_b32 v44, 16, v57
    v_mfma_f32_16x16x32_bf16 a[48:51], v[88:91], a[248:251], a[48:51]
    s_waitcnt vmcnt(15)
    ds_read_b128 v[88:91], v8 offset:46128
    v_and_b32 v45, s84, v57
    v_mfma_f32_16x16x32_bf16 a[48:51], v[92:95], a[252:255], a[48:51]
    s_mov_b32 s28, 132096
    v_lshlrev_b32 v46, 16, v61
    v_mfma_f32_16x16x32_bf16 a[52:55], v[92:95], a[248:251], a[52:55]
    buffer_load_dwordx4 a[204:207], v2, s[12:15], s28 offen offset:1024 sc1
    v_mfma_f32_16x16x32_bf16 a[52:55], v[96:99], a[252:255], a[52:55]
    ds_read_b128 v[92:95], v8 offset:46272
    v_and_b32 v47, s84, v61
    v_mfma_f32_16x16x32_bf16 a[56:59], v[96:99], a[248:251], a[56:59]
    v_add_f32 v44, v44, v46
    v_add_f32 v45, v45, v47
    v_mfma_f32_16x16x32_bf16 a[56:59], v[100:103], a[252:255], a[56:59]
    v_cvt_pk_bf16_f32 v216, v40, v41
    v_mfma_f32_16x16x32_bf16 a[60:63], v[100:103], a[248:251], a[60:63]
    s_mov_b32 s36, 187392
    v_cvt_pk_bf16_f32 v217, v44, v45
    v_mfma_f32_16x16x32_bf16 a[60:63], v[104:107], a[252:255], a[60:63]
    buffer_load_dwordx4 a[208:211], v2, s[12:15], s36 offen offset:1024 sc1
    v_mfma_f32_16x16x32_bf16 a[64:67], v[104:107], a[248:251], a[64:67]
    global_load_short_d16_hi v13, v0, s[40:41] offset:0
    v_mfma_f32_16x16x32_bf16 a[64:67], v[108:111], a[252:255], a[64:67]
    v_lshlrev_b32 v40, 16, v58
    v_and_b32 v41, s84, v58
    v_mfma_f32_16x16x32_bf16 a[68:71], v[108:111], a[248:251], a[68:71]
    v_lshlrev_b32 v42, 16, v62
    v_and_b32 v43, s84, v62
    v_mfma_f32_16x16x32_bf16 a[68:71], v[112:115], a[252:255], a[68:71]
    s_waitcnt vmcnt(17) lgkmcnt(6)
    s_mov_b32 s37, 215040
    v_add_f32 v40, v40, v42
    v_mfma_f32_16x16x32_bf16 a[0:3], v[68:71], a[144:147], a[0:3]
    s_waitcnt vmcnt(16) lgkmcnt(5)
    buffer_load_dwordx4 a[212:215], v2, s[12:15], s37 offen offset:1024 sc1
    v_mfma_f32_16x16x32_bf16 a[0:3], v[72:75], a[148:151], a[0:3]
    global_load_short_d16_hi v14, v0, s[40:41] offset:32
    v_mfma_f32_16x16x32_bf16 a[4:7], v[72:75], a[144:147], a[4:7]
    s_waitcnt lgkmcnt(4)
    v_add_f32 v41, v41, v43
    v_lshlrev_b32 v44, 16, v59
    v_mfma_f32_16x16x32_bf16 a[4:7], v[76:79], a[148:151], a[4:7]
    v_and_b32 v45, s84, v59
    v_lshlrev_b32 v46, 16, v63
    v_mfma_f32_16x16x32_bf16 a[8:11], v[76:79], a[144:147], a[8:11]
    s_waitcnt lgkmcnt(3)
    s_mov_b32 s28, 76800
    v_and_b32 v47, s84, v63
    v_mfma_f32_16x16x32_bf16 a[8:11], v[80:83], a[148:151], a[8:11]
    buffer_load_dwordx4 a[216:219], v2, s[12:15], s28 offen offset:2048 sc1
    v_mfma_f32_16x16x32_bf16 a[12:15], v[80:83], a[144:147], a[12:15]
    s_waitcnt lgkmcnt(2)
    ds_read_b128 v[96:99], v8 offset:46416
    v_add_f32 v44, v44, v46
    v_mfma_f32_16x16x32_bf16 a[12:15], v[84:87], a[148:151], a[12:15]
    global_load_short_d16_hi v15, v0, s[40:41] offset:64
    v_mfma_f32_16x16x32_bf16 a[16:19], v[84:87], a[144:147], a[16:19]
    s_waitcnt lgkmcnt(2)
    s_mov_b32 s36, 104448
    ds_read_b128 v[100:103], v8 offset:46560
    v_add_f32 v45, v45, v47
    v_mfma_f32_16x16x32_bf16 a[16:19], v[88:91], a[148:151], a[16:19]
    buffer_load_dwordx4 a[220:223], v2, s[12:15], s36 offen offset:2048 sc1
    v_mfma_f32_16x16x32_bf16 a[20:23], v[88:91], a[144:147], a[20:23]
    s_waitcnt lgkmcnt(2)
    ds_read_b128 v[104:107], v8 offset:46704
    v_cvt_pk_bf16_f32 v218, v40, v41
    v_mfma_f32_16x16x32_bf16 a[20:23], v[92:95], a[148:151], a[20:23]
    s_waitcnt vmcnt(20)
    v_cvt_pk_bf16_f32 v219, v44, v45
    v_mov_b32_dpp v220, v64 row_shr:15 row_mask:0xf bank_mask:0xf
    v_mfma_f32_16x16x32_bf16 a[44:47], v[92:95], a[152:155], a[44:47]
    s_waitcnt vmcnt(19)
    global_load_short_d16_hi v16, v0, s[42:43] offset:0
    v_mfma_f32_16x16x32_bf16 a[44:47], v[88:91], a[156:159], a[44:47]
    s_mov_b32 s37, 159744
    ds_read_b128 v[108:111], v8 offset:46848
    v_mov_b32_dpp v221, v65 row_shr:15 row_mask:0xf bank_mask:0xf
    v_mfma_f32_16x16x32_bf16 a[40:43], v[88:91], a[152:155], a[40:43]
    buffer_load_dwordx4 a[224:227], v2, s[12:15], s37 offen offset:2048 sc1
    v_mfma_f32_16x16x32_bf16 a[40:43], v[84:87], a[156:159], a[40:43]
    v_mov_b32_dpp v222, v66 row_shr:15 row_mask:0xf bank_mask:0xf
    v_mov_b32_dpp v223, v67 row_shr:15 row_mask:0xf bank_mask:0xf
    v_mfma_f32_16x16x32_bf16 a[36:39], v[84:87], a[152:155], a[36:39]
    v_mov_b32_dpp v220, v196 row_shl:1 row_mask:0xf bank_mask:0xf
    v_mov_b32_dpp v221, v197 row_shl:1 row_mask:0xf bank_mask:0xf
    v_mfma_f32_16x16x32_bf16 a[36:39], v[80:83], a[156:159], a[36:39]
    s_mov_b32 s28, 132096
    v_mov_b32_dpp v222, v198 row_shl:1 row_mask:0xf bank_mask:0xf
    v_mov_b32_dpp v223, v199 row_shl:1 row_mask:0xf bank_mask:0xf
    v_mfma_f32_16x16x32_bf16 a[32:35], v[80:83], a[152:155], a[32:35]
    global_load_short_d16_hi v17, v0, s[42:43] offset:32
    v_mfma_f32_16x16x32_bf16 a[32:35], v[76:79], a[156:159], a[32:35]
    buffer_load_dwordx4 a[228:231], v2, s[12:15], s28 offen offset:2048 sc1
    v_mfma_f32_16x16x32_bf16 a[28:31], v[76:79], a[152:155], a[28:31]
    v_mov_b32_dpp v224, v64 row_shr:14 row_mask:0xf bank_mask:0xf
    v_mov_b32_dpp v225, v65 row_shr:14 row_mask:0xf bank_mask:0xf
    v_mfma_f32_16x16x32_bf16 a[28:31], v[72:75], a[156:159], a[28:31]
    v_mov_b32_dpp v226, v66 row_shr:14 row_mask:0xf bank_mask:0xf
    v_mov_b32_dpp v227, v67 row_shr:14 row_mask:0xf bank_mask:0xf
    v_mfma_f32_16x16x32_bf16 a[24:27], v[72:75], a[152:155], a[24:27]
    s_mov_b32 s36, 187392
    v_mov_b32_dpp v224, v200 row_shl:1 row_mask:0xf bank_mask:0xf
    v_mov_b32_dpp v225, v201 row_shl:1 row_mask:0xf bank_mask:0xf
    v_mfma_f32_16x16x32_bf16 a[24:27], v[68:71], a[156:159], a[24:27]
    s_waitcnt vmcnt(22)
    global_load_short_d16_hi v18, v0, s[42:43] offset:64
    v_mfma_f32_16x16x32_bf16 a[48:51], v[68:71], a[160:163], a[48:51]
    s_waitcnt vmcnt(22)
    buffer_load_dwordx4 a[232:235], v2, s[12:15], s36 offen offset:2048 sc1
    v_mfma_f32_16x16x32_bf16 a[48:51], v[72:75], a[164:167], a[48:51]
    v_mov_b32_dpp v226, v202 row_shl:1 row_mask:0xf bank_mask:0xf
    v_mov_b32_dpp v227, v203 row_shl:1 row_mask:0xf bank_mask:0xf
    v_mfma_f32_16x16x32_bf16 a[52:55], v[72:75], a[160:163], a[52:55]
    v_mov_b32_dpp v228, v64 row_shr:13 row_mask:0xf bank_mask:0xf
    v_mov_b32_dpp v229, v65 row_shr:13 row_mask:0xf bank_mask:0xf
    v_mfma_f32_16x16x32_bf16 a[52:55], v[76:79], a[164:167], a[52:55]
    v_mov_b32_dpp v230, v66 row_shr:13 row_mask:0xf bank_mask:0xf
    v_mfma_f32_16x16x32_bf16 a[56:59], v[76:79], a[160:163], a[56:59]
    s_mov_b32 s37, 215040
    v_mov_b32_dpp v231, v67 row_shr:13 row_mask:0xf bank_mask:0xf
    v_mfma_f32_16x16x32_bf16 a[56:59], v[80:83], a[164:167], a[56:59]
    buffer_load_dwordx4 a[236:239], v2, s[12:15], s37 offen offset:2048 sc1
    v_mfma_f32_16x16x32_bf16 a[60:63], v[80:83], a[160:163], a[60:63]
    global_load_short_d16_hi v19, v0, s[44:45] offset:0
    v_mfma_f32_16x16x32_bf16 a[60:63], v[84:87], a[164:167], a[60:63]
    ds_read_b128 v[112:115], v8 offset:46992
    v_mov_b32_dpp v228, v204 row_shl:1 row_mask:0xf bank_mask:0xf
    v_mfma_f32_16x16x32_bf16 a[64:67], v[84:87], a[160:163], a[64:67]
    v_mov_b32_dpp v229, v205 row_shl:1 row_mask:0xf bank_mask:0xf
    v_mov_b32_dpp v230, v206 row_shl:1 row_mask:0xf bank_mask:0xf
    v_mfma_f32_16x16x32_bf16 a[64:67], v[88:91], a[164:167], a[64:67]
    s_mov_b32 s28, 445440
    ds_read_b128 v[68:71], v8 offset:47136
    v_mov_b32_dpp v231, v207 row_shl:1 row_mask:0xf bank_mask:0xf
    v_mfma_f32_16x16x32_bf16 a[68:71], v[88:91], a[160:163], a[68:71]
    buffer_load_dwordx4 a[240:243], v2, s[12:15], s28 offen offset:0 sc1
    v_mfma_f32_16x16x32_bf16 a[68:71], v[92:95], a[164:167], a[68:71]
    s_waitcnt vmcnt(25)
    global_load_short_d16_hi v20, v0, s[44:45] offset:32
    v_mfma_f32_16x16x32_bf16 a[0:3], v[76:79], a[168:171], a[0:3]
    s_waitcnt vmcnt(25)
    v_mov_b32_dpp v232, v64 row_shr:12 row_mask:0xf bank_mask:0xf
    v_mov_b32_dpp v233, v65 row_shr:12 row_mask:0xf bank_mask:0xf
    v_mfma_f32_16x16x32_bf16 a[0:3], v[80:83], a[172:175], a[0:3]
    v_mov_b32_dpp v234, v66 row_shr:12 row_mask:0xf bank_mask:0xf
    v_mov_b32_dpp v235, v67 row_shr:12 row_mask:0xf bank_mask:0xf
    v_mfma_f32_16x16x32_bf16 a[4:7], v[80:83], a[168:171], a[4:7]
    s_mov_b32 s36, 473088
    v_mov_b32_dpp v232, v208 row_shl:1 row_mask:0xf bank_mask:0xf
    v_mov_b32_dpp v233, v209 row_shl:1 row_mask:0xf bank_mask:0xf
    v_mfma_f32_16x16x32_bf16 a[4:7], v[84:87], a[172:175], a[4:7]
    buffer_load_dwordx4 a[244:247], v2, s[12:15], s36 offen offset:0 sc1
    v_mfma_f32_16x16x32_bf16 a[8:11], v[84:87], a[168:171], a[8:11]
    global_load_short_d16_hi v21, v0, s[44:45] offset:64
    v_mfma_f32_16x16x32_bf16 a[8:11], v[88:91], a[172:175], a[8:11]
    v_mov_b32_dpp v234, v210 row_shl:1 row_mask:0xf bank_mask:0xf
    v_mov_b32_dpp v235, v211 row_shl:1 row_mask:0xf bank_mask:0xf
    v_mfma_f32_16x16x32_bf16 a[12:15], v[88:91], a[168:171], a[12:15]
    v_mov_b32_dpp v236, v64 row_shr:11 row_mask:0xf bank_mask:0xf
    v_mov_b32_dpp v237, v65 row_shr:11 row_mask:0xf bank_mask:0xf
    v_mfma_f32_16x16x32_bf16 a[12:15], v[92:95], a[172:175], a[12:15]
    s_mov_b32 s37, 500736
    v_mov_b32_dpp v238, v66 row_shr:11 row_mask:0xf bank_mask:0xf
    v_mfma_f32_16x16x32_bf16 a[16:19], v[92:95], a[168:171], a[16:19]
    s_waitcnt lgkmcnt(5)
    buffer_load_dwordx4 a[248:251], v2, s[12:15], s37 offen offset:0 sc1
    v_mfma_f32_16x16x32_bf16 a[16:19], v[96:99], a[172:175], a[16:19]
    v_mov_b32_dpp v239, v67 row_shr:11 row_mask:0xf bank_mask:0xf
    v_mov_b32_dpp v236, v212 row_shl:1 row_mask:0xf bank_mask:0xf
    v_mfma_f32_16x16x32_bf16 a[20:23], v[96:99], a[168:171], a[20:23]
    s_waitcnt lgkmcnt(4)
    v_mov_b32_dpp v237, v213 row_shl:1 row_mask:0xf bank_mask:0xf
    v_mfma_f32_16x16x32_bf16 a[20:23], v[100:103], a[172:175], a[20:23]
    s_waitcnt vmcnt(27) lgkmcnt(2)
    v_mov_b32_dpp v238, v214 row_shl:1 row_mask:0xf bank_mask:0xf
    v_mfma_f32_16x16x32_bf16 a[20:23], v[108:111], a[176:179], a[20:23]
    s_waitcnt vmcnt(26)
    s_mov_b32 s28, 528384
    v_mov_b32_dpp v239, v215 row_shl:1 row_mask:0xf bank_mask:0xf
    v_mfma_f32_16x16x32_bf16 a[20:23], v[104:107], a[180:183], a[20:23]
    buffer_load_dwordx4 a[252:255], v2, s[12:15], s28 offen offset:0 sc1
    v_mfma_f32_16x16x32_bf16 a[16:19], v[104:107], a[176:179], a[16:19]
    v_mov_b32_dpp v240, v64 row_shr:10 row_mask:0xf bank_mask:0xf
    v_mov_b32_dpp v241, v65 row_shr:10 row_mask:0xf bank_mask:0xf
    v_mfma_f32_16x16x32_bf16 a[16:19], v[100:103], a[180:183], a[16:19]
    v_mov_b32_dpp v242, v66 row_shr:10 row_mask:0xf bank_mask:0xf
    v_mfma_f32_16x16x32_bf16 a[12:15], v[100:103], a[176:179], a[12:15]
    v_mov_b32_dpp v243, v67 row_shr:10 row_mask:0xf bank_mask:0xf
    v_mfma_f32_16x16x32_bf16 a[12:15], v[96:99], a[180:183], a[12:15]
    s_mov_b32 s36, 556032
    v_mov_b32_dpp v240, v216 row_shl:1 row_mask:0xf bank_mask:0xf
    v_mfma_f32_16x16x32_bf16 a[8:11], v[96:99], a[176:179], a[8:11]
    buffer_load_dwordx4 a[144:147], v2, s[12:15], s36 offen offset:0 sc1
    v_mfma_f32_16x16x32_bf16 a[8:11], v[92:95], a[180:183], a[8:11]
    s_bitcmp1_b32 s30, 0
    v_mov_b32_dpp v241, v217 row_shl:1 row_mask:0xf bank_mask:0xf
    v_mov_b32_dpp v242, v218 row_shl:1 row_mask:0xf bank_mask:0xf
    v_mfma_f32_16x16x32_bf16 a[4:7], v[92:95], a[176:179], a[4:7]
    s_waitcnt lgkmcnt(0)
    s_barrier
    v_mfma_f32_16x16x32_bf16 a[4:7], v[88:91], a[180:183], a[4:7]
    s_cbranch_scc1 Lsp1
Lsp0:
    v_mov_b32_dpp v243, v219 row_shl:1 row_mask:0xf bank_mask:0xf
    v_mov_b32_dpp v244, v64 row_shr:9 row_mask:0xf bank_mask:0xf
    v_mfma_f32_16x16x32_bf16 a[0:3], v[88:91], a[176:179], a[0:3]
    s_mov_b32 s37, 583680
    v_mov_b32 v118, 0xbdd2d3e8
    v_mov_b32 v119, 0xc0135761
    v_mfma_f32_16x16x32_bf16 a[0:3], v[84:87], a[180:183], a[0:3]
    s_waitcnt vmcnt(27)
    buffer_load_dwordx4 a[148:151], v2, s[12:15], s37 offen offset:0 sc1
    v_mfma_f32_16x16x32_bf16 a[0:3], v[92:95], a[184:187], a[0:3]
    s_waitcnt vmcnt(27)
    v_mov_b32 v4, 0x39035177
    v_mov_b32 v5, 0x3727c5ac
    v_mfma_f32_16x16x32_bf16 a[0:3], v[96:99], a[188:191], a[0:3]
    v_mov_b32 v33, 0
    v_mov_b32 v34, 0
    v_mfma_f32_16x16x32_bf16 a[4:7], v[96:99], a[184:187], a[4:7]
    s_lshl_b32 s6, s31, 5
    v_mov_b32 v36, 0
    v_mov_b32 v37, 0
    v_mfma_f32_16x16x32_bf16 a[4:7], v[100:103], a[188:191], a[4:7]
    s_mov_b32 s28, 611328
    v_mov_b32 v38, 0
    v_mov_b32_dpp v245, v65 row_shr:9 row_mask:0xf bank_mask:0xf
    v_mfma_f32_16x16x32_bf16 a[8:11], v[100:103], a[184:187], a[8:11]
    buffer_load_dwordx4 a[152:155], v2, s[12:15], s28 offen offset:0 sc1
    v_mfma_f32_16x16x32_bf16 a[8:11], v[104:107], a[188:191], a[8:11]
    v_mov_b32_dpp v246, v66 row_shr:9 row_mask:0xf bank_mask:0xf
    v_mov_b32_dpp v247, v67 row_shr:9 row_mask:0xf bank_mask:0xf
    v_mfma_f32_16x16x32_bf16 a[12:15], v[104:107], a[184:187], a[12:15]
    v_mov_b32_dpp v244, v220 row_shl:1 row_mask:0xf bank_mask:0xf
    v_mov_b32_dpp v245, v221 row_shl:1 row_mask:0xf bank_mask:0xf
    v_mfma_f32_16x16x32_bf16 a[12:15], v[108:111], a[188:191], a[12:15]
    v_mov_b32_dpp v246, v222 row_shl:1 row_mask:0xf bank_mask:0xf
    v_mov_b32_dpp v247, v223 row_shl:1 row_mask:0xf bank_mask:0xf
    v_mfma_f32_16x16x32_bf16 a[16:19], v[108:111], a[184:187], a[16:19]
    s_mov_b32 s36, 638976
    v_mfma_f32_16x16x32_bf16 a[16:19], v[112:115], a[188:191], a[16:19]
    buffer_load_dwordx4 a[156:159], v2, s[12:15], s36 offen offset:0 sc1
    v_mfma_f32_16x16x32_bf16 a[20:23], v[112:115], a[184:187], a[20:23]
    v_mfma_f32_16x16x32_bf16 a[20:23], v[68:71], a[188:191], a[20:23]
    s_waitcnt vmcnt(28)
    s_movk_i32 s49, 576
    v_mfma_f32_16x16x32_bf16 a[24:27], v[76:79], a[192:195], a[24:27]
    s_waitcnt vmcnt(27)
    s_movk_i32 s47, 3168
    s_movk_i32 s48, 0
    v_mfma_f32_16x16x32_bf16 a[24:27], v[80:83], a[196:199], a[24:27]
    s_mov_b32 s37, 442368
    s_movk_i32 s39, 3168
    s_movk_i32 s46, 0
    v_mfma_f32_16x16x32_bf16 a[28:31], v[80:83], a[192:195], a[28:31]
    buffer_load_dwordx4 a[160:163], v35, s[12:15], s37 offen offset:0 sc1
    v_mfma_f32_16x16x32_bf16 a[28:31], v[84:87], a[196:199], a[28:31]
    s_mov_b32 s28, 463872
    s_movk_i32 s38, 288
    v_mov_b32 v35, 0
    v_mfma_f32_16x16x32_bf16 a[32:35], v[84:87], a[192:195], a[32:35]
    ds_write_b32 v22, a4 offset:3072
    v_mfma_f32_16x16x32_bf16 a[32:35], v[88:91], a[196:199], a[32:35]
    ds_write_b32 v22, a5 offset:3076
    v_mfma_f32_16x16x32_bf16 a[36:39], v[88:91], a[192:195], a[36:39]
    buffer_load_dwordx4 a[164:167], v2, s[12:15], s28 offen offset:0 sc1
    v_mfma_f32_16x16x32_bf16 a[36:39], v[92:95], a[196:199], a[36:39]
    ds_write_b32 v22, a6 offset:3584
    v_mfma_f32_16x16x32_bf16 a[40:43], v[92:95], a[192:195], a[40:43]
    ds_write_b32 v22, a7 offset:3588
    v_mfma_f32_16x16x32_bf16 a[40:43], v[96:99], a[196:199], a[40:43]
    ds_write_b32 v22, a8 offset:6144
    v_mfma_f32_16x16x32_bf16 a[44:47], v[96:99], a[192:195], a[44:47]
    s_mov_b32 s36, 491520
    ds_write_b32 v22, a9 offset:6148
    v_mfma_f32_16x16x32_bf16 a[44:47], v[100:103], a[196:199], a[44:47]
    s_waitcnt vmcnt(28)
    buffer_load_dwordx4 a[168:171], v2, s[12:15], s36 offen offset:0 sc1
    v_mfma_f32_16x16x32_bf16 a[44:47], v[108:111], a[200:203], a[44:47]
    s_waitcnt vmcnt(28)
    ds_write_b32 v22, a10 offset:6656
    v_mfma_f32_16x16x32_bf16 a[44:47], v[104:107], a[204:207], a[44:47]
    ds_write_b32 v22, a11 offset:6660
    v_mfma_f32_16x16x32_bf16 a[40:43], v[104:107], a[200:203], a[40:43]
    ds_write_b32 v22, a12 offset:9216
    v_mfma_f32_16x16x32_bf16 a[40:43], v[100:103], a[204:207], a[40:43]
    s_mov_b32 s37, 519168
    ds_write_b32 v22, a13 offset:9220
    v_mfma_f32_16x16x32_bf16 a[36:39], v[100:103], a[200:203], a[36:39]
    buffer_load_dwordx4 a[172:175], v2, s[12:15], s37 offen offset:0 sc1
    v_mfma_f32_16x16x32_bf16 a[36:39], v[96:99], a[204:207], a[36:39]
    ds_write_b32 v22, a14 offset:9728
    v_mfma_f32_16x16x32_bf16 a[32:35], v[96:99], a[200:203], a[32:35]
    ds_write_b32 v22, a15 offset:9732
    v_mfma_f32_16x16x32_bf16 a[32:35], v[92:95], a[204:207], a[32:35]
    ds_write_b32 v22, a16 offset:12288
    v_mfma_f32_16x16x32_bf16 a[28:31], v[92:95], a[200:203], a[28:31]
    s_mov_b32 s28, 546816
    ds_write_b32 v22, a17 offset:12292
    v_mfma_f32_16x16x32_bf16 a[28:31], v[88:91], a[204:207], a[28:31]
    buffer_load_dwordx4 a[176:179], v2, s[12:15], s28 offen offset:0 sc1
    v_mfma_f32_16x16x32_bf16 a[24:27], v[88:91], a[200:203], a[24:27]
    ds_write_b32 v22, a18 offset:12800
    v_mfma_f32_16x16x32_bf16 a[24:27], v[84:87], a[204:207], a[24:27]
    s_waitcnt vmcnt(29)
    ds_write_b32 v22, a19 offset:12804
    v_mfma_f32_16x16x32_bf16 a[24:27], v[92:95], a[208:211], a[24:27]
    s_waitcnt vmcnt(27)
    v_mfma_f32_16x16x32_bf16 a[24:27], v[96:99], a[212:215], a[24:27]
    s_mov_b32 s36, 574464
    v_mfma_f32_16x16x32_bf16 a[28:31], v[96:99], a[208:211], a[28:31]
    buffer_load_dwordx4 a[180:183], v2, s[12:15], s36 offen offset:0 sc1
    v_mfma_f32_16x16x32_bf16 a[28:31], v[100:103], a[212:215], a[28:31]
    v_mfma_f32_16x16x32_bf16 a[32:35], v[100:103], a[208:211], a[32:35]
    v_mfma_f32_16x16x32_bf16 a[32:35], v[104:107], a[212:215], a[32:35]
    v_mfma_f32_16x16x32_bf16 a[36:39], v[104:107], a[208:211], a[36:39]
    s_mov_b32 s37, 602112
    v_mfma_f32_16x16x32_bf16 a[36:39], v[108:111], a[212:215], a[36:39]
    buffer_load_dwordx4 a[184:187], v2, s[12:15], s37 offen offset:0 sc1
    v_mfma_f32_16x16x32_bf16 a[40:43], v[108:111], a[208:211], a[40:43]
    v_mfma_f32_16x16x32_bf16 a[40:43], v[112:115], a[212:215], a[40:43]
    v_mfma_f32_16x16x32_bf16 a[44:47], v[112:115], a[208:211], a[44:47]
    v_mfma_f32_16x16x32_bf16 a[44:47], v[68:71], a[212:215], a[44:47]
    s_waitcnt vmcnt(27)
    s_mov_b32 s28, 629760
    v_mfma_f32_16x16x32_bf16 a[48:51], v[76:79], a[216:219], a[48:51]
    s_waitcnt vmcnt(25)
    buffer_load_dwordx4 a[188:191], v2, s[12:15], s28 offen offset:0 sc1
    v_mfma_f32_16x16x32_bf16 a[48:51], v[80:83], a[220:223], a[48:51]
    s_mov_b32 s36, 657408
    v_mfma_f32_16x16x32_bf16 a[52:55], v[80:83], a[216:219], a[52:55]
    ds_write_b32 v22, a28 offset:22528
    v_mfma_f32_16x16x32_bf16 a[52:55], v[84:87], a[220:223], a[52:55]
    ds_write_b32 v22, a29 offset:22532
    v_mfma_f32_16x16x32_bf16 a[56:59], v[84:87], a[216:219], a[56:59]
    ds_write_b32 v22, a30 offset:23040
    v_mfma_f32_16x16x32_bf16 a[56:59], v[88:91], a[220:223], a[56:59]
    buffer_load_dwordx4 a[192:195], v2, s[12:15], s36 offen offset:0 sc1
    v_mfma_f32_16x16x32_bf16 a[60:63], v[88:91], a[216:219], a[60:63]
    ds_write_b32 v22, a31 offset:23044
    v_mfma_f32_16x16x32_bf16 a[60:63], v[92:95], a[220:223], a[60:63]
    ds_write_b32 v22, a32 offset:25600
    v_mfma_f32_16x16x32_bf16 a[64:67], v[92:95], a[216:219], a[64:67]
    ds_write_b32 v22, a33 offset:25604
    v_mfma_f32_16x16x32_bf16 a[64:67], v[96:99], a[220:223], a[64:67]
    s_mov_b32 s37, 445440
    ds_write_b32 v22, a34 offset:26112
    v_mfma_f32_16x16x32_bf16 a[68:71], v[96:99], a[216:219], a[68:71]
    buffer_load_dwordx4 a[196:199], v2, s[12:15], s37 offen offset:1024 sc1
    v_mfma_f32_16x16x32_bf16 a[68:71], v[100:103], a[220:223], a[68:71]
    s_waitcnt vmcnt(26)
    ds_write_b32 v22, a35 offset:26116
    v_mfma_f32_16x16x32_bf16 a[68:71], v[108:111], a[224:227], a[68:71]
    s_waitcnt vmcnt(24)
    ds_write_b32 v22, a36 offset:28672
    v_mfma_f32_16x16x32_bf16 a[68:71], v[104:107], a[228:231], a[68:71]
    ds_write_b32 v22, a37 offset:28676
    v_mfma_f32_16x16x32_bf16 a[64:67], v[104:107], a[224:227], a[64:67]
    s_mov_b32 s28, 473088
    ds_write_b32 v22, a38 offset:29184
    v_mfma_f32_16x16x32_bf16 a[64:67], v[100:103], a[228:231], a[64:67]
    buffer_load_dwordx4 a[200:203], v2, s[12:15], s28 offen offset:1024 sc1
    v_mfma_f32_16x16x32_bf16 a[60:63], v[100:103], a[224:227], a[60:63]
    ds_write_b32 v22, a39 offset:29188
    v_mfma_f32_16x16x32_bf16 a[60:63], v[96:99], a[228:231], a[60:63]
    ds_write_b32 v22, a40 offset:31744
    v_mfma_f32_16x16x32_bf16 a[56:59], v[96:99], a[224:227], a[56:59]
    ds_write_b32 v22, a41 offset:31748
    v_mfma_f32_16x16x32_bf16 a[56:59], v[92:95], a[228:231], a[56:59]
    s_mov_b32 s36, 500736
    ds_write_b32 v22, a42 offset:32256
    v_mfma_f32_16x16x32_bf16 a[52:55], v[92:95], a[224:227], a[52:55]
    buffer_load_dwordx4 a[204:207], v2, s[12:15], s36 offen offset:1024 sc1
    v_mfma_f32_16x16x32_bf16 a[52:55], v[88:91], a[228:231], a[52:55]
    ds_write_b32 v22, a43 offset:32260
    v_mfma_f32_16x16x32_bf16 a[48:51], v[88:91], a[224:227], a[48:51]
    v_mfma_f32_16x16x32_bf16 a[48:51], v[84:87], a[228:231], a[48:51]
    s_waitcnt vmcnt(24)
    v_mfma_f32_16x16x32_bf16 a[48:51], v[92:95], a[232:235], a[48:51]
    s_waitcnt vmcnt(23)
    s_mov_b32 s37, 528384
    v_mfma_f32_16x16x32_bf16 a[48:51], v[96:99], a[236:239], a[48:51]
    buffer_load_dwordx4 a[208:211], v2, s[12:15], s37 offen offset:1024 sc1
    v_mfma_f32_16x16x32_bf16 a[52:55], v[96:99], a[232:235], a[52:55]
    v_mfma_f32_16x16x32_bf16 a[52:55], v[100:103], a[236:239], a[52:55]
Lt2:
    s_cbranch_execz Lt3
    v_mfma_f32_16x16x32_bf16 a[56:59], v[100:103], a[232:235], a[56:59]
    s_waitcnt lgkmcnt(0)
    s_barrier
    v_mfma_f32_16x16x32_bf16 a[56:59], v[104:107], a[236:239], a[56:59]
    s_mov_b32 s28, 556032
    v_mfma_f32_16x16x32_bf16 a[60:63], v[104:107], a[232:235], a[60:63]
    buffer_load_dwordx4 a[212:215], v2, s[12:15], s28 offen offset:1024 sc1
    v_mfma_f32_16x16x32_bf16 a[60:63], v[108:111], a[236:239], a[60:63]
    v_mfma_f32_16x16x32_bf16 a[64:67], v[108:111], a[232:235], a[64:67]
    v_mfma_f32_16x16x32_bf16 a[64:67], v[112:115], a[236:239], a[64:67]
    v_mfma_f32_16x16x32_bf16 a[68:71], v[112:115], a[232:235], a[68:71]
    s_mov_b32 s36, 583680
    v_mfma_f32_16x16x32_bf16 a[68:71], v[68:71], a[236:239], a[68:71]
    s_waitcnt vmcnt(23)
    buffer_load_dwordx4 a[216:219], v2, s[12:15], s36 offen offset:1024 sc1
    v_mfma_f32_16x16x32_bf16 a[72:75], v[120:123], a[240:243], a[0:3]
    s_waitcnt vmcnt(22)
    v_mfma_f32_16x16x32_bf16 a[72:75], v[124:127], a[244:247], a[72:75]
    s_mov_b32 s37, 611328
    ds_read2st64_b64 v[104:107], v22 offset0:4 offset1:5
    v_accvgpr_read_b32 v68, a0
    v_mfma_f32_16x16x32_bf16 a[76:79], v[124:127], a[240:243], a[4:7]
    ds_write_b32 v22, a48 offset:38912
    v_mfma_f32_16x16x32_bf16 a[76:79], v[128:131], a[244:247], a[76:79]
    buffer_load_dwordx4 a[220:223], v2, s[12:15], s37 offen offset:1024 sc1
    v_mfma_f32_16x16x32_bf16 a[80:83], v[128:131], a[240:243], a[8:11]
    ds_write_b32 v22, a49 offset:38916
    v_mfma_f32_16x16x32_bf16 a[80:83], v[132:135], a[244:247], a[80:83]
    ds_write_b32 v22, a50 offset:39424
    v_mfma_f32_16x16x32_bf16 a[84:87], v[132:135], a[240:243], a[12:15]
    ds_write_b32 v22, a51 offset:39428
    v_mfma_f32_16x16x32_bf16 a[84:87], v[136:139], a[244:247], a[84:87]
    s_mov_b32 s28, 638976
    ds_write_b32 v22, a52 offset:41984
    v_mfma_f32_16x16x32_bf16 a[88:91], v[136:139], a[240:243], a[16:19]
    buffer_load_dwordx4 a[224:227], v2, s[12:15], s28 offen offset:1024 sc1
    v_mfma_f32_16x16x32_bf16 a[88:91], v[140:143], a[244:247], a[88:91]
    ds_write_b32 v22, a53 offset:41988
    v_mfma_f32_16x16x32_bf16 a[92:95], v[140:143], a[240:243], a[20:23]
    ds_write_b32 v22, a54 offset:42496
    v_mfma_f32_16x16x32_bf16 a[92:95], v[144:147], a[244:247], a[92:95]
    s_waitcnt vmcnt(21)
    ds_write_b32 v22, a55 offset:42500
    v_mfma_f32_16x16x32_bf16 a[92:95], v[152:155], a[252:255], a[92:95]
    s_mov_b32 s36, 442368
    ds_write_b32 v22, a56 offset:45056
    v_mfma_f32_16x16x32_bf16 a[92:95], v[148:151], a[248:251], a[92:95]
    buffer_load_dwordx4 a[228:231], v2, s[12:15], s36 offen offset:1024 sc1
    v_mfma_f32_16x16x32_bf16 a[88:91], v[148:151], a[252:255], a[88:91]
    ds_write_b32 v22, a57 offset:45060
    v_mfma_f32_16x16x32_bf16 a[88:91], v[144:147], a[248:251], a[88:91]
    ds_write_b32 v22, a58 offset:45568
    v_mfma_f32_16x16x32_bf16 a[84:87], v[144:147], a[252:255], a[84:87]
    ds_write_b32 v22, a59 offset:45572
    v_mfma_f32_16x16x32_bf16 a[84:87], v[140:143], a[248:251], a[84:87]
    s_mov_b32 s37, 463872
    ds_write_b32 v22, a60 offset:48128
    v_mfma_f32_16x16x32_bf16 a[80:83], v[140:143], a[252:255], a[80:83]
    buffer_load_dwordx4 a[232:235], v2, s[12:15], s37 offen offset:1024 sc1
    v_mfma_f32_16x16x32_bf16 a[80:83], v[136:139], a[248:251], a[80:83]
    ds_write_b32 v22, a61 offset:48132
    v_mfma_f32_16x16x32_bf16 a[76:79], v[136:139], a[252:255], a[76:79]
    ds_write_b32 v22, a62 offset:48640
    v_mfma_f32_16x16x32_bf16 a[76:79], v[132:135], a[248:251], a[76:79]
    ds_write_b32 v22, a63 offset:48644
    v_mfma_f32_16x16x32_bf16 a[72:75], v[132:135], a[252:255], a[72:75]
    s_mov_b32 s28, 491520
    ds_write_b32 v22, a64 offset:51200
    v_mfma_f32_16x16x32_bf16 a[72:75], v[128:131], a[248:251], a[72:75]
    s_waitcnt vmcnt(22)
    buffer_load_dwordx4 a[236:239], v2, s[12:15], s28 offen offset:1024 sc1
    v_mfma_f32_16x16x32_bf16 a[72:75], v[136:139], a[144:147], a[72:75]
    s_waitcnt vmcnt(22)
    ds_write_b32 v22, a65 offset:51204
    v_mfma_f32_16x16x32_bf16 a[72:75], v[140:143], a[148:151], a[72:75]
    ds_write_b32 v22, a66 offset:51712
    v_mfma_f32_16x16x32_bf16 a[76:79], v[140:143], a[144:147], a[76:79]
    ds_write_b32 v22, a67 offset:51716
    v_mfma_f32_16x16x32_bf16 a[76:79], v[144:147], a[148:151], a[76:79]
    s_mov_b32 s36, 519168
    v_min_u32 v47, 35, v1
    v_add_u32 v47, 0, v47
    v_mfma_f32_16x16x32_bf16 a[80:83], v[144:147], a[144:147], a[80:83]
    buffer_load_dwordx4 a[240:243], v2, s[12:15], s36 offen offset:1024 sc1
    v_mfma_f32_16x16x32_bf16 a[80:83], v[148:151], a[148:151], a[80:83]
    v_mul_u32_u24 v47, 384, v47
    v_add_u32 v47, s6, v47
    v_mfma_f32_16x16x32_bf16 a[84:87], v[148:151], a[144:147], a[84:87]
    v_accvgpr_read_b32 v69, a1
    v_accvgpr_read_b32 v70, a2
    v_mfma_f32_16x16x32_bf16 a[84:87], v[152:155], a[148:151], a[84:87]
    s_mov_b32 s37, 546816
    ds_read2st64_b64 v[108:111], v22 offset0:0 offset1:1
    v_accvgpr_read_b32 v71, a3
    v_mfma_f32_16x16x32_bf16 a[88:91], v[152:155], a[144:147], a[88:91]
    s_waitcnt lgkmcnt(1)
    s_barrier
    v_mfma_f32_16x16x32_bf16 a[88:91], v[156:159], a[148:151], a[88:91]
    buffer_load_dwordx4 a[244:247], v2, s[12:15], s37 offen offset:1024 sc1
    v_mfma_f32_16x16x32_bf16 a[92:95], v[156:159], a[144:147], a[92:95]
    ds_read2st64_b64 v[112:115], v22 offset0:2 offset1:3
    v_add_f32 v68, v68, v104
    v_mfma_f32_16x16x32_bf16 a[92:95], v[160:163], a[148:151], a[92:95]
    s_waitcnt vmcnt(22)
    ds_read2st64_b64 v[48:51], v22 offset0:35 offset1:37
    v_add_f32 v69, v69, v105
    v_mfma_f32_16x16x32_bf16 a[92:95], v[168:171], a[156:159], a[92:95]
    v_add_f32 v70, v70, v106
    v_add_f32 v71, v71, v107
    v_mfma_f32_16x16x32_bf16 a[92:95], v[164:167], a[152:155], a[92:95]
    s_mov_b32 s28, 574464
    ds_read2st64_b64 v[52:55], v22 offset0:30 offset1:31
    v_lshrrev_b32 v45, 5, v1
    v_mfma_f32_16x16x32_bf16 a[88:91], v[164:167], a[156:159], a[88:91]
    buffer_load_dwordx4 a[248:251], v2, s[12:15], s28 offen offset:1024 sc1
    v_mfma_f32_16x16x32_bf16 a[88:91], v[160:163], a[152:155], a[88:91]
    v_mul_i32_i24 v46, -512, v45
    v_add_u32 v46, 2048, v46
    v_mfma_f32_16x16x32_bf16 a[84:87], v[160:163], a[156:159], a[84:87]
    s_waitcnt lgkmcnt(2)
    v_add_f32 v108, v108, v112
    v_add_f32 v109, v109, v113
    v_mfma_f32_16x16x32_bf16 a[84:87], v[156:159], a[152:155], a[84:87]
    ds_read2st64_b64 v[56:59], v22 offset0:32 offset1:34
    v_add_f32 v110, v110, v114
    v_mfma_f32_16x16x32_bf16 a[80:83], v[156:159], a[156:159], a[80:83]
    s_mov_b32 s36, 602112
    v_add_f32 v111, v111, v115
    v_add_f32 v68, v68, v108
    v_mfma_f32_16x16x32_bf16 a[80:83], v[152:155], a[152:155], a[80:83]
    buffer_load_dwordx4 a[252:255], v2, s[12:15], s36 offen offset:1024 sc1
    v_mfma_f32_16x16x32_bf16 a[76:79], v[152:155], a[156:159], a[76:79]
    v_add_f32 v69, v69, v109
    v_add_f32 v70, v70, v110
    v_mfma_f32_16x16x32_bf16 a[76:79], v[148:151], a[152:155], a[76:79]
    v_add_f32 v71, v71, v111
    v_cndmask_b32 v69, 0, v69, s[76:77]
    v_mfma_f32_16x16x32_bf16 a[72:75], v[148:151], a[156:159], a[72:75]
    s_mov_b32 s37, 629760
    v_cndmask_b32 v70, 0, v70, s[76:77]
    v_cndmask_b32 v71, 0, v71, s[76:77]
    v_mfma_f32_16x16x32_bf16 a[72:75], v[144:147], a[152:155], a[72:75]
    s_waitcnt vmcnt(23)
    v_add_f32 v33, v33, v68
    v_fmac_f32 v36, v68, v68
    v_mfma_f32_16x16x32_bf16 a[72:75], v[172:175], a[160:163], a[72:75]
    s_waitcnt vmcnt(22)
    buffer_load_dwordx4 a[144:147], v2, s[12:15], s37 offen offset:1024 sc1
    v_mfma_f32_16x16x32_bf16 a[72:75], v[196:199], a[164:167], a[72:75]
    v_add_f32 v33, v33, v69
    v_fmac_f32 v36, v69, v69
    v_mfma_f32_16x16x32_bf16 a[76:79], v[176:179], a[160:163], a[76:79]
    v_add_f32 v33, v33, v70
    v_fmac_f32 v36, v70, v70
    v_mfma_f32_16x16x32_bf16 a[76:79], v[200:203], a[164:167], a[76:79]
    v_add_f32 v33, v33, v71
    v_fmac_f32 v36, v71, v71
    v_mfma_f32_16x16x32_bf16 a[80:83], v[180:183], a[160:163], a[80:83]
    s_mov_b32 s28, 657408
    v_accvgpr_read_b32 v72, a20
    v_accvgpr_read_b32 v73, a21
    v_mfma_f32_16x16x32_bf16 a[80:83], v[204:207], a[164:167], a[80:83]
    buffer_load_dwordx4 a[148:151], v2, s[12:15], s28 offen offset:1024 sc1
    v_mfma_f32_16x16x32_bf16 a[84:87], v[184:187], a[160:163], a[84:87]
    v_accvgpr_read_b32 v74, a22
    v_accvgpr_read_b32 v75, a23
    v_mfma_f32_16x16x32_bf16 a[84:87], v[208:211], a[164:167], a[84:87]
    s_waitcnt lgkmcnt(2)
    ds_read2st64_b64 v[104:107], v22 offset0:42 offset1:43
    v_add_f32 v72, v72, v48
    v_mfma_f32_16x16x32_bf16 a[88:91], v[188:191], a[160:163], a[88:91]
    v_add_f32 v73, v73, v49
    v_add_f32 v74, v74, v50
    v_mfma_f32_16x16x32_bf16 a[88:91], v[212:215], a[164:167], a[88:91]
    s_mov_b32 s36, 445440
    ds_read2st64_b64 v[108:111], v22 offset0:38 offset1:39
    v_add_f32 v75, v75, v51
    v_mfma_f32_16x16x32_bf16 a[92:95], v[192:195], a[160:163], a[92:95]
    buffer_load_dwordx4 a[152:155], v2, s[12:15], s36 offen offset:2048 sc1
    v_mfma_f32_16x16x32_bf16 a[92:95], v[216:219], a[164:167], a[92:95]
    s_waitcnt vmcnt(23) lgkmcnt(2)
    v_add_f32 v52, v52, v56
    v_add_f32 v53, v53, v57
    v_mfma_f32_16x16x32_bf16 a[92:95], v[224:227], a[172:175], a[92:95]
    ds_read2st64_b64 v[112:115], v22 offset0:40 offset1:41
    v_add_f32 v54, v54, v58
    v_mfma_f32_16x16x32_bf16 a[92:95], v[220:223], a[168:171], a[92:95]
    v_add_f32 v55, v55, v59
    v_add_f32 v72, v72, v52
    v_mfma_f32_16x16x32_bf16 a[88:91], v[220:223], a[172:175], a[88:91]
    s_mov_b32 s37, 473088
    v_add_f32 v73, v73, v53
    v_add_f32 v74, v74, v54
    v_mfma_f32_16x16x32_bf16 a[88:91], v[216:219], a[168:171], a[88:91]
    buffer_load_dwordx4 a[156:159], v2, s[12:15], s37 offen offset:2048 sc1
    v_mfma_f32_16x16x32_bf16 a[84:87], v[216:219], a[172:175], a[84:87]
    v_add_f32 v75, v75, v55
    v_cndmask_b32 v72, 0, v72, s[76:77]
    v_mfma_f32_16x16x32_bf16 a[84:87], v[212:215], a[168:171], a[84:87]
    v_cndmask_b32 v73, 0, v73, s[76:77]
    v_cndmask_b32 v74, 0, v74, s[76:77]
    v_mfma_f32_16x16x32_bf16 a[80:83], v[212:215], a[172:175], a[80:83]
    v_cndmask_b32 v75, 0, v75, s[78:79]
    v_add_f32 v33, v33, v72
    v_mfma_f32_16x16x32_bf16 a[80:83], v[208:211], a[168:171], a[80:83]
    s_mov_b32 s28, 500736
    v_fmac_f32 v36, v72, v72
    v_add_f32 v33, v33, v73
    v_mfma_f32_16x16x32_bf16 a[76:79], v[208:211], a[172:175], a[76:79]
    buffer_load_dwordx4 a[160:163], v2, s[12:15], s28 offen offset:2048 sc1
    v_mfma_f32_16x16x32_bf16 a[76:79], v[204:207], a[168:171], a[76:79]
    v_fmac_f32 v36, v73, v73
    v_add_f32 v33, v33, v74
    v_mfma_f32_16x16x32_bf16 a[72:75], v[204:207], a[172:175], a[72:75]
    s_mov_b32 s36, 528384
    v_fmac_f32 v36, v74, v74
    v_add_f32 v33, v33, v75
    v_mfma_f32_16x16x32_bf16 a[72:75], v[200:203], a[168:171], a[72:75]
    s_waitcnt vmcnt(24)
    v_fmac_f32 v36, v75, v75
    v_accvgpr_read_b32 v80, a24
    v_mfma_f32_16x16x32_bf16 a[76:79], v[212:215], a[176:179], a[76:79]
    s_waitcnt vmcnt(23)
    buffer_load_dwordx4 a[164:167], v2, s[12:15], s36 offen offset:2048 sc1
    v_mfma_f32_16x16x32_bf16 a[76:79], v[216:219], a[180:183], a[76:79]
    s_waitcnt vmcnt(23)
    v_accvgpr_read_b32 v81, a25
    v_accvgpr_read_b32 v82, a26
    v_mfma_f32_16x16x32_bf16 a[76:79], v[220:223], a[184:187], a[76:79]
    s_waitcnt vmcnt(22) lgkmcnt(2)
    v_accvgpr_read_b32 v83, a27
    v_add_f32 v80, v80, v104
    v_mfma_f32_16x16x32_bf16 a[76:79], v[224:227], a[188:191], a[76:79]
    s_waitcnt vmcnt(21)
    v_add_f32 v81, v81, v105
    v_add_f32 v82, v82, v106
    v_mfma_f32_16x16x32_bf16 a[76:79], v[228:231], a[192:195], a[76:79]
    s_waitcnt lgkmcnt(0)
    s_mov_b32 s37, 556032
    v_add_f32 v83, v83, v107
    v_add_f32 v108, v108, v112
    v_mfma_f32_16x16x32_bf16 a[80:83], v[232:235], a[192:195], a[80:83]
    buffer_load_dwordx4 a[168:171], v2, s[12:15], s37 offen offset:2048 sc1
    v_mfma_f32_16x16x32_bf16 a[80:83], v[228:231], a[188:191], a[80:83]
    v_add_f32 v109, v109, v113
    v_add_f32 v110, v110, v114
    v_mfma_f32_16x16x32_bf16 a[80:83], v[224:227], a[184:187], a[80:83]
    ds_write_b64 v23, a[76:77] offset:3072
    v_mfma_f32_16x16x32_bf16 a[80:83], v[220:223], a[180:183], a[80:83]
    s_mov_b32 s28, 583680
    v_add_f32 v111, v111, v115
    v_add_f32 v80, v80, v108
    v_mfma_f32_16x16x32_bf16 a[80:83], v[216:219], a[176:179], a[80:83]
    ds_write_b64 v23, a[78:79] offset:3584
    v_mfma_f32_16x16x32_bf16 a[84:87], v[220:223], a[176:179], a[84:87]
    buffer_load_dwordx4 a[172:175], v2, s[12:15], s28 offen offset:2048 sc1
    v_mfma_f32_16x16x32_bf16 a[84:87], v[224:227], a[180:183], a[84:87]
    v_add_f32 v81, v81, v109
    v_add_f32 v82, v82, v110
    v_mfma_f32_16x16x32_bf16 a[84:87], v[228:231], a[184:187], a[84:87]
    ds_write_b64 v23, a[80:81] offset:6144
    v_mfma_f32_16x16x32_bf16 a[84:87], v[232:235], a[188:191], a[84:87]
    v_add_f32 v83, v83, v111
    v_cndmask_b32 v81, 0, v81, s[76:77]
    v_mfma_f32_16x16x32_bf16 a[84:87], v[236:239], a[192:195], a[84:87]
    ds_write_b64 v23, a[82:83] offset:6656
    v_mfma_f32_16x16x32_bf16 a[88:91], v[240:243], a[192:195], a[88:91]
    v_cndmask_b32 v82, 0, v82, s[76:77]
    v_cndmask_b32 v83, 0, v83, s[76:77]
    v_mfma_f32_16x16x32_bf16 a[88:91], v[236:239], a[188:191], a[88:91]
    v_add_f32 v34, v34, v80
    v_fmac_f32 v37, v80, v80
    v_mfma_f32_16x16x32_bf16 a[88:91], v[232:235], a[184:187], a[88:91]
    ds_write_b64 v23, a[84:85] offset:9216
    v_mfma_f32_16x16x32_bf16 a[88:91], v[228:231], a[180:183], a[88:91]
    v_add_f32 v34, v34, v81
    v_fmac_f32 v37, v81, v81
    v_mfma_f32_16x16x32_bf16 a[88:91], v[224:227], a[176:179], a[88:91]
    ds_write_b64 v23, a[86:87] offset:9728
    v_mfma_f32_16x16x32_bf16 a[92:95], v[228:231], a[176:179], a[92:95]
    v_add_f32 v34, v34, v82
    v_fmac_f32 v37, v82, v82
    v_mfma_f32_16x16x32_bf16 a[92:95], v[232:235], a[180:183], a[92:95]
    v_add_f32 v34, v34, v83
    v_fmac_f32 v37, v83, v83
    v_mfma_f32_16x16x32_bf16 a[92:95], v[236:239], a[184:187], a[92:95]
    ds_write_b64 v23, a[88:89] offset:12288
    v_mfma_f32_16x16x32_bf16 a[92:95], v[240:243], a[188:191], a[92:95]
    v_add_u32 v30, v116, v46
    v_mul_i32_i24 v46, -512, v45
    v_mfma_f32_16x16x32_bf16 a[92:95], v[244:247], a[192:195], a[92:95]
    ds_write_b64 v23, a[90:91] offset:12800
    v_mfma_f32_16x16x32_bf16 a[72:75], v[224:227], a[192:195], a[72:75]
    v_add_u32 v46, 2560, v46
    v_add_u32 v32, v116, v46
    v_mfma_f32_16x16x32_bf16 a[72:75], v[220:223], a[188:191], a[72:75]
    v_mul_i32_i24 v46, -4608, v45
    v_add_u32 v46, 7168, v46
    v_mfma_f32_16x16x32_bf16 a[72:75], v[216:219], a[184:187], a[72:75]
    ds_write_b64 v23, a[92:93] offset:15360
    v_mfma_f32_16x16x32_bf16 a[72:75], v[212:215], a[180:183], a[72:75]
    s_mov_b32 s36, 611328
    v_add_u32 v44, v116, v46
    v_mfma_f32_16x16x32_bf16 a[72:75], v[208:211], a[176:179], a[72:75]
    s_waitcnt vmcnt(22)
    buffer_load_dwordx4 a[176:179], v2, s[12:15], s36 offen offset:2048 sc1
    v_mfma_f32_16x16x32_bf16 a[96:99], v[120:123], a[196:199], a[24:27]
    s_waitcnt vmcnt(22)
    s_mov_b32 s37, 638976
    ds_write_b64 v23, a[94:95] offset:15872
    v_mfma_f32_16x16x32_bf16 a[96:99], v[124:127], a[200:203], a[96:99]
    buffer_load_dwordx4 a[180:183], v2, s[12:15], s37 offen offset:2048 sc1
    v_mfma_f32_16x16x32_bf16 a[100:103], v[124:127], a[196:199], a[28:31]
    s_mov_b32 s28, 442368
    v_mfma_f32_16x16x32_bf16 a[100:103], v[128:131], a[200:203], a[100:103]
    buffer_load_dwordx4 a[184:187], v2, s[12:15], s28 offen offset:2048 sc1
    v_mfma_f32_16x16x32_bf16 a[104:107], v[128:131], a[196:199], a[32:35]
    s_mov_b32 s36, 463872
    v_mfma_f32_16x16x32_bf16 a[104:107], v[132:135], a[200:203], a[104:107]
    s_waitcnt lgkmcnt(0)
    s_barrier
    v_mfma_f32_16x16x32_bf16 a[108:111], v[132:135], a[196:199], a[36:39]
    buffer_load_dwordx4 a[188:191], v2, s[12:15], s36 offen offset:2048 sc1
    v_mfma_f32_16x16x32_bf16 a[108:111], v[136:139], a[200:203], a[108:111]
    s_mov_b32 s37, 491520
    ds_read2st64_b64 v[48:51], v23 offset0:4 offset1:5
    v_accvgpr_read_b32 v76, a72
    v_mfma_f32_16x16x32_bf16 a[112:115], v[136:139], a[196:199], a[40:43]
    buffer_load_dwordx4 a[192:195], v2, s[12:15], s37 offen offset:2048 sc1
    v_mfma_f32_16x16x32_bf16 a[112:115], v[140:143], a[200:203], a[112:115]
    s_mov_b32 s28, 519168
    v_accvgpr_read_b32 v77, a73
    v_accvgpr_read_b32 v78, a74
    v_mfma_f32_16x16x32_bf16 a[116:119], v[140:143], a[196:199], a[44:47]
    buffer_load_dwordx4 a[196:199], v2, s[12:15], s28 offen offset:2048 sc1
    v_mfma_f32_16x16x32_bf16 a[116:119], v[144:147], a[200:203], a[116:119]
    s_waitcnt vmcnt(25)
    ds_read2st64_b64 v[52:55], v23 offset0:0 offset1:1
    v_accvgpr_read_b32 v79, a75
    v_mfma_f32_16x16x32_bf16 a[116:119], v[152:155], a[208:211], a[116:119]
    v_mfma_f32_16x16x32_bf16 a[116:119], v[148:151], a[204:207], a[116:119]
    ds_read2st64_b64 v[56:59], v23 offset0:2 offset1:3
    v_mfma_f32_16x16x32_bf16 a[112:115], v[148:151], a[208:211], a[112:115]
    s_mov_b32 s36, 546816
    v_mfma_f32_16x16x32_bf16 a[112:115], v[144:147], a[204:207], a[112:115]
    buffer_load_dwordx4 a[200:203], v2, s[12:15], s36 offen offset:2048 sc1
    v_mfma_f32_16x16x32_bf16 a[108:111], v[144:147], a[208:211], a[108:111]
    s_waitcnt lgkmcnt(2)
    v_add_f32 v76, v76, v48
    v_add_f32 v77, v77, v49
    v_mfma_f32_16x16x32_bf16 a[108:111], v[140:143], a[204:207], a[108:111]
    v_add_f32 v78, v78, v50
    v_add_f32 v79, v79, v51
    v_mfma_f32_16x16x32_bf16 a[104:107], v[140:143], a[208:211], a[104:107]
    v_mfma_f32_16x16x32_bf16 a[104:107], v[136:139], a[204:207], a[104:107]
    s_waitcnt lgkmcnt(0)
    v_add_f32 v52, v52, v56
    v_add_f32 v53, v53, v57
    v_mfma_f32_16x16x32_bf16 a[100:103], v[136:139], a[208:211], a[100:103]
    v_add_f32 v54, v54, v58
    v_add_f32 v55, v55, v59
    v_mfma_f32_16x16x32_bf16 a[100:103], v[132:135], a[204:207], a[100:103]
    v_sub_f32 v76, -v76, v52
    v_sub_f32 v77, -v77, v53
    v_mfma_f32_16x16x32_bf16 a[96:99], v[132:135], a[208:211], a[96:99]
    s_mov_b32 s37, 574464
    v_sub_f32 v78, -v78, v54
    v_sub_f32 v79, -v79, v55
    v_mfma_f32_16x16x32_bf16 a[96:99], v[128:131], a[204:207], a[96:99]
    s_waitcnt vmcnt(25)
    buffer_load_dwordx4 a[204:207], v2, s[12:15], s37 offen offset:2048 sc1
    v_mfma_f32_16x16x32_bf16 a[96:99], v[136:139], a[212:215], a[96:99]
    s_waitcnt vmcnt(25)
    s_mov_b32 s28, 602112
    v_cndmask_b32 v77, 0, v77, s[76:77]
    v_cndmask_b32 v78, 0, v78, s[76:77]
    v_mfma_f32_16x16x32_bf16 a[96:99], v[140:143], a[216:219], a[96:99]
    buffer_load_dwordx4 a[208:211], v2, s[12:15], s28 offen offset:2048 sc1
    v_mfma_f32_16x16x32_bf16 a[100:103], v[140:143], a[212:215], a[100:103]
    v_cndmask_b32 v79, 0, v79, s[76:77]
    v_add_f32 v33, v33, v76
    v_mfma_f32_16x16x32_bf16 a[100:103], v[144:147], a[216:219], a[100:103]
    v_fmac_f32 v36, v76, v76
    v_add_f32 v33, v33, v77
    v_mfma_f32_16x16x32_bf16 a[104:107], v[144:147], a[212:215], a[104:107]
    v_fmac_f32 v36, v77, v77
    v_add_f32 v33, v33, v78
    v_mfma_f32_16x16x32_bf16 a[104:107], v[148:151], a[216:219], a[104:107]
    v_fmac_f32 v36, v78, v78
    v_add_f32 v33, v33, v79
    v_mfma_f32_16x16x32_bf16 a[108:111], v[148:151], a[212:215], a[108:111]
    v_fmac_f32 v36, v79, v79
    v_mfma_f32_16x16x32_bf16 a[108:111], v[152:155], a[216:219], a[108:111]
    v_mfma_f32_16x16x32_bf16 a[112:115], v[152:155], a[212:215], a[112:115]
    s_mov_b32 s36, 629760
    v_permlane32_swap_b32 v33, v36
    v_add_f32 v33, v33, v36
    v_mfma_f32_16x16x32_bf16 a[112:115], v[156:159], a[216:219], a[112:115]
    ds_write_b32 v24, v33 offset:0
    v_mfma_f32_16x16x32_bf16 a[116:119], v[156:159], a[212:215], a[116:119]
    buffer_load_dwordx4 a[212:215], v2, s[12:15], s36 offen offset:2048 sc1
    v_mfma_f32_16x16x32_bf16 a[116:119], v[160:163], a[216:219], a[116:119]
    s_waitcnt vmcnt(25)
    s_mov_b32 s37, 657408
    ds_read2st64_b64 v[104:107], v22 offset0:73 offset1:75
    v_accvgpr_read_b32 v84, a44
    v_mfma_f32_16x16x32_bf16 a[116:119], v[168:171], a[224:227], a[116:119]
    buffer_load_dwordx4 a[216:219], v2, s[12:15], s37 offen offset:2048 sc1
    v_mfma_f32_16x16x32_bf16 a[116:119], v[164:167], a[220:223], a[116:119]
    v_accvgpr_read_b32 v85, a45
    v_accvgpr_read_b32 v86, a46
    v_mfma_f32_16x16x32_bf16 a[112:115], v[164:167], a[224:227], a[112:115]
    ds_read2st64_b64 v[108:111], v22 offset0:68 offset1:69
    v_accvgpr_read_b32 v87, a47
    v_mfma_f32_16x16x32_bf16 a[112:115], v[160:163], a[220:223], a[112:115]
    v_mfma_f32_16x16x32_bf16 a[108:111], v[160:163], a[224:227], a[108:111]
    ds_read2st64_b64 v[112:115], v22 offset0:70 offset1:72
    v_mfma_f32_16x16x32_bf16 a[108:111], v[156:159], a[220:223], a[108:111]
    v_mfma_f32_16x16x32_bf16 a[104:107], v[156:159], a[224:227], a[104:107]
    buffer_load_dword v12, v47, s[16:19], 0 offen sc1
    v_mfma_f32_16x16x32_bf16 a[104:107], v[152:155], a[220:223], a[104:107]
    s_waitcnt lgkmcnt(2)
    ds_read2st64_b64 v[48:51], v22 offset0:111 offset1:113
    v_add_f32 v84, v84, v104
    v_mfma_f32_16x16x32_bf16 a[100:103], v[152:155], a[224:227], a[100:103]
    v_add_f32 v85, v85, v105
    v_add_f32 v86, v86, v106
    v_mfma_f32_16x16x32_bf16 a[100:103], v[148:151], a[220:223], a[100:103]
    ds_read2st64_b64 v[52:55], v22 offset0:106 offset1:107
    v_add_f32 v87, v87, v107
    v_mfma_f32_16x16x32_bf16 a[96:99], v[148:151], a[224:227], a[96:99]
    s_waitcnt lgkmcnt(2)
    v_add_f32 v108, v108, v112
    v_add_f32 v109, v109, v113
    v_mfma_f32_16x16x32_bf16 a[96:99], v[144:147], a[220:223], a[96:99]
    s_waitcnt vmcnt(26)
    ds_read2st64_b64 v[56:59], v22 offset0:108 offset1:110
    v_add_f32 v110, v110, v114
    v_mfma_f32_16x16x32_bf16 a[96:99], v[172:175], a[228:231], a[96:99]
    s_waitcnt vmcnt(25)
    v_add_f32 v111, v111, v115
    v_add_f32 v84, v84, v108
    v_mfma_f32_16x16x32_bf16 a[96:99], v[196:199], a[232:235], a[96:99]
    v_add_f32 v85, v85, v109
    v_add_f32 v86, v86, v110
    v_mfma_f32_16x16x32_bf16 a[100:103], v[176:179], a[228:231], a[100:103]
    v_add_f32 v87, v87, v111
    v_cndmask_b32 v84, 0, v84, s[76:77]
    v_mfma_f32_16x16x32_bf16 a[100:103], v[200:203], a[232:235], a[100:103]
    v_cndmask_b32 v85, 0, v85, s[76:77]
    v_cndmask_b32 v86, 0, v86, s[76:77]
    v_mfma_f32_16x16x32_bf16 a[104:107], v[180:183], a[228:231], a[104:107]
    v_cndmask_b32 v87, 0, v87, s[78:79]
    v_add_f32 v34, v34, v84
    v_mfma_f32_16x16x32_bf16 a[104:107], v[204:207], a[232:235], a[104:107]
    v_fmac_f32 v37, v84, v84
    v_add_f32 v34, v34, v85
    v_mfma_f32_16x16x32_bf16 a[108:111], v[184:187], a[228:231], a[108:111]
    s_barrier
    v_mfma_f32_16x16x32_bf16 a[108:111], v[208:211], a[232:235], a[108:111]
    v_fmac_f32 v37, v85, v85
    v_add_f32 v34, v34, v86
    v_mfma_f32_16x16x32_bf16 a[112:115], v[188:191], a[228:231], a[112:115]
    v_fmac_f32 v37, v86, v86
    v_add_f32 v34, v34, v87
    v_mfma_f32_16x16x32_bf16 a[112:115], v[212:215], a[232:235], a[112:115]
    v_fmac_f32 v37, v87, v87
    v_accvgpr_read_b32 v92, a68
    v_mfma_f32_16x16x32_bf16 a[116:119], v[192:195], a[228:231], a[116:119]
    v_accvgpr_read_b32 v93, a69
    v_accvgpr_read_b32 v94, a70
    v_mfma_f32_16x16x32_bf16 a[116:119], v[216:219], a[232:235], a[116:119]
    s_waitcnt vmcnt(23) lgkmcnt(2)
    v_accvgpr_read_b32 v95, a71
    v_add_f32 v92, v92, v48
    v_mfma_f32_16x16x32_bf16 a[116:119], v[224:227], a[240:243], a[116:119]
    v_add_f32 v93, v93, v49
    v_add_f32 v94, v94, v50
    v_mfma_f32_16x16x32_bf16 a[116:119], v[220:223], a[236:239], a[116:119]
    s_waitcnt lgkmcnt(0)
    v_add_f32 v95, v95, v51
    v_add_f32 v52, v52, v56
    v_mfma_f32_16x16x32_bf16 a[112:115], v[220:223], a[240:243], a[112:115]
    v_add_f32 v53, v53, v57
    v_add_f32 v54, v54, v58
    v_mfma_f32_16x16x32_bf16 a[112:115], v[216:219], a[236:239], a[112:115]
    v_add_f32 v55, v55, v59
    v_add_f32 v92, v92, v52
    v_mfma_f32_16x16x32_bf16 a[108:111], v[216:219], a[240:243], a[108:111]
    v_add_f32 v93, v93, v53
    v_add_f32 v94, v94, v54
    v_mfma_f32_16x16x32_bf16 a[108:111], v[212:215], a[236:239], a[108:111]
    v_add_f32 v95, v95, v55
    v_cndmask_b32 v92, 0, v92, s[76:77]
    v_mfma_f32_16x16x32_bf16 a[104:107], v[212:215], a[240:243], a[104:107]
    v_cndmask_b32 v93, 0, v93, s[76:77]
    v_cndmask_b32 v94, 0, v94, s[76:77]
    v_mfma_f32_16x16x32_bf16 a[104:107], v[208:211], a[236:239], a[104:107]
    v_cndmask_b32 v95, 0, v95, s[78:79]
    v_add_f32 v35, v35, v92
    v_mfma_f32_16x16x32_bf16 a[100:103], v[208:211], a[240:243], a[100:103]
    v_fmac_f32 v38, v92, v92
    v_add_f32 v35, v35, v93
    v_mfma_f32_16x16x32_bf16 a[100:103], v[204:207], a[236:239], a[100:103]
    v_fmac_f32 v38, v93, v93
    v_add_f32 v35, v35, v94
    v_mfma_f32_16x16x32_bf16 a[96:99], v[204:207], a[240:243], a[96:99]
    v_fmac_f32 v38, v94, v94
    v_add_f32 v35, v35, v95
    v_mfma_f32_16x16x32_bf16 a[96:99], v[200:203], a[236:239], a[96:99]
    s_waitcnt vmcnt(22)
    v_fmac_f32 v38, v95, v95
    v_mfma_f32_16x16x32_bf16 a[100:103], v[212:215], a[244:247], a[100:103]
    s_waitcnt vmcnt(21)
    v_mfma_f32_16x16x32_bf16 a[100:103], v[216:219], a[248:251], a[100:103]
    s_waitcnt vmcnt(20)
    v_mfma_f32_16x16x32_bf16 a[100:103], v[220:223], a[252:255], a[100:103]
    s_waitcnt vmcnt(19)
    v_mfma_f32_16x16x32_bf16 a[100:103], v[224:227], a[144:147], a[100:103]
    s_waitcnt vmcnt(18)
    v_mfma_f32_16x16x32_bf16 a[100:103], v[228:231], a[148:151], a[100:103]
    v_mfma_f32_16x16x32_bf16 a[104:107], v[232:235], a[148:151], a[104:107]
    v_mfma_f32_16x16x32_bf16 a[104:107], v[228:231], a[144:147], a[104:107]
    v_mfma_f32_16x16x32_bf16 a[104:107], v[224:227], a[252:255], a[104:107]
    ds_write_b64 v23, a[100:101] offset:21504
    v_mfma_f32_16x16x32_bf16 a[104:107], v[220:223], a[248:251], a[104:107]
    v_mfma_f32_16x16x32_bf16 a[104:107], v[216:219], a[244:247], a[104:107]
    ds_write_b64 v23, a[102:103] offset:22016
    v_mfma_f32_16x16x32_bf16 a[108:111], v[220:223], a[244:247], a[108:111]
    v_mfma_f32_16x16x32_bf16 a[108:111], v[224:227], a[248:251], a[108:111]
    v_mfma_f32_16x16x32_bf16 a[108:111], v[228:231], a[252:255], a[108:111]
    ds_write_b64 v23, a[104:105] offset:24576
    v_mfma_f32_16x16x32_bf16 a[108:111], v[232:235], a[144:147], a[108:111]
    v_mov_b32 v27, 2.0
    v_mfma_f32_16x16x32_bf16 a[108:111], v[236:239], a[148:151], a[108:111]
    ds_write_b64 v23, a[106:107] offset:25088
    v_mfma_f32_16x16x32_bf16 a[112:115], v[240:243], a[148:151], a[112:115]
    v_mfma_f32_16x16x32_bf16 a[112:115], v[236:239], a[144:147], a[112:115]
    v_mfma_f32_16x16x32_bf16 a[112:115], v[232:235], a[252:255], a[112:115]
    ds_write_b64 v23, a[108:109] offset:27648
    v_mfma_f32_16x16x32_bf16 a[112:115], v[228:231], a[248:251], a[112:115]
    v_mfma_f32_16x16x32_bf16 a[112:115], v[224:227], a[244:247], a[112:115]
    ds_write_b64 v23, a[110:111] offset:28160
    v_mfma_f32_16x16x32_bf16 a[116:119], v[228:231], a[244:247], a[116:119]
    v_mfma_f32_16x16x32_bf16 a[116:119], v[232:235], a[248:251], a[116:119]
    v_mfma_f32_16x16x32_bf16 a[116:119], v[236:239], a[252:255], a[116:119]
    ds_write_b64 v23, a[112:113] offset:30720
    v_mfma_f32_16x16x32_bf16 a[116:119], v[240:243], a[144:147], a[116:119]
    v_mfma_f32_16x16x32_bf16 a[116:119], v[244:247], a[148:151], a[116:119]
    ds_write_b64 v23, a[114:115] offset:31232
    v_mfma_f32_16x16x32_bf16 a[96:99], v[224:227], a[148:151], a[96:99]
    v_mfma_f32_16x16x32_bf16 a[96:99], v[220:223], a[144:147], a[96:99]
    v_mfma_f32_16x16x32_bf16 a[96:99], v[216:219], a[252:255], a[96:99]
    ds_write_b64 v23, a[116:117] offset:33792
    v_mfma_f32_16x16x32_bf16 a[96:99], v[212:215], a[248:251], a[96:99]
    v_mfma_f32_16x16x32_bf16 a[96:99], v[208:211], a[244:247], a[96:99]
    s_waitcnt vmcnt(17)
    ds_write_b64 v23, a[118:119] offset:34304
    v_mfma_f32_16x16x32_bf16 a[120:123], v[120:123], a[152:155], a[48:51]
    s_waitcnt vmcnt(16)
    v_mfma_f32_16x16x32_bf16 a[120:123], v[124:127], a[156:159], a[120:123]
    v_mfma_f32_16x16x32_bf16 a[128:131], v[128:131], a[152:155], a[56:59]
    v_mfma_f32_16x16x32_bf16 a[128:131], v[132:135], a[156:159], a[128:131]
    v_mfma_f32_16x16x32_bf16 a[132:135], v[132:135], a[152:155], a[60:63]
    v_mfma_f32_16x16x32_bf16 a[132:135], v[136:139], a[156:159], a[132:135]
    s_waitcnt lgkmcnt(0)
    s_barrier
    v_mfma_f32_16x16x32_bf16 a[136:139], v[136:139], a[152:155], a[64:67]
    ds_read2st64_b64 v[104:107], v23 offset0:40 offset1:41
    v_accvgpr_read_b32 v88, a96
    v_mfma_f32_16x16x32_bf16 a[136:139], v[140:143], a[156:159], a[136:139]
    v_accvgpr_read_b32 v89, a97
    v_accvgpr_read_b32 v90, a98
    v_mfma_f32_16x16x32_bf16 a[140:143], v[140:143], a[152:155], a[68:71]
    ds_read2st64_b64 v[108:111], v23 offset0:36 offset1:37
    v_accvgpr_read_b32 v91, a99
    v_mfma_f32_16x16x32_bf16 a[140:143], v[144:147], a[156:159], a[140:143]
    s_waitcnt vmcnt(14)
    v_mfma_f32_16x16x32_bf16 a[140:143], v[152:155], a[164:167], a[140:143]
    ds_read2st64_b64 v[112:115], v23 offset0:38 offset1:39
    v_mfma_f32_16x16x32_bf16 a[140:143], v[148:151], a[160:163], a[140:143]
    v_mfma_f32_16x16x32_bf16 a[136:139], v[148:151], a[164:167], a[136:139]
    v_mfma_f32_16x16x32_bf16 a[136:139], v[144:147], a[160:163], a[136:139]
    v_mfma_f32_16x16x32_bf16 a[132:135], v[144:147], a[164:167], a[132:135]
    s_waitcnt lgkmcnt(2)
    v_add_f32 v88, v88, v104
    v_add_f32 v89, v89, v105
    v_mfma_f32_16x16x32_bf16 a[132:135], v[140:143], a[160:163], a[132:135]
    v_add_f32 v90, v90, v106
    v_add_f32 v91, v91, v107
    v_mfma_f32_16x16x32_bf16 a[128:131], v[140:143], a[164:167], a[128:131]
    s_waitcnt lgkmcnt(0)
    v_add_f32 v108, v108, v112
    v_add_f32 v109, v109, v113
    v_mfma_f32_16x16x32_bf16 a[128:131], v[136:139], a[160:163], a[128:131]
    v_add_f32 v110, v110, v114
    v_add_f32 v111, v111, v115
    v_mfma_f32_16x16x32_bf16 a[120:123], v[132:135], a[164:167], a[120:123]
    v_sub_f32 v88, -v88, v108
    v_sub_f32 v89, -v89, v109
    v_mfma_f32_16x16x32_bf16 a[120:123], v[128:131], a[160:163], a[120:123]
    s_waitcnt vmcnt(13)
    v_sub_f32 v90, -v90, v110
    v_sub_f32 v91, -v91, v111
    v_mfma_f32_16x16x32_bf16 a[120:123], v[136:139], a[168:171], a[120:123]
    s_waitcnt vmcnt(12)
    v_cndmask_b32 v89, 0, v89, s[76:77]
    v_cndmask_b32 v90, 0, v90, s[76:77]
    v_mfma_f32_16x16x32_bf16 a[120:123], v[140:143], a[172:175], a[120:123]
Lt3:
    s_cbranch_execz Lpr0
    v_cndmask_b32 v91, 0, v91, s[76:77]
    v_add_f32 v34, v34, v88
    v_mfma_f32_16x16x32_bf16 a[128:131], v[144:147], a[168:171], a[128:131]
    v_fmac_f32 v37, v88, v88
    v_add_f32 v34, v34, v89
    v_mfma_f32_16x16x32_bf16 a[128:131], v[148:151], a[172:175], a[128:131]
    v_fmac_f32 v37, v89, v89
    v_add_f32 v34, v34, v90
    v_mfma_f32_16x16x32_bf16 a[132:135], v[148:151], a[168:171], a[132:135]
    v_fmac_f32 v37, v90, v90
    v_add_f32 v34, v34, v91
    v_mfma_f32_16x16x32_bf16 a[132:135], v[152:155], a[172:175], a[132:135]
    v_fmac_f32 v37, v91, v91
    v_mfma_f32_16x16x32_bf16 a[136:139], v[152:155], a[168:171], a[136:139]
    v_mfma_f32_16x16x32_bf16 a[136:139], v[156:159], a[172:175], a[136:139]
    v_permlane32_swap_b32 v34, v37
    v_add_f32 v34, v34, v37
    v_mfma_f32_16x16x32_bf16 a[140:143], v[156:159], a[168:171], a[140:143]
    buffer_load_dwordx2 v[6:7], v28, s[24:27], 0 offen offset:0 sc1
    v_mfma_f32_16x16x32_bf16 a[140:143], v[160:163], a[172:175], a[140:143]
    s_waitcnt vmcnt(11)
    ds_write_b32 v24, v34 offset:1024
    v_mfma_f32_16x16x32_bf16 a[140:143], v[168:171], a[180:183], a[140:143]
    buffer_load_dwordx2 v[8:9], v28, s[24:27], 0 offen offset:2048 sc1
    v_mfma_f32_16x16x32_bf16 a[140:143], v[164:167], a[176:179], a[140:143]
    v_mfma_f32_16x16x32_bf16 a[136:139], v[164:167], a[180:183], a[136:139]
    buffer_load_dwordx2 v[10:11], v3, s[24:27], 0 offen offset:0 sc1
    v_mfma_f32_16x16x32_bf16 a[136:139], v[160:163], a[176:179], a[136:139]
    v_mfma_f32_16x16x32_bf16 a[132:135], v[160:163], a[180:183], a[132:135]
    v_mfma_f32_16x16x32_bf16 a[132:135], v[156:159], a[176:179], a[132:135]
    v_mfma_f32_16x16x32_bf16 a[128:131], v[156:159], a[180:183], a[128:131]
    v_mfma_f32_16x16x32_bf16 a[128:131], v[152:155], a[176:179], a[128:131]
    v_mfma_f32_16x16x32_bf16 a[120:123], v[148:151], a[180:183], a[120:123]
    v_mfma_f32_16x16x32_bf16 a[120:123], v[144:147], a[176:179], a[120:123]
    s_waitcnt vmcnt(12)
    v_mfma_f32_16x16x32_bf16 a[128:131], v[180:183], a[184:187], a[128:131]
    s_waitcnt vmcnt(11)
    v_mfma_f32_16x16x32_bf16 a[128:131], v[204:207], a[188:191], a[128:131]
    s_waitcnt vmcnt(10)
    v_mfma_f32_16x16x32_bf16 a[128:131], v[208:211], a[192:195], a[128:131]
    s_waitcnt vmcnt(9)
    v_mfma_f32_16x16x32_bf16 a[128:131], v[212:215], a[196:199], a[128:131]
    s_waitcnt vmcnt(8)
    v_mfma_f32_16x16x32_bf16 a[128:131], v[216:219], a[200:203], a[128:131]
    s_waitcnt vmcnt(7)
    v_mfma_f32_16x16x32_bf16 a[128:131], v[220:223], a[204:207], a[128:131]
    s_waitcnt vmcnt(6)
    v_mfma_f32_16x16x32_bf16 a[128:131], v[224:227], a[208:211], a[128:131]
    s_waitcnt vmcnt(5)
    v_mfma_f32_16x16x32_bf16 a[128:131], v[228:231], a[212:215], a[128:131]
    s_waitcnt vmcnt(4)
    v_mfma_f32_16x16x32_bf16 a[128:131], v[232:235], a[216:219], a[128:131]
    v_mfma_f32_16x16x32_bf16 a[120:123], v[224:227], a[216:219], a[120:123]
    v_mfma_f32_16x16x32_bf16 a[120:123], v[220:223], a[212:215], a[120:123]
    v_mfma_f32_16x16x32_bf16 a[120:123], v[216:219], a[208:211], a[120:123]
    s_waitcnt lgkmcnt(0)
    s_barrier
    v_mfma_f32_16x16x32_bf16 a[120:123], v[212:215], a[204:207], a[120:123]
    ds_write_b64 v23, a[128:129] offset:43008
    v_mfma_f32_16x16x32_bf16 a[120:123], v[208:211], a[200:203], a[120:123]
    v_accvgpr_read_b32 v100, a52
    v_accvgpr_read_b32 v101, a53
    v_mfma_f32_16x16x32_bf16 a[120:123], v[204:207], a[196:199], a[120:123]
    ds_write_b64 v23, a[130:131] offset:43520
    v_mfma_f32_16x16x32_bf16 a[120:123], v[200:203], a[192:195], a[120:123]
    v_accvgpr_read_b32 v102, a54
    v_accvgpr_read_b32 v103, a55
    v_mfma_f32_16x16x32_bf16 a[120:123], v[196:199], a[188:191], a[120:123]
    v_mfma_f32_16x16x32_bf16 a[120:123], v[172:175], a[184:187], a[120:123]
    v_mfma_f32_16x16x32_bf16 a[136:139], v[188:191], a[184:187], a[136:139]
    v_mfma_f32_16x16x32_bf16 a[136:139], v[212:215], a[188:191], a[136:139]
    v_mfma_f32_16x16x32_bf16 a[136:139], v[216:219], a[192:195], a[136:139]
    v_mfma_f32_16x16x32_bf16 a[136:139], v[220:223], a[196:199], a[136:139]
    v_mfma_f32_16x16x32_bf16 a[136:139], v[224:227], a[200:203], a[136:139]
    v_mfma_f32_16x16x32_bf16 a[136:139], v[228:231], a[204:207], a[136:139]
    v_mfma_f32_16x16x32_bf16 a[136:139], v[232:235], a[208:211], a[136:139]
    v_mfma_f32_16x16x32_bf16 a[136:139], v[236:239], a[212:215], a[136:139]
    v_mfma_f32_16x16x32_bf16 a[136:139], v[240:243], a[216:219], a[136:139]
    s_waitcnt lgkmcnt(0)
    s_barrier
    v_mfma_f32_16x16x32_bf16 a[140:143], v[244:247], a[216:219], a[140:143]
    ds_read2st64_b64 v[104:107], v23 offset0:76 offset1:77
    v_accvgpr_read_b32 v96, a120
    v_mfma_f32_16x16x32_bf16 a[140:143], v[240:243], a[212:215], a[140:143]
    v_accvgpr_read_b32 v97, a121
    v_accvgpr_read_b32 v98, a122
    v_mfma_f32_16x16x32_bf16 a[140:143], v[236:239], a[208:211], a[140:143]
    ds_write_b64 v23, a[136:137] offset:49152
    v_mfma_f32_16x16x32_bf16 a[140:143], v[232:235], a[204:207], a[140:143]
    ds_read2st64_b64 v[108:111], v23 offset0:72 offset1:73
    v_accvgpr_read_b32 v99, a123
    v_mfma_f32_16x16x32_bf16 a[140:143], v[228:231], a[200:203], a[140:143]
    ds_write_b64 v23, a[138:139] offset:49664
    v_mfma_f32_16x16x32_bf16 a[140:143], v[224:227], a[196:199], a[140:143]
    ds_read2st64_b64 v[112:115], v23 offset0:74 offset1:75
    v_mfma_f32_16x16x32_bf16 a[140:143], v[220:223], a[192:195], a[140:143]
    s_waitcnt vmcnt(0)
    v_max3_u32 v39, v6, v7, v8
    v_max3_u32 v39, v39, v10, v11
    v_mfma_f32_16x16x32_bf16 a[140:143], v[216:219], a[188:191], a[140:143]
    v_max_u32 v39, v39, v9
    v_cmp_eq_u32 vcc, -1, v39
    v_mfma_f32_16x16x32_bf16 a[140:143], v[192:195], a[184:187], a[140:143]
    s_waitcnt lgkmcnt(4)
    v_add_f32 v96, v96, v104
    v_add_f32 v97, v97, v105
    v_mfma_f32_16x16x32_bf16 a[132:135], v[184:187], a[184:187], a[132:135]
    s_cbranch_vccnz Lg0_0
Lh0_0:
    v_add_f32 v6, v6, v8
    v_add_f32 v7, v7, v9
    v_mfma_f32_16x16x32_bf16 a[132:135], v[208:211], a[188:191], a[132:135]
    v_add_f32 v6, v6, v10
    v_add_f32 v7, v7, v11
    v_mfma_f32_16x16x32_bf16 a[132:135], v[212:215], a[192:195], a[132:135]
    ds_write_b64 v23, a[140:141] offset:52224
    v_mfma_f32_16x16x32_bf16 a[132:135], v[216:219], a[196:199], a[132:135]
    v_permlane32_swap_b32 v6, v7
    v_add_f32 v6, v6, v7
    v_mfma_f32_16x16x32_bf16 a[132:135], v[220:223], a[200:203], a[132:135]
    ds_write_b64 v23, a[142:143] offset:52736
    v_mfma_f32_16x16x32_bf16 a[132:135], v[224:227], a[204:207], a[132:135]
    v_mov_b32 v7, v6
    v_add_f32 v98, v98, v106
    v_mfma_f32_16x16x32_bf16 a[132:135], v[228:231], a[208:211], a[132:135]
    s_waitcnt lgkmcnt(2)
    v_add_f32 v99, v99, v107
    v_add_f32 v108, v108, v112
    v_mfma_f32_16x16x32_bf16 a[132:135], v[232:235], a[212:215], a[132:135]
    v_permlane16_swap_b32 v6, v7
    v_add_f32 v6, v6, v7
    v_mfma_f32_16x16x32_bf16 a[132:135], v[236:239], a[216:219], a[132:135]
    s_waitcnt lgkmcnt(0)
    s_barrier
    v_mfma_f32_16x16x32_bf16 v[40:43], v[124:127], a[152:155], 0
    ds_write_b32 v117, v6 offset:0
    v_mfma_f32_16x16x32_bf16 v[40:43], v[128:131], a[156:159], v[40:43]
    v_add_f32 v109, v109, v113
    v_add_f32 v110, v110, v114
    v_mfma_f32_16x16x32_bf16 v[40:43], v[132:135], a[160:163], v[40:43]
    ds_write_b64 v23, a[132:133] offset:46080
    v_mfma_f32_16x16x32_bf16 v[40:43], v[136:139], a[164:167], v[40:43]
    v_add_f32 v111, v111, v115
    v_sub_f32 v96, -v96, v108
    v_mfma_f32_16x16x32_bf16 v[40:43], v[140:143], a[168:171], v[40:43]
    ds_write_b64 v23, a[134:135] offset:46592
    v_mfma_f32_16x16x32_bf16 v[40:43], v[144:147], a[172:175], v[40:43]
    v_sub_f32 v97, -v97, v109
    v_sub_f32 v98, -v98, v110
    v_mfma_f32_16x16x32_bf16 v[40:43], v[148:151], a[176:179], v[40:43]
    v_sub_f32 v99, -v99, v111
    v_cndmask_b32 v97, 0, v97, s[76:77]
    v_mfma_f32_16x16x32_bf16 v[40:43], v[152:155], a[180:183], v[40:43]
    v_cndmask_b32 v98, 0, v98, s[76:77]
    v_cndmask_b32 v99, 0, v99, s[76:77]
    v_mfma_f32_16x16x32_bf16 v[40:43], v[176:179], a[184:187], v[40:43]
    s_waitcnt lgkmcnt(0)
    s_barrier
    v_mfma_f32_16x16x32_bf16 v[40:43], v[200:203], a[188:191], v[40:43]
    v_add_f32 v35, v35, v96
    v_fmac_f32 v38, v96, v96
    v_mfma_f32_16x16x32_bf16 v[40:43], v[204:207], a[192:195], v[40:43]
    v_add_f32 v35, v35, v97
    v_fmac_f32 v38, v97, v97
    v_mfma_f32_16x16x32_bf16 v[40:43], v[208:211], a[196:199], v[40:43]
    v_add_f32 v35, v35, v98
    v_fmac_f32 v38, v98, v98
    v_mfma_f32_16x16x32_bf16 v[40:43], v[212:215], a[200:203], v[40:43]
    v_add_f32 v35, v35, v99
    v_fmac_f32 v38, v99, v99
    v_mfma_f32_16x16x32_bf16 v[40:43], v[216:219], a[204:207], v[40:43]
    ds_read2st64_b64 v[52:55], v23 offset0:78 offset1:79
    ds_read2st64_b64 v[56:59], v23 offset0:80 offset1:81
    v_mfma_f32_16x16x32_bf16 v[40:43], v[220:223], a[208:211], v[40:43]
    ds_read2st64_b64 v[48:51], v23 offset0:82 offset1:83
    v_mfma_f32_16x16x32_bf16 v[40:43], v[224:227], a[212:215], v[40:43]
    v_mfma_f32_16x16x32_bf16 v[40:43], v[228:231], a[216:219], v[40:43]
    s_waitcnt lgkmcnt(1)
    v_add_f32 v52, v52, v56
    v_add_f32 v53, v53, v57
    v_add_f32 v54, v54, v58
    v_add_f32 v55, v55, v59
    v_add_f32 v100, v100, v52
    v_add_f32 v101, v101, v53
    v_add_f32 v102, v102, v54
    v_add_f32 v103, v103, v55
    s_waitcnt lgkmcnt(0)
    v_add_f32 v100, v100, v48
    v_add_f32 v101, v101, v49
    v_add_f32 v102, v102, v50
    v_add_f32 v103, v103, v51
    v_sub_f32 v100, -v100, v40
    v_sub_f32 v101, -v101, v41
    v_sub_f32 v102, -v102, v42
    v_sub_f32 v103, -v103, v43
    v_cndmask_b32 v101, 0, v101, s[76:77]
    v_cndmask_b32 v102, 0, v102, s[76:77]
    v_cndmask_b32 v103, 0, v103, s[76:77]
    v_add_f32 v35, v35, v100
    v_fmac_f32 v38, v100, v100
    v_add_f32 v35, v35, v101
    v_fmac_f32 v38, v101, v101
    v_add_f32 v35, v35, v102
    v_fmac_f32 v38, v102, v102
    v_add_f32 v35, v35, v103
    v_fmac_f32 v38, v103, v103
    s_nop 1
    v_permlane32_swap_b32 v35, v38
    v_add_f32 v35, v35, v38
    ds_write_b32 v24, v35 offset:2048
    buffer_load_dwordx2 v[120:121], v28, s[24:27], s74 offen offset:0 sc1
    buffer_load_dwordx2 v[122:123], v28, s[24:27], s74 offen offset:2048 sc1
    buffer_load_dwordx2 v[124:125], v3, s[24:27], s74 offen offset:0 sc1
    s_waitcnt lgkmcnt(0)
    s_barrier
    s_branch Lepi
Lg0_0:
    s_mov_b64 exec, vcc
    buffer_load_dwordx2 v[6:7], v28, s[24:27], 0 offen offset:0 sc1
    buffer_load_dwordx2 v[8:9], v28, s[24:27], 0 offen offset:2048 sc1
    buffer_load_dwordx2 v[10:11], v3, s[24:27], 0 offen offset:0 sc1
    s_mov_b64 exec, -1
    s_waitcnt vmcnt(0)
    v_max3_u32 v39, v6, v7, v8
    v_max3_u32 v39, v39, v10, v11
    v_max_u32 v39, v39, v9
    v_cmp_eq_u32 vcc, -1, v39
    s_sub_u32 s85, s85, 1
    s_cmp_lt_i32 s85, 0
    s_cbranch_scc1 Lh0_0
    s_cbranch_vccnz Lg0_0
    s_branch Lh0_0
Lq1:
    s_cbranch_execz Lt5
Lsp1:
    v_mov_b32_dpp v243, v219 row_shl:1 row_mask:0xf bank_mask:0xf
    v_mov_b32_dpp v244, v64 row_shr:9 row_mask:0xf bank_mask:0xf
    v_mfma_f32_16x16x32_bf16 a[0:3], v[88:91], a[176:179], a[0:3]
    s_mov_b32 s37, 583680
    v_mov_b32 v118, 0xbdd2d3e8
    v_mov_b32 v119, 0xc0135761
    v_mfma_f32_16x16x32_bf16 a[0:3], v[84:87], a[180:183], a[0:3]
    s_waitcnt vmcnt(27)
    buffer_load_dwordx4 a[148:151], v2, s[12:15], s37 offen offset:0 sc1
    v_mfma_f32_16x16x32_bf16 a[0:3], v[92:95], a[184:187], a[0:3]
    s_waitcnt vmcnt(27)
    v_mov_b32 v4, 0x39035177
    v_mov_b32 v5, 0x3727c5ac
    v_mfma_f32_16x16x32_bf16 a[0:3], v[96:99], a[188:191], a[0:3]
    v_mov_b32 v33, 0
    v_mov_b32 v34, 0
    v_mfma_f32_16x16x32_bf16 a[4:7], v[96:99], a[184:187], a[4:7]
    s_lshl_b32 s6, s31, 5
    v_mov_b32 v36, 0
    v_mov_b32 v37, 0
    v_mfma_f32_16x16x32_bf16 a[4:7], v[100:103], a[188:191], a[4:7]
    s_mov_b32 s28, 611328
    v_mov_b32 v38, 0
    v_mov_b32_dpp v245, v65 row_shr:9 row_mask:0xf bank_mask:0xf
    v_mfma_f32_16x16x32_bf16 a[8:11], v[100:103], a[184:187], a[8:11]
    buffer_load_dwordx4 a[152:155], v2, s[12:15], s28 offen offset:0 sc1
    v_mfma_f32_16x16x32_bf16 a[8:11], v[104:107], a[188:191], a[8:11]
    v_mov_b32_dpp v246, v66 row_shr:9 row_mask:0xf bank_mask:0xf
    v_mov_b32_dpp v247, v67 row_shr:9 row_mask:0xf bank_mask:0xf
    v_mfma_f32_16x16x32_bf16 a[12:15], v[104:107], a[184:187], a[12:15]
    v_mov_b32_dpp v244, v220 row_shl:1 row_mask:0xf bank_mask:0xf
    v_mov_b32_dpp v245, v221 row_shl:1 row_mask:0xf bank_mask:0xf
    v_mfma_f32_16x16x32_bf16 a[12:15], v[108:111], a[188:191], a[12:15]
    v_mov_b32_dpp v246, v222 row_shl:1 row_mask:0xf bank_mask:0xf
    v_mov_b32_dpp v247, v223 row_shl:1 row_mask:0xf bank_mask:0xf
    v_mfma_f32_16x16x32_bf16 a[16:19], v[108:111], a[184:187], a[16:19]
    s_mov_b32 s36, 638976
    v_mfma_f32_16x16x32_bf16 a[16:19], v[112:115], a[188:191], a[16:19]
    buffer_load_dwordx4 a[156:159], v2, s[12:15], s36 offen offset:0 sc1
    v_mfma_f32_16x16x32_bf16 a[20:23], v[112:115], a[184:187], a[20:23]
    v_mfma_f32_16x16x32_bf16 a[20:23], v[68:71], a[188:191], a[20:23]
    s_waitcnt vmcnt(28)
    s_movk_i32 s49, 1728
    v_mfma_f32_16x16x32_bf16 a[24:27], v[76:79], a[192:195], a[24:27]
    s_waitcnt vmcnt(27)
    s_movk_i32 s47, 288
    s_movk_i32 s48, 1152
    v_mfma_f32_16x16x32_bf16 a[24:27], v[80:83], a[196:199], a[24:27]
    s_mov_b32 s37, 442368
    s_movk_i32 s39, 1440
    s_movk_i32 s46, 576
    v_mfma_f32_16x16x32_bf16 a[28:31], v[80:83], a[192:195], a[28:31]
    buffer_load_dwordx4 a[160:163], v35, s[12:15], s37 offen offset:0 sc1
    v_mfma_f32_16x16x32_bf16 a[28:31], v[84:87], a[196:199], a[28:31]
    s_mov_b32 s28, 463872
    s_movk_i32 s38, 864
    v_mov_b32 v35, 0
    v_mfma_f32_16x16x32_bf16 a[32:35], v[84:87], a[192:195], a[32:35]
    ds_write_b32 v22, a0 offset:0
    v_mfma_f32_16x16x32_bf16 a[32:35], v[88:91], a[196:199], a[32:35]
    ds_write_b32 v22, a1 offset:4
    v_mfma_f32_16x16x32_bf16 a[36:39], v[88:91], a[192:195], a[36:39]
    buffer_load_dwordx4 a[164:167], v2, s[12:15], s28 offen offset:0 sc1
    v_mfma_f32_16x16x32_bf16 a[36:39], v[92:95], a[196:199], a[36:39]
    ds_write_b32 v22, a2 offset:512
    v_mfma_f32_16x16x32_bf16 a[40:43], v[92:95], a[192:195], a[40:43]
    ds_write_b32 v22, a3 offset:516
    v_mfma_f32_16x16x32_bf16 a[40:43], v[96:99], a[196:199], a[40:43]
    ds_write_b32 v22, a12 offset:10240
    v_mfma_f32_16x16x32_bf16 a[44:47], v[96:99], a[192:195], a[44:47]
    s_mov_b32 s36, 491520
    ds_write_b32 v22, a13 offset:10244
    v_mfma_f32_16x16x32_bf16 a[44:47], v[100:103], a[196:199], a[44:47]
    s_waitcnt vmcnt(28)
    buffer_load_dwordx4 a[168:171], v2, s[12:15], s36 offen offset:0 sc1
    v_mfma_f32_16x16x32_bf16 a[44:47], v[108:111], a[200:203], a[44:47]
    s_waitcnt vmcnt(28)
    ds_write_b32 v22, a14 offset:10752
    v_mfma_f32_16x16x32_bf16 a[44:47], v[104:107], a[204:207], a[44:47]
    ds_write_b32 v22, a15 offset:10756
    v_mfma_f32_16x16x32_bf16 a[40:43], v[104:107], a[200:203], a[40:43]
    ds_write_b32 v22, a16 offset:13312
    v_mfma_f32_16x16x32_bf16 a[40:43], v[100:103], a[204:207], a[40:43]
    s_mov_b32 s37, 519168
    ds_write_b32 v22, a17 offset:13316
    v_mfma_f32_16x16x32_bf16 a[36:39], v[100:103], a[200:203], a[36:39]
    buffer_load_dwordx4 a[172:175], v2, s[12:15], s37 offen offset:0 sc1
    v_mfma_f32_16x16x32_bf16 a[36:39], v[96:99], a[204:207], a[36:39]
    ds_write_b32 v22, a18 offset:13824
    v_mfma_f32_16x16x32_bf16 a[32:35], v[96:99], a[200:203], a[32:35]
    ds_write_b32 v22, a19 offset:13828
    v_mfma_f32_16x16x32_bf16 a[32:35], v[92:95], a[204:207], a[32:35]
    ds_write_b32 v22, a20 offset:15360
    v_mfma_f32_16x16x32_bf16 a[28:31], v[92:95], a[200:203], a[28:31]
    s_mov_b32 s28, 546816
    ds_write_b32 v22, a21 offset:15364
    v_mfma_f32_16x16x32_bf16 a[28:31], v[88:91], a[204:207], a[28:31]
    buffer_load_dwordx4 a[176:179], v2, s[12:15], s28 offen offset:0 sc1
    v_mfma_f32_16x16x32_bf16 a[24:27], v[88:91], a[200:203], a[24:27]
    ds_write_b32 v22, a22 offset:15872
    v_mfma_f32_16x16x32_bf16 a[24:27], v[84:87], a[204:207], a[24:27]
    s_waitcnt vmcnt(29)
    ds_write_b32 v22, a23 offset:15876
    v_mfma_f32_16x16x32_bf16 a[24:27], v[92:95], a[208:211], a[24:27]
    s_waitcnt vmcnt(27)
    v_mfma_f32_16x16x32_bf16 a[24:27], v[96:99], a[212:215], a[24:27]
    s_mov_b32 s36, 574464
    v_mfma_f32_16x16x32_bf16 a[28:31], v[96:99], a[208:211], a[28:31]
    buffer_load_dwordx4 a[180:183], v2, s[12:15], s36 offen offset:0 sc1
    v_mfma_f32_16x16x32_bf16 a[28:31], v[100:103], a[212:215], a[28:31]
    v_mfma_f32_16x16x32_bf16 a[32:35], v[100:103], a[208:211], a[32:35]
    v_mfma_f32_16x16x32_bf16 a[32:35], v[104:107], a[212:215], a[32:35]
    v_mfma_f32_16x16x32_bf16 a[36:39], v[104:107], a[208:211], a[36:39]
    s_mov_b32 s37, 602112
    v_mfma_f32_16x16x32_bf16 a[36:39], v[108:111], a[212:215], a[36:39]
    buffer_load_dwordx4 a[184:187], v2, s[12:15], s37 offen offset:0 sc1
    v_mfma_f32_16x16x32_bf16 a[40:43], v[108:111], a[208:211], a[40:43]
    v_mfma_f32_16x16x32_bf16 a[40:43], v[112:115], a[212:215], a[40:43]
    v_mfma_f32_16x16x32_bf16 a[44:47], v[112:115], a[208:211], a[44:47]
    v_mfma_f32_16x16x32_bf16 a[44:47], v[68:71], a[212:215], a[44:47]
    s_waitcnt vmcnt(27)
    s_mov_b32 s28, 629760
    v_mfma_f32_16x16x32_bf16 a[48:51], v[76:79], a[216:219], a[48:51]
    s_waitcnt vmcnt(25)
    buffer_load_dwordx4 a[188:191], v2, s[12:15], s28 offen offset:0 sc1
    v_mfma_f32_16x16x32_bf16 a[48:51], v[80:83], a[220:223], a[48:51]
    s_mov_b32 s36, 657408
    v_mfma_f32_16x16x32_bf16 a[52:55], v[80:83], a[216:219], a[52:55]
    ds_write_b32 v22, a24 offset:19456
    v_mfma_f32_16x16x32_bf16 a[52:55], v[84:87], a[220:223], a[52:55]
    ds_write_b32 v22, a25 offset:19460
    v_mfma_f32_16x16x32_bf16 a[56:59], v[84:87], a[216:219], a[56:59]
    ds_write_b32 v22, a26 offset:19968
    v_mfma_f32_16x16x32_bf16 a[56:59], v[88:91], a[220:223], a[56:59]
    buffer_load_dwordx4 a[192:195], v2, s[12:15], s36 offen offset:0 sc1
    v_mfma_f32_16x16x32_bf16 a[60:63], v[88:91], a[216:219], a[60:63]
    ds_write_b32 v22, a27 offset:19972
    v_mfma_f32_16x16x32_bf16 a[60:63], v[92:95], a[220:223], a[60:63]
    ds_write_b32 v22, a36 offset:29696
    v_mfma_f32_16x16x32_bf16 a[64:67], v[92:95], a[216:219], a[64:67]
    ds_write_b32 v22, a37 offset:29700
    v_mfma_f32_16x16x32_bf16 a[64:67], v[96:99], a[220:223], a[64:67]
    s_mov_b32 s37, 445440
    ds_write_b32 v22, a38 offset:30208
    v_mfma_f32_16x16x32_bf16 a[68:71], v[96:99], a[216:219], a[68:71]
    buffer_load_dwordx4 a[196:199], v2, s[12:15], s37 offen offset:1024 sc1
    v_mfma_f32_16x16x32_bf16 a[68:71], v[100:103], a[220:223], a[68:71]
    s_waitcnt vmcnt(26)
    ds_write_b32 v22, a39 offset:30212
    v_mfma_f32_16x16x32_bf16 a[68:71], v[108:111], a[224:227], a[68:71]
    s_waitcnt vmcnt(24)
    ds_write_b32 v22, a40 offset:32768
    v_mfma_f32_16x16x32_bf16 a[68:71], v[104:107], a[228:231], a[68:71]
    ds_write_b32 v22, a41 offset:32772
    v_mfma_f32_16x16x32_bf16 a[64:67], v[104:107], a[224:227], a[64:67]
    s_mov_b32 s28, 473088
    ds_write_b32 v22, a42 offset:33280
    v_mfma_f32_16x16x32_bf16 a[64:67], v[100:103], a[228:231], a[64:67]
    buffer_load_dwordx4 a[200:203], v2, s[12:15], s28 offen offset:1024 sc1
    v_mfma_f32_16x16x32_bf16 a[60:63], v[100:103], a[224:227], a[60:63]
    ds_write_b32 v22, a43 offset:33284
    v_mfma_f32_16x16x32_bf16 a[60:63], v[96:99], a[228:231], a[60:63]
    ds_write_b32 v22, a44 offset:34816
    v_mfma_f32_16x16x32_bf16 a[56:59], v[96:99], a[224:227], a[56:59]
    ds_write_b32 v22, a45 offset:34820
    v_mfma_f32_16x16x32_bf16 a[56:59], v[92:95], a[228:231], a[56:59]
    s_mov_b32 s36, 500736
    ds_write_b32 v22, a46 offset:35328
    v_mfma_f32_16x16x32_bf16 a[52:55], v[92:95], a[224:227], a[52:55]
    buffer_load_dwordx4 a[204:207], v2, s[12:15], s36 offen offset:1024 sc1
    v_mfma_f32_16x16x32_bf16 a[52:55], v[88:91], a[228:231], a[52:55]
    ds_write_b32 v22, a47 offset:35332
    v_mfma_f32_16x16x32_bf16 a[48:51], v[88:91], a[224:227], a[48:51]
    v_mfma_f32_16x16x32_bf16 a[48:51], v[84:87], a[228:231], a[48:51]
    s_waitcnt vmcnt(24)
    v_mfma_f32_16x16x32_bf16 a[48:51], v[92:95], a[232:235], a[48:51]
    s_waitcnt vmcnt(23)
    s_mov_b32 s37, 528384
    v_mfma_f32_16x16x32_bf16 a[48:51], v[96:99], a[236:239], a[48:51]
    buffer_load_dwordx4 a[208:211], v2, s[12:15], s37 offen offset:1024 sc1
    v_mfma_f32_16x16x32_bf16 a[52:55], v[96:99], a[232:235], a[52:55]
    v_mfma_f32_16x16x32_bf16 a[52:55], v[100:103], a[236:239], a[52:55]
    v_mfma_f32_16x16x32_bf16 a[56:59], v[100:103], a[232:235], a[56:59]
    s_waitcnt lgkmcnt(0)
    s_barrier
    v_mfma_f32_16x16x32_bf16 a[56:59], v[104:107], a[236:239], a[56:59]
    s_mov_b32 s28, 556032
    v_mfma_f32_16x16x32_bf16 a[60:63], v[104:107], a[232:235], a[60:63]
    buffer_load_dwordx4 a[212:215], v2, s[12:15], s28 offen offset:1024 sc1
    v_mfma_f32_16x16x32_bf16 a[60:63], v[108:111], a[236:239], a[60:63]
    v_mfma_f32_16x16x32_bf16 a[64:67], v[108:111], a[232:235], a[64:67]
    v_mfma_f32_16x16x32_bf16 a[64:67], v[112:115], a[236:239], a[64:67]
    v_mfma_f32_16x16x32_bf16 a[68:71], v[112:115], a[232:235], a[68:71]
    s_mov_b32 s36, 583680
    v_mfma_f32_16x16x32_bf16 a[68:71], v[68:71], a[236:239], a[68:71]
    s_waitcnt vmcnt(23)
    buffer_load_dwordx4 a[216:219], v2, s[12:15], s36 offen offset:1024 sc1
    v_mfma_f32_16x16x32_bf16 a[72:75], v[120:123], a[240:243], a[0:3]
    s_waitcnt vmcnt(22)
    v_mfma_f32_16x16x32_bf16 a[72:75], v[124:127], a[244:247], a[72:75]
    s_mov_b32 s37, 611328
    ds_read2st64_b64 v[104:107], v22 offset0:6 offset1:7
    v_accvgpr_read_b32 v68, a4
    v_mfma_f32_16x16x32_bf16 a[76:79], v[124:127], a[240:243], a[4:7]
    ds_write_b32 v22, a52 offset:43008
    v_mfma_f32_16x16x32_bf16 a[76:79], v[128:131], a[244:247], a[76:79]
    buffer_load_dwordx4 a[220:223], v2, s[12:15], s37 offen offset:1024 sc1
    v_mfma_f32_16x16x32_bf16 a[80:83], v[128:131], a[240:243], a[8:11]
    ds_write_b32 v22, a53 offset:43012
    v_mfma_f32_16x16x32_bf16 a[80:83], v[132:135], a[244:247], a[80:83]
    ds_write_b32 v22, a54 offset:43520
    v_mfma_f32_16x16x32_bf16 a[84:87], v[132:135], a[240:243], a[12:15]
    ds_write_b32 v22, a55 offset:43524
    v_mfma_f32_16x16x32_bf16 a[84:87], v[136:139], a[244:247], a[84:87]
    s_mov_b32 s28, 638976
    ds_write_b32 v22, a56 offset:46080
    v_mfma_f32_16x16x32_bf16 a[88:91], v[136:139], a[240:243], a[16:19]
    buffer_load_dwordx4 a[224:227], v2, s[12:15], s28 offen offset:1024 sc1
    v_mfma_f32_16x16x32_bf16 a[88:91], v[140:143], a[244:247], a[88:91]
    ds_write_b32 v22, a57 offset:46084
    v_mfma_f32_16x16x32_bf16 a[92:95], v[140:143], a[240:243], a[20:23]
    ds_write_b32 v22, a58 offset:46592
    v_mfma_f32_16x16x32_bf16 a[92:95], v[144:147], a[244:247], a[92:95]
    s_waitcnt vmcnt(21)
    ds_write_b32 v22, a59 offset:46596
    v_mfma_f32_16x16x32_bf16 a[92:95], v[152:155], a[252:255], a[92:95]
    s_mov_b32 s36, 549888
    ds_write_b32 v22, a60 offset:49152
    v_mfma_f32_16x16x32_bf16 a[92:95], v[148:151], a[248:251], a[92:95]
    buffer_load_dwordx4 a[228:231], v2, s[12:15], s36 offen offset:1024 sc1
    v_mfma_f32_16x16x32_bf16 a[88:91], v[148:151], a[252:255], a[88:91]
    ds_write_b32 v22, a61 offset:49156
    v_mfma_f32_16x16x32_bf16 a[88:91], v[144:147], a[248:251], a[88:91]
    ds_write_b32 v22, a62 offset:49664
    v_mfma_f32_16x16x32_bf16 a[84:87], v[144:147], a[252:255], a[84:87]
    ds_write_b32 v22, a63 offset:49668
    v_mfma_f32_16x16x32_bf16 a[84:87], v[140:143], a[248:251], a[84:87]
    s_mov_b32 s37, 463872
    ds_write_b32 v22, a64 offset:52224
    v_mfma_f32_16x16x32_bf16 a[80:83], v[140:143], a[252:255], a[80:83]
    buffer_load_dwordx4 a[232:235], v2, s[12:15], s37 offen offset:1024 sc1
    v_mfma_f32_16x16x32_bf16 a[80:83], v[136:139], a[248:251], a[80:83]
    ds_write_b32 v22, a65 offset:52228
    v_mfma_f32_16x16x32_bf16 a[76:79], v[136:139], a[252:255], a[76:79]
    ds_write_b32 v22, a66 offset:52736
    v_mfma_f32_16x16x32_bf16 a[76:79], v[132:135], a[248:251], a[76:79]
    ds_write_b32 v22, a67 offset:52740
    v_mfma_f32_16x16x32_bf16 a[72:75], v[132:135], a[252:255], a[72:75]
    s_mov_b32 s28, 491520
    ds_write_b32 v22, a68 offset:54272
    v_mfma_f32_16x16x32_bf16 a[72:75], v[128:131], a[248:251], a[72:75]
    s_waitcnt vmcnt(22)
    buffer_load_dwordx4 a[236:239], v2, s[12:15], s28 offen offset:1024 sc1
    v_mfma_f32_16x16x32_bf16 a[72:75], v[136:139], a[144:147], a[72:75]
    s_waitcnt vmcnt(22)
    ds_write_b32 v22, a69 offset:54276
    v_mfma_f32_16x16x32_bf16 a[72:75], v[140:143], a[148:151], a[72:75]
    ds_write_b32 v22, a70 offset:54784
    v_mfma_f32_16x16x32_bf16 a[76:79], v[140:143], a[144:147], a[76:79]
    ds_write_b32 v22, a71 offset:54788
    v_mfma_f32_16x16x32_bf16 a[76:79], v[144:147], a[148:151], a[76:79]
    s_mov_b32 s36, 519168
    v_min_u32 v47, 35, v1
    v_add_u32 v47, 36, v47
    v_mfma_f32_16x16x32_bf16 a[80:83], v[144:147], a[144:147], a[80:83]
    buffer_load_dwordx4 a[240:243], v2, s[12:15], s36 offen offset:1024 sc1
    v_mfma_f32_16x16x32_bf16 a[80:83], v[148:151], a[148:151], a[80:83]
    v_mul_u32_u24 v47, 384, v47
    v_add_u32 v47, s6, v47
    v_mfma_f32_16x16x32_bf16 a[84:87], v[148:151], a[144:147], a[84:87]
    v_accvgpr_read_b32 v69, a5
    v_accvgpr_read_b32 v70, a6
    v_mfma_f32_16x16x32_bf16 a[84:87], v[152:155], a[148:151], a[84:87]
    s_mov_b32 s37, 546816
    ds_read2st64_b64 v[108:111], v22 offset0:8 offset1:9
    v_accvgpr_read_b32 v71, a7
    v_mfma_f32_16x16x32_bf16 a[88:91], v[152:155], a[144:147], a[88:91]
    s_waitcnt lgkmcnt(1)
    s_barrier
    v_mfma_f32_16x16x32_bf16 a[88:91], v[156:159], a[148:151], a[88:91]
    buffer_load_dwordx4 a[244:247], v2, s[12:15], s37 offen offset:1024 sc1
    v_mfma_f32_16x16x32_bf16 a[92:95], v[156:159], a[144:147], a[92:95]
    ds_read2st64_b64 v[112:115], v22 offset0:10 offset1:11
    v_add_f32 v68, v68, v104
    v_mfma_f32_16x16x32_bf16 a[92:95], v[160:163], a[148:151], a[92:95]
    s_waitcnt vmcnt(22)
    ds_read2st64_b64 v[48:51], v22 offset0:12 offset1:13
    v_add_f32 v69, v69, v105
    v_mfma_f32_16x16x32_bf16 a[92:95], v[168:171], a[156:159], a[92:95]
    v_add_f32 v70, v70, v106
    v_add_f32 v71, v71, v107
    v_mfma_f32_16x16x32_bf16 a[92:95], v[164:167], a[152:155], a[92:95]
    s_mov_b32 s28, 574464
    ds_read2st64_b64 v[52:55], v22 offset0:14 offset1:15
    v_lshrrev_b32 v45, 5, v1
    v_mfma_f32_16x16x32_bf16 a[88:91], v[164:167], a[156:159], a[88:91]
    buffer_load_dwordx4 a[248:251], v2, s[12:15], s28 offen offset:1024 sc1
    v_mfma_f32_16x16x32_bf16 a[88:91], v[160:163], a[152:155], a[88:91]
    v_mul_i32_i24 v46, 4608, v45
    v_add_u32 v46, -3072, v46
    v_mfma_f32_16x16x32_bf16 a[84:87], v[160:163], a[156:159], a[84:87]
    s_waitcnt lgkmcnt(2)
    v_add_f32 v108, v108, v112
    v_add_f32 v109, v109, v113
    v_mfma_f32_16x16x32_bf16 a[84:87], v[156:159], a[152:155], a[84:87]
    ds_read2st64_b64 v[56:59], v22 offset0:16 offset1:17
    v_add_f32 v110, v110, v114
    v_mfma_f32_16x16x32_bf16 a[80:83], v[156:159], a[156:159], a[80:83]
    s_mov_b32 s36, 602112
    v_add_f32 v111, v111, v115
    v_add_f32 v68, v68, v108
    v_mfma_f32_16x16x32_bf16 a[80:83], v[152:155], a[152:155], a[80:83]
    buffer_load_dwordx4 a[252:255], v2, s[12:15], s36 offen offset:1024 sc1
    v_mfma_f32_16x16x32_bf16 a[76:79], v[152:155], a[156:159], a[76:79]
    v_add_f32 v69, v69, v109
    v_add_f32 v70, v70, v110
    v_mfma_f32_16x16x32_bf16 a[76:79], v[148:151], a[152:155], a[76:79]
    v_add_f32 v71, v71, v111
    v_cndmask_b32 v69, 0, v69, s[76:77]
    v_mfma_f32_16x16x32_bf16 a[72:75], v[148:151], a[156:159], a[72:75]
    s_mov_b32 s37, 629760
    v_cndmask_b32 v70, 0, v70, s[76:77]
    v_cndmask_b32 v71, 0, v71, s[76:77]
    v_mfma_f32_16x16x32_bf16 a[72:75], v[144:147], a[152:155], a[72:75]
    s_waitcnt vmcnt(23)
    v_add_f32 v33, v33, v68
    v_fmac_f32 v36, v68, v68
    v_mfma_f32_16x16x32_bf16 a[72:75], v[172:175], a[160:163], a[72:75]
    s_waitcnt vmcnt(22)
    buffer_load_dwordx4 a[144:147], v2, s[12:15], s37 offen offset:1024 sc1
    v_mfma_f32_16x16x32_bf16 a[72:75], v[196:199], a[164:167], a[72:75]
    v_add_f32 v33, v33, v69
    v_fmac_f32 v36, v69, v69
    v_mfma_f32_16x16x32_bf16 a[76:79], v[176:179], a[160:163], a[76:79]
    v_add_f32 v33, v33, v70
    v_fmac_f32 v36, v70, v70
    v_mfma_f32_16x16x32_bf16 a[76:79], v[200:203], a[164:167], a[76:79]
    v_add_f32 v33, v33, v71
    v_fmac_f32 v36, v71, v71
    v_mfma_f32_16x16x32_bf16 a[80:83], v[180:183], a[160:163], a[80:83]
    s_mov_b32 s28, 657408
    v_accvgpr_read_b32 v72, a8
    v_accvgpr_read_b32 v73, a9
    v_mfma_f32_16x16x32_bf16 a[80:83], v[204:207], a[164:167], a[80:83]
    buffer_load_dwordx4 a[148:151], v2, s[12:15], s28 offen offset:1024 sc1
    v_mfma_f32_16x16x32_bf16 a[84:87], v[184:187], a[160:163], a[84:87]
    v_accvgpr_read_b32 v74, a10
    v_accvgpr_read_b32 v75, a11
    v_mfma_f32_16x16x32_bf16 a[84:87], v[208:211], a[164:167], a[84:87]
    s_waitcnt lgkmcnt(2)
    ds_read2st64_b64 v[104:107], v22 offset0:44 offset1:45
    v_add_f32 v72, v72, v48
    v_mfma_f32_16x16x32_bf16 a[88:91], v[188:191], a[160:163], a[88:91]
    v_add_f32 v73, v73, v49
    v_add_f32 v74, v74, v50
    v_mfma_f32_16x16x32_bf16 a[88:91], v[212:215], a[164:167], a[88:91]
    s_mov_b32 s36, 445440
    ds_read2st64_b64 v[108:111], v22 offset0:46 offset1:47
    v_add_f32 v75, v75, v51
    v_mfma_f32_16x16x32_bf16 a[92:95], v[192:195], a[160:163], a[92:95]
    buffer_load_dwordx4 a[152:155], v2, s[12:15], s36 offen offset:2048 sc1
    v_mfma_f32_16x16x32_bf16 a[92:95], v[216:219], a[164:167], a[92:95]
    s_waitcnt vmcnt(23) lgkmcnt(2)
    v_add_f32 v52, v52, v56
    v_add_f32 v53, v53, v57
    v_mfma_f32_16x16x32_bf16 a[92:95], v[224:227], a[172:175], a[92:95]
Lt5:
    s_cbranch_execz Lt6
    ds_read2st64_b64 v[112:115], v22 offset0:48 offset1:49
    v_add_f32 v54, v54, v58
    v_mfma_f32_16x16x32_bf16 a[92:95], v[220:223], a[168:171], a[92:95]
    v_add_f32 v55, v55, v59
    v_add_f32 v72, v72, v52
    v_mfma_f32_16x16x32_bf16 a[88:91], v[220:223], a[172:175], a[88:91]
    s_mov_b32 s37, 473088
    v_add_f32 v73, v73, v53
    v_add_f32 v74, v74, v54
    v_mfma_f32_16x16x32_bf16 a[88:91], v[216:219], a[168:171], a[88:91]
    buffer_load_dwordx4 a[156:159], v2, s[12:15], s37 offen offset:2048 sc1
    v_mfma_f32_16x16x32_bf16 a[84:87], v[216:219], a[172:175], a[84:87]
    v_add_f32 v75, v75, v55
    v_cndmask_b32 v73, 0, v73, s[76:77]
    v_mfma_f32_16x16x32_bf16 a[84:87], v[212:215], a[168:171], a[84:87]
    v_cndmask_b32 v74, 0, v74, s[76:77]
    v_cndmask_b32 v75, 0, v75, s[76:77]
    v_mfma_f32_16x16x32_bf16 a[80:83], v[212:215], a[172:175], a[80:83]
    v_add_f32 v33, v33, v72
    v_fmac_f32 v36, v72, v72
    v_mfma_f32_16x16x32_bf16 a[80:83], v[208:211], a[168:171], a[80:83]
    s_mov_b32 s28, 500736
    v_add_f32 v33, v33, v73
    v_fmac_f32 v36, v73, v73
    v_mfma_f32_16x16x32_bf16 a[76:79], v[208:211], a[172:175], a[76:79]
    buffer_load_dwordx4 a[160:163], v2, s[12:15], s28 offen offset:2048 sc1
    v_mfma_f32_16x16x32_bf16 a[76:79], v[204:207], a[168:171], a[76:79]
    v_add_f32 v33, v33, v74
    v_fmac_f32 v36, v74, v74
    v_mfma_f32_16x16x32_bf16 a[72:75], v[204:207], a[172:175], a[72:75]
    s_mov_b32 s36, 528384
    v_add_f32 v33, v33, v75
    v_fmac_f32 v36, v75, v75
    v_mfma_f32_16x16x32_bf16 a[72:75], v[200:203], a[168:171], a[72:75]
    s_waitcnt vmcnt(24)
    v_accvgpr_read_b32 v80, a28
    v_accvgpr_read_b32 v81, a29
    v_mfma_f32_16x16x32_bf16 a[72:75], v[208:211], a[176:179], a[72:75]
    s_waitcnt vmcnt(23)
    buffer_load_dwordx4 a[164:167], v2, s[12:15], s36 offen offset:2048 sc1
    v_mfma_f32_16x16x32_bf16 a[72:75], v[212:215], a[180:183], a[72:75]
    s_waitcnt vmcnt(23)
    v_accvgpr_read_b32 v82, a30
    v_accvgpr_read_b32 v83, a31
    v_mfma_f32_16x16x32_bf16 a[72:75], v[216:219], a[184:187], a[72:75]
    s_waitcnt vmcnt(22) lgkmcnt(2)
    v_add_f32 v80, v80, v104
    v_add_f32 v81, v81, v105
    v_mfma_f32_16x16x32_bf16 a[72:75], v[220:223], a[188:191], a[72:75]
    s_waitcnt vmcnt(21)
    v_add_f32 v82, v82, v106
    v_add_f32 v83, v83, v107
    v_mfma_f32_16x16x32_bf16 a[72:75], v[224:227], a[192:195], a[72:75]
    s_waitcnt lgkmcnt(0)
    s_mov_b32 s37, 556032
    v_add_f32 v108, v108, v112
    v_add_f32 v109, v109, v113
    v_mfma_f32_16x16x32_bf16 a[80:83], v[232:235], a[192:195], a[80:83]
    buffer_load_dwordx4 a[168:171], v2, s[12:15], s37 offen offset:2048 sc1
    v_mfma_f32_16x16x32_bf16 a[80:83], v[228:231], a[188:191], a[80:83]
    v_add_f32 v110, v110, v114
    v_add_f32 v111, v111, v115
    v_mfma_f32_16x16x32_bf16 a[80:83], v[224:227], a[184:187], a[80:83]
    ds_write_b64 v23, a[72:73] offset:0
    v_mfma_f32_16x16x32_bf16 a[80:83], v[220:223], a[180:183], a[80:83]
    s_mov_b32 s28, 583680
    v_add_f32 v80, v80, v108
    v_add_f32 v81, v81, v109
    v_mfma_f32_16x16x32_bf16 a[80:83], v[216:219], a[176:179], a[80:83]
    ds_write_b64 v23, a[74:75] offset:512
    v_mfma_f32_16x16x32_bf16 a[84:87], v[220:223], a[176:179], a[84:87]
    buffer_load_dwordx4 a[172:175], v2, s[12:15], s28 offen offset:2048 sc1
    v_mfma_f32_16x16x32_bf16 a[84:87], v[224:227], a[180:183], a[84:87]
    v_add_f32 v82, v82, v110
    v_add_f32 v83, v83, v111
    v_mfma_f32_16x16x32_bf16 a[84:87], v[228:231], a[184:187], a[84:87]
    ds_write_b64 v23, a[80:81] offset:7168
    v_mfma_f32_16x16x32_bf16 a[84:87], v[232:235], a[188:191], a[84:87]
    v_cndmask_b32 v81, 0, v81, s[76:77]
    v_cndmask_b32 v82, 0, v82, s[76:77]
    v_mfma_f32_16x16x32_bf16 a[84:87], v[236:239], a[192:195], a[84:87]
    ds_write_b64 v23, a[82:83] offset:7680
    v_mfma_f32_16x16x32_bf16 a[88:91], v[240:243], a[192:195], a[88:91]
    v_cndmask_b32 v83, 0, v83, s[76:77]
    v_add_f32 v34, v34, v80
    v_mfma_f32_16x16x32_bf16 a[88:91], v[236:239], a[188:191], a[88:91]
    v_fmac_f32 v37, v80, v80
    v_add_f32 v34, v34, v81
    v_mfma_f32_16x16x32_bf16 a[88:91], v[232:235], a[184:187], a[88:91]
    ds_write_b64 v23, a[84:85] offset:10240
    v_mfma_f32_16x16x32_bf16 a[88:91], v[228:231], a[180:183], a[88:91]
    v_fmac_f32 v37, v81, v81
    v_add_f32 v34, v34, v82
    v_mfma_f32_16x16x32_bf16 a[88:91], v[224:227], a[176:179], a[88:91]
    ds_write_b64 v23, a[86:87] offset:10752
    v_mfma_f32_16x16x32_bf16 a[92:95], v[228:231], a[176:179], a[92:95]
    v_fmac_f32 v37, v82, v82
    v_add_f32 v34, v34, v83
    v_mfma_f32_16x16x32_bf16 a[92:95], v[232:235], a[180:183], a[92:95]
    v_fmac_f32 v37, v83, v83
    v_add_u32 v30, v116, v46
    v_mfma_f32_16x16x32_bf16 a[92:95], v[236:239], a[184:187], a[92:95]
    ds_write_b64 v23, a[88:89] offset:13312
    v_mfma_f32_16x16x32_bf16 a[92:95], v[240:243], a[188:191], a[92:95]
    v_mul_i32_i24 v46, -4608, v45
    v_add_u32 v46, 6656, v46
    v_mfma_f32_16x16x32_bf16 a[92:95], v[244:247], a[192:195], a[92:95]
    ds_write_b64 v23, a[90:91] offset:13824
    v_mfma_f32_16x16x32_bf16 a[76:79], v[228:231], a[192:195], a[76:79]
    v_add_u32 v32, v116, v46
    v_mul_i32_i24 v46, -4608, v45
    v_mfma_f32_16x16x32_bf16 a[76:79], v[224:227], a[188:191], a[76:79]
    v_add_u32 v46, 7168, v46
    v_add_u32 v44, v116, v46
    v_mfma_f32_16x16x32_bf16 a[76:79], v[220:223], a[184:187], a[76:79]
    ds_write_b64 v23, a[92:93] offset:16384
    v_mfma_f32_16x16x32_bf16 a[76:79], v[216:219], a[180:183], a[76:79]
    s_mov_b32 s36, 611328
    v_mfma_f32_16x16x32_bf16 a[76:79], v[212:215], a[176:179], a[76:79]
    s_waitcnt vmcnt(22)
    buffer_load_dwordx4 a[176:179], v2, s[12:15], s36 offen offset:2048 sc1
    v_mfma_f32_16x16x32_bf16 a[96:99], v[120:123], a[196:199], a[24:27]
    s_waitcnt vmcnt(22)
    s_mov_b32 s37, 638976
    ds_write_b64 v23, a[94:95] offset:16896
    v_mfma_f32_16x16x32_bf16 a[96:99], v[124:127], a[200:203], a[96:99]
    buffer_load_dwordx4 a[180:183], v2, s[12:15], s37 offen offset:2048 sc1
    v_mfma_f32_16x16x32_bf16 a[100:103], v[124:127], a[196:199], a[28:31]
    s_mov_b32 s28, 549888
    v_mfma_f32_16x16x32_bf16 a[100:103], v[128:131], a[200:203], a[100:103]
    buffer_load_dwordx4 a[184:187], v2, s[12:15], s28 offen offset:2048 sc1
    v_mfma_f32_16x16x32_bf16 a[104:107], v[128:131], a[196:199], a[32:35]
    s_mov_b32 s36, 463872
    v_mfma_f32_16x16x32_bf16 a[104:107], v[132:135], a[200:203], a[104:107]
    s_waitcnt lgkmcnt(0)
    s_barrier
    v_mfma_f32_16x16x32_bf16 a[108:111], v[132:135], a[196:199], a[36:39]
    buffer_load_dwordx4 a[188:191], v2, s[12:15], s36 offen offset:2048 sc1
    v_mfma_f32_16x16x32_bf16 a[108:111], v[136:139], a[200:203], a[108:111]
    s_mov_b32 s37, 491520
    ds_read2st64_b64 v[48:51], v23 offset0:6 offset1:7
    v_accvgpr_read_b32 v76, a76
    v_mfma_f32_16x16x32_bf16 a[112:115], v[136:139], a[196:199], a[40:43]
    buffer_load_dwordx4 a[192:195], v2, s[12:15], s37 offen offset:2048 sc1
    v_mfma_f32_16x16x32_bf16 a[112:115], v[140:143], a[200:203], a[112:115]
    s_mov_b32 s28, 519168
    v_accvgpr_read_b32 v77, a77
    v_accvgpr_read_b32 v78, a78
    v_mfma_f32_16x16x32_bf16 a[116:119], v[140:143], a[196:199], a[44:47]
    buffer_load_dwordx4 a[196:199], v2, s[12:15], s28 offen offset:2048 sc1
    v_mfma_f32_16x16x32_bf16 a[116:119], v[144:147], a[200:203], a[116:119]
    s_waitcnt vmcnt(25)
    ds_read2st64_b64 v[52:55], v23 offset0:8 offset1:9
    v_accvgpr_read_b32 v79, a79
    v_mfma_f32_16x16x32_bf16 a[116:119], v[152:155], a[208:211], a[116:119]
    v_mfma_f32_16x16x32_bf16 a[116:119], v[148:151], a[204:207], a[116:119]
    ds_read2st64_b64 v[56:59], v23 offset0:10 offset1:11
    v_mfma_f32_16x16x32_bf16 a[112:115], v[148:151], a[208:211], a[112:115]
    s_mov_b32 s36, 546816
    v_mfma_f32_16x16x32_bf16 a[112:115], v[144:147], a[204:207], a[112:115]
    buffer_load_dwordx4 a[200:203], v2, s[12:15], s36 offen offset:2048 sc1
    v_mfma_f32_16x16x32_bf16 a[108:111], v[144:147], a[208:211], a[108:111]
    s_waitcnt lgkmcnt(2)
    v_add_f32 v76, v76, v48
    v_add_f32 v77, v77, v49
    v_mfma_f32_16x16x32_bf16 a[108:111], v[140:143], a[204:207], a[108:111]
    v_add_f32 v78, v78, v50
    v_add_f32 v79, v79, v51
    v_mfma_f32_16x16x32_bf16 a[104:107], v[140:143], a[208:211], a[104:107]
    v_mfma_f32_16x16x32_bf16 a[104:107], v[136:139], a[204:207], a[104:107]
    s_waitcnt lgkmcnt(0)
    v_add_f32 v52, v52, v56
    v_add_f32 v53, v53, v57
    v_mfma_f32_16x16x32_bf16 a[100:103], v[136:139], a[208:211], a[100:103]
    v_add_f32 v54, v54, v58
    v_add_f32 v55, v55, v59
    v_mfma_f32_16x16x32_bf16 a[100:103], v[132:135], a[204:207], a[100:103]
    v_sub_f32 v76, -v76, v52
    v_sub_f32 v77, -v77, v53
    v_mfma_f32_16x16x32_bf16 a[96:99], v[132:135], a[208:211], a[96:99]
    s_mov_b32 s37, 574464
    v_sub_f32 v78, -v78, v54
    v_sub_f32 v79, -v79, v55
    v_mfma_f32_16x16x32_bf16 a[96:99], v[128:131], a[204:207], a[96:99]
    s_waitcnt vmcnt(25)
    buffer_load_dwordx4 a[204:207], v2, s[12:15], s37 offen offset:2048 sc1
    v_mfma_f32_16x16x32_bf16 a[96:99], v[136:139], a[212:215], a[96:99]
    s_waitcnt vmcnt(25)
    s_mov_b32 s28, 602112
    v_cndmask_b32 v77, 0, v77, s[76:77]
    v_cndmask_b32 v78, 0, v78, s[76:77]
    v_mfma_f32_16x16x32_bf16 a[96:99], v[140:143], a[216:219], a[96:99]
    buffer_load_dwordx4 a[208:211], v2, s[12:15], s28 offen offset:2048 sc1
    v_mfma_f32_16x16x32_bf16 a[100:103], v[140:143], a[212:215], a[100:103]
    v_cndmask_b32 v79, 0, v79, s[76:77]
    v_add_f32 v33, v33, v76
    v_mfma_f32_16x16x32_bf16 a[100:103], v[144:147], a[216:219], a[100:103]
    v_fmac_f32 v36, v76, v76
    v_add_f32 v33, v33, v77
    v_mfma_f32_16x16x32_bf16 a[104:107], v[144:147], a[212:215], a[104:107]
    v_fmac_f32 v36, v77, v77
    v_add_f32 v33, v33, v78
    v_mfma_f32_16x16x32_bf16 a[104:107], v[148:151], a[216:219], a[104:107]
    v_fmac_f32 v36, v78, v78
    v_add_f32 v33, v33, v79
    v_mfma_f32_16x16x32_bf16 a[108:111], v[148:151], a[212:215], a[108:111]
    v_fmac_f32 v36, v79, v79
    v_mfma_f32_16x16x32_bf16 a[108:111], v[152:155], a[216:219], a[108:111]
    v_mfma_f32_16x16x32_bf16 a[112:115], v[152:155], a[212:215], a[112:115]
    s_mov_b32 s36, 629760
    v_permlane32_swap_b32 v33, v36
    v_add_f32 v33, v33, v36
    v_mfma_f32_16x16x32_bf16 a[112:115], v[156:159], a[216:219], a[112:115]
    ds_write_b32 v24, v33 offset:0
    v_mfma_f32_16x16x32_bf16 a[116:119], v[156:159], a[212:215], a[116:119]
    buffer_load_dwordx4 a[212:215], v2, s[12:15], s36 offen offset:2048 sc1
    v_mfma_f32_16x16x32_bf16 a[116:119], v[160:163], a[216:219], a[116:119]
    s_waitcnt vmcnt(25)
    s_mov_b32 s37, 657408
    ds_read2st64_b64 v[104:107], v22 offset0:50 offset1:51
    v_accvgpr_read_b32 v84, a32
    v_mfma_f32_16x16x32_bf16 a[116:119], v[168:171], a[224:227], a[116:119]
    buffer_load_dwordx4 a[216:219], v2, s[12:15], s37 offen offset:2048 sc1
    v_mfma_f32_16x16x32_bf16 a[116:119], v[164:167], a[220:223], a[116:119]
    v_accvgpr_read_b32 v85, a33
    v_accvgpr_read_b32 v86, a34
    v_mfma_f32_16x16x32_bf16 a[112:115], v[164:167], a[224:227], a[112:115]
    ds_read2st64_b64 v[108:111], v22 offset0:52 offset1:53
    v_accvgpr_read_b32 v87, a35
    v_mfma_f32_16x16x32_bf16 a[112:115], v[160:163], a[220:223], a[112:115]
    v_mfma_f32_16x16x32_bf16 a[108:111], v[160:163], a[224:227], a[108:111]
    ds_read2st64_b64 v[112:115], v22 offset0:54 offset1:55
    v_mfma_f32_16x16x32_bf16 a[108:111], v[156:159], a[220:223], a[108:111]
    v_mfma_f32_16x16x32_bf16 a[104:107], v[156:159], a[224:227], a[104:107]
    buffer_load_dword v12, v47, s[16:19], 0 offen sc1
    v_mfma_f32_16x16x32_bf16 a[104:107], v[152:155], a[220:223], a[104:107]
    s_waitcnt lgkmcnt(2)
    ds_read2st64_b64 v[48:51], v22 offset0:76 offset1:77
    v_add_f32 v84, v84, v104
    v_mfma_f32_16x16x32_bf16 a[100:103], v[152:155], a[224:227], a[100:103]
    v_add_f32 v85, v85, v105
    v_add_f32 v86, v86, v106
    v_mfma_f32_16x16x32_bf16 a[100:103], v[148:151], a[220:223], a[100:103]
    ds_read2st64_b64 v[52:55], v22 offset0:78 offset1:79
    v_add_f32 v87, v87, v107
    v_mfma_f32_16x16x32_bf16 a[96:99], v[148:151], a[224:227], a[96:99]
    s_waitcnt lgkmcnt(2)
    v_add_f32 v108, v108, v112
    v_add_f32 v109, v109, v113
    v_mfma_f32_16x16x32_bf16 a[96:99], v[144:147], a[220:223], a[96:99]
    s_waitcnt vmcnt(26)
    ds_read2st64_b64 v[56:59], v22 offset0:80 offset1:81
    v_add_f32 v110, v110, v114
    v_mfma_f32_16x16x32_bf16 a[96:99], v[172:175], a[228:231], a[96:99]
    s_waitcnt vmcnt(25)
    v_add_f32 v111, v111, v115
    v_add_f32 v84, v84, v108
    v_mfma_f32_16x16x32_bf16 a[96:99], v[196:199], a[232:235], a[96:99]
    v_add_f32 v85, v85, v109
    v_add_f32 v86, v86, v110
    v_mfma_f32_16x16x32_bf16 a[100:103], v[176:179], a[228:231], a[100:103]
    v_add_f32 v87, v87, v111
    v_cndmask_b32 v85, 0, v85, s[76:77]
    v_mfma_f32_16x16x32_bf16 a[100:103], v[200:203], a[232:235], a[100:103]
    v_cndmask_b32 v86, 0, v86, s[76:77]
    v_cndmask_b32 v87, 0, v87, s[76:77]
    v_mfma_f32_16x16x32_bf16 a[104:107], v[180:183], a[228:231], a[104:107]
    v_add_f32 v34, v34, v84
    v_fmac_f32 v37, v84, v84
    v_mfma_f32_16x16x32_bf16 a[104:107], v[204:207], a[232:235], a[104:107]
    v_add_f32 v34, v34, v85
    v_fmac_f32 v37, v85, v85
    v_mfma_f32_16x16x32_bf16 a[108:111], v[184:187], a[228:231], a[108:111]
    s_barrier
    v_mfma_f32_16x16x32_bf16 a[108:111], v[208:211], a[232:235], a[108:111]
    v_add_f32 v34, v34, v86
    v_fmac_f32 v37, v86, v86
    v_mfma_f32_16x16x32_bf16 a[112:115], v[188:191], a[228:231], a[112:115]
    v_add_f32 v34, v34, v87
    v_fmac_f32 v37, v87, v87
    v_mfma_f32_16x16x32_bf16 a[112:115], v[212:215], a[232:235], a[112:115]
    v_accvgpr_read_b32 v92, a48
    v_accvgpr_read_b32 v93, a49
    v_mfma_f32_16x16x32_bf16 a[116:119], v[192:195], a[228:231], a[116:119]
    v_accvgpr_read_b32 v94, a50
    v_accvgpr_read_b32 v95, a51
    v_mfma_f32_16x16x32_bf16 a[116:119], v[216:219], a[232:235], a[116:119]
    s_waitcnt vmcnt(23) lgkmcnt(2)
    v_add_f32 v92, v92, v48
    v_add_f32 v93, v93, v49
    v_mfma_f32_16x16x32_bf16 a[116:119], v[224:227], a[240:243], a[116:119]
    v_add_f32 v94, v94, v50
    v_add_f32 v95, v95, v51
    v_mfma_f32_16x16x32_bf16 a[116:119], v[220:223], a[236:239], a[116:119]
    s_waitcnt lgkmcnt(0)
    v_add_f32 v52, v52, v56
    v_add_f32 v53, v53, v57
    v_mfma_f32_16x16x32_bf16 a[112:115], v[220:223], a[240:243], a[112:115]
    v_add_f32 v54, v54, v58
    v_add_f32 v55, v55, v59
    v_mfma_f32_16x16x32_bf16 a[112:115], v[216:219], a[236:239], a[112:115]
    v_add_f32 v92, v92, v52
    v_add_f32 v93, v93, v53
    v_mfma_f32_16x16x32_bf16 a[108:111], v[216:219], a[240:243], a[108:111]
    v_add_f32 v94, v94, v54
    v_add_f32 v95, v95, v55
    v_mfma_f32_16x16x32_bf16 a[108:111], v[212:215], a[236:239], a[108:111]
    v_cndmask_b32 v93, 0, v93, s[76:77]
    v_cndmask_b32 v94, 0, v94, s[76:77]
    v_mfma_f32_16x16x32_bf16 a[104:107], v[212:215], a[240:243], a[104:107]
    v_cndmask_b32 v95, 0, v95, s[76:77]
    v_add_f32 v35, v35, v92
    v_mfma_f32_16x16x32_bf16 a[104:107], v[208:211], a[236:239], a[104:107]
    v_fmac_f32 v38, v92, v92
    v_add_f32 v35, v35, v93
    v_mfma_f32_16x16x32_bf16 a[100:103], v[208:211], a[240:243], a[100:103]
    v_fmac_f32 v38, v93, v93
    v_add_f32 v35, v35, v94
    v_mfma_f32_16x16x32_bf16 a[100:103], v[204:207], a[236:239], a[100:103]
    v_fmac_f32 v38, v94, v94
    v_add_f32 v35, v35, v95
    v_mfma_f32_16x16x32_bf16 a[96:99], v[204:207], a[240:243], a[96:99]
    v_fmac_f32 v38, v95, v95
    v_mfma_f32_16x16x32_bf16 a[96:99], v[200:203], a[236:239], a[96:99]
    s_waitcnt vmcnt(22)
    v_mfma_f32_16x16x32_bf16 a[96:99], v[208:211], a[244:247], a[96:99]
    s_waitcnt vmcnt(21)
    v_mfma_f32_16x16x32_bf16 a[96:99], v[212:215], a[248:251], a[96:99]
    s_waitcnt vmcnt(20)
    v_mfma_f32_16x16x32_bf16 a[96:99], v[216:219], a[252:255], a[96:99]
    s_waitcnt vmcnt(19)
    v_mfma_f32_16x16x32_bf16 a[96:99], v[220:223], a[144:147], a[96:99]
    s_waitcnt vmcnt(18)
    v_mfma_f32_16x16x32_bf16 a[96:99], v[224:227], a[148:151], a[96:99]
    v_mfma_f32_16x16x32_bf16 a[104:107], v[232:235], a[148:151], a[104:107]
    v_mfma_f32_16x16x32_bf16 a[104:107], v[228:231], a[144:147], a[104:107]
    v_mfma_f32_16x16x32_bf16 a[104:107], v[224:227], a[252:255], a[104:107]
    ds_write_b64 v23, a[96:97] offset:18432
    v_mfma_f32_16x16x32_bf16 a[104:107], v[220:223], a[248:251], a[104:107]
    v_mfma_f32_16x16x32_bf16 a[104:107], v[216:219], a[244:247], a[104:107]
    ds_write_b64 v23, a[98:99] offset:18944
    v_mfma_f32_16x16x32_bf16 a[108:111], v[220:223], a[244:247], a[108:111]
    v_mfma_f32_16x16x32_bf16 a[108:111], v[224:227], a[248:251], a[108:111]
    v_mfma_f32_16x16x32_bf16 a[108:111], v[228:231], a[252:255], a[108:111]
    ds_write_b64 v23, a[104:105] offset:25600
    v_mfma_f32_16x16x32_bf16 a[108:111], v[232:235], a[144:147], a[108:111]
    v_mfma_f32_16x16x32_bf16 a[108:111], v[236:239], a[148:151], a[108:111]
    ds_write_b64 v23, a[106:107] offset:26112
    v_mfma_f32_16x16x32_bf16 a[112:115], v[240:243], a[148:151], a[112:115]
    v_mfma_f32_16x16x32_bf16 a[112:115], v[236:239], a[144:147], a[112:115]
    v_mfma_f32_16x16x32_bf16 a[112:115], v[232:235], a[252:255], a[112:115]
    ds_write_b64 v23, a[108:109] offset:28672
    v_mfma_f32_16x16x32_bf16 a[112:115], v[228:231], a[248:251], a[112:115]
    v_mfma_f32_16x16x32_bf16 a[112:115], v[224:227], a[244:247], a[112:115]
    ds_write_b64 v23, a[110:111] offset:29184
    v_mfma_f32_16x16x32_bf16 a[116:119], v[228:231], a[244:247], a[116:119]
    v_mfma_f32_16x16x32_bf16 a[116:119], v[232:235], a[248:251], a[116:119]
    v_mfma_f32_16x16x32_bf16 a[116:119], v[236:239], a[252:255], a[116:119]
    ds_write_b64 v23, a[112:113] offset:31744
    v_mfma_f32_16x16x32_bf16 a[116:119], v[240:243], a[144:147], a[116:119]
    v_mfma_f32_16x16x32_bf16 a[116:119], v[244:247], a[148:151], a[116:119]
    ds_write_b64 v23, a[114:115] offset:32256
    v_mfma_f32_16x16x32_bf16 a[100:103], v[228:231], a[148:151], a[100:103]
    v_mfma_f32_16x16x32_bf16 a[100:103], v[224:227], a[144:147], a[100:103]
    v_mfma_f32_16x16x32_bf16 a[100:103], v[220:223], a[252:255], a[100:103]
    ds_write_b64 v23, a[116:117] offset:34816
    v_mfma_f32_16x16x32_bf16 a[100:103], v[216:219], a[248:251], a[100:103]
    v_mfma_f32_16x16x32_bf16 a[100:103], v[212:215], a[244:247], a[100:103]
    s_waitcnt vmcnt(17)
    ds_write_b64 v23, a[118:119] offset:35328
    v_mfma_f32_16x16x32_bf16 a[120:123], v[120:123], a[152:155], a[48:51]
    s_waitcnt vmcnt(16)
    v_mfma_f32_16x16x32_bf16 a[120:123], v[124:127], a[156:159], a[120:123]
    v_mfma_f32_16x16x32_bf16 a[124:127], v[124:127], a[152:155], a[52:55]
    v_mfma_f32_16x16x32_bf16 a[124:127], v[128:131], a[156:159], a[124:127]
    v_mfma_f32_16x16x32_bf16 a[128:131], v[128:131], a[152:155], a[56:59]
    v_mfma_f32_16x16x32_bf16 a[128:131], v[132:135], a[156:159], a[128:131]
    s_waitcnt lgkmcnt(0)
    s_barrier
    v_mfma_f32_16x16x32_bf16 a[136:139], v[136:139], a[152:155], a[64:67]
    ds_read2st64_b64 v[104:107], v23 offset0:42 offset1:43
    v_accvgpr_read_b32 v88, a100
    v_mfma_f32_16x16x32_bf16 a[136:139], v[140:143], a[156:159], a[136:139]
    v_accvgpr_read_b32 v89, a101
    v_accvgpr_read_b32 v90, a102
    v_mfma_f32_16x16x32_bf16 a[140:143], v[140:143], a[152:155], a[68:71]
    ds_read2st64_b64 v[108:111], v23 offset0:44 offset1:45
    v_accvgpr_read_b32 v91, a103
    v_mfma_f32_16x16x32_bf16 a[140:143], v[144:147], a[156:159], a[140:143]
    s_waitcnt vmcnt(14)
    v_mfma_f32_16x16x32_bf16 a[140:143], v[152:155], a[164:167], a[140:143]
    ds_read2st64_b64 v[112:115], v23 offset0:46 offset1:47
    v_mfma_f32_16x16x32_bf16 a[140:143], v[148:151], a[160:163], a[140:143]
    v_mfma_f32_16x16x32_bf16 a[136:139], v[148:151], a[164:167], a[136:139]
    v_mfma_f32_16x16x32_bf16 a[136:139], v[144:147], a[160:163], a[136:139]
    v_mfma_f32_16x16x32_bf16 a[128:131], v[140:143], a[164:167], a[128:131]
    s_waitcnt lgkmcnt(2)
    v_add_f32 v88, v88, v104
    v_add_f32 v89, v89, v105
    v_mfma_f32_16x16x32_bf16 a[128:131], v[136:139], a[160:163], a[128:131]
    v_add_f32 v90, v90, v106
    v_add_f32 v91, v91, v107
    v_mfma_f32_16x16x32_bf16 a[124:127], v[136:139], a[164:167], a[124:127]
    s_waitcnt lgkmcnt(0)
    v_add_f32 v108, v108, v112
    v_add_f32 v109, v109, v113
    v_mfma_f32_16x16x32_bf16 a[124:127], v[132:135], a[160:163], a[124:127]
    v_add_f32 v110, v110, v114
    v_add_f32 v111, v111, v115
    v_mfma_f32_16x16x32_bf16 a[120:123], v[132:135], a[164:167], a[120:123]
    v_sub_f32 v88, -v88, v108
    v_sub_f32 v89, -v89, v109
    v_mfma_f32_16x16x32_bf16 a[120:123], v[128:131], a[160:163], a[120:123]
    s_waitcnt vmcnt(13)
    v_sub_f32 v90, -v90, v110
    v_sub_f32 v91, -v91, v111
    v_mfma_f32_16x16x32_bf16 a[120:123], v[136:139], a[168:171], a[120:123]
    s_waitcnt vmcnt(12)
    v_cndmask_b32 v89, 0, v89, s[76:77]
    v_cndmask_b32 v90, 0, v90, s[76:77]
    v_mfma_f32_16x16x32_bf16 a[120:123], v[140:143], a[172:175], a[120:123]
    v_cndmask_b32 v91, 0, v91, s[76:77]
    v_add_f32 v34, v34, v88
    v_mfma_f32_16x16x32_bf16 a[124:127], v[140:143], a[168:171], a[124:127]
    v_fmac_f32 v37, v88, v88
    v_add_f32 v34, v34, v89
    v_mfma_f32_16x16x32_bf16 a[124:127], v[144:147], a[172:175], a[124:127]
    v_fmac_f32 v37, v89, v89
    v_add_f32 v34, v34, v90
    v_mfma_f32_16x16x32_bf16 a[128:131], v[144:147], a[168:171], a[128:131]
    v_fmac_f32 v37, v90, v90
    v_add_f32 v34, v34, v91
    v_mfma_f32_16x16x32_bf16 a[128:131], v[148:151], a[172:175], a[128:131]
    v_fmac_f32 v37, v91, v91
    v_mfma_f32_16x16x32_bf16 a[136:139], v[152:155], a[168:171], a[136:139]
    v_mfma_f32_16x16x32_bf16 a[136:139], v[156:159], a[172:175], a[136:139]
    v_permlane32_swap_b32 v34, v37
    v_add_f32 v34, v34, v37
    v_mfma_f32_16x16x32_bf16 a[140:143], v[156:159], a[168:171], a[140:143]
    buffer_load_dwordx2 v[6:7], v28, s[24:27], 0 offen offset:0 sc1
    v_mfma_f32_16x16x32_bf16 a[140:143], v[160:163], a[172:175], a[140:143]
    s_waitcnt vmcnt(11)
    ds_write_b32 v24, v34 offset:1024
    v_mfma_f32_16x16x32_bf16 a[140:143], v[168:171], a[180:183], a[140:143]
    buffer_load_dwordx2 v[8:9], v28, s[24:27], 0 offen offset:2048 sc1
    v_mfma_f32_16x16x32_bf16 a[140:143], v[164:167], a[176:179], a[140:143]
    v_mfma_f32_16x16x32_bf16 a[136:139], v[164:167], a[180:183], a[136:139]
    buffer_load_dwordx2 v[10:11], v3, s[24:27], 0 offen offset:0 sc1
    v_mfma_f32_16x16x32_bf16 a[136:139], v[160:163], a[176:179], a[136:139]
    v_mfma_f32_16x16x32_bf16 a[128:131], v[156:159], a[180:183], a[128:131]
    v_mfma_f32_16x16x32_bf16 a[128:131], v[152:155], a[176:179], a[128:131]
    v_mfma_f32_16x16x32_bf16 a[124:127], v[152:155], a[180:183], a[124:127]
    v_mfma_f32_16x16x32_bf16 a[124:127], v[148:151], a[176:179], a[124:127]
    v_mfma_f32_16x16x32_bf16 a[120:123], v[148:151], a[180:183], a[120:123]
    v_mfma_f32_16x16x32_bf16 a[120:123], v[144:147], a[176:179], a[120:123]
    s_waitcnt vmcnt(12)
    v_mfma_f32_16x16x32_bf16 a[120:123], v[172:175], a[184:187], a[120:123]
    s_waitcnt vmcnt(11)
    v_mfma_f32_16x16x32_bf16 a[120:123], v[196:199], a[188:191], a[120:123]
    s_waitcnt vmcnt(10)
    v_mfma_f32_16x16x32_bf16 a[120:123], v[200:203], a[192:195], a[120:123]
    s_waitcnt vmcnt(9)
    v_mfma_f32_16x16x32_bf16 a[120:123], v[204:207], a[196:199], a[120:123]
    s_waitcnt vmcnt(8)
    v_mfma_f32_16x16x32_bf16 a[120:123], v[208:211], a[200:203], a[120:123]
    s_waitcnt vmcnt(7)
    v_mfma_f32_16x16x32_bf16 a[120:123], v[212:215], a[204:207], a[120:123]
    s_waitcnt vmcnt(6)
    v_mfma_f32_16x16x32_bf16 a[120:123], v[216:219], a[208:211], a[120:123]
    s_waitcnt vmcnt(5)
    v_mfma_f32_16x16x32_bf16 a[120:123], v[220:223], a[212:215], a[120:123]
    s_waitcnt vmcnt(4)
    v_mfma_f32_16x16x32_bf16 a[120:123], v[224:227], a[216:219], a[120:123]
    v_mfma_f32_16x16x32_bf16 a[128:131], v[232:235], a[216:219], a[128:131]
    v_mfma_f32_16x16x32_bf16 a[128:131], v[228:231], a[212:215], a[128:131]
    v_mfma_f32_16x16x32_bf16 a[128:131], v[224:227], a[208:211], a[128:131]
    s_waitcnt lgkmcnt(0)
    s_barrier
    v_mfma_f32_16x16x32_bf16 a[128:131], v[220:223], a[204:207], a[128:131]
    ds_write_b64 v23, a[120:121] offset:36864
    v_mfma_f32_16x16x32_bf16 a[128:131], v[216:219], a[200:203], a[128:131]
    ds_read_b128 v[60:63], v25 offset:1024
    ds_read_b128 v[64:67], v25 offset:1040
    v_mfma_f32_16x16x32_bf16 a[128:131], v[212:215], a[196:199], a[128:131]
    ds_write_b64 v23, a[122:123] offset:37376
    v_mfma_f32_16x16x32_bf16 a[128:131], v[208:211], a[192:195], a[128:131]
    v_accvgpr_read_b32 v100, a60
    v_accvgpr_read_b32 v101, a61
    v_mfma_f32_16x16x32_bf16 a[128:131], v[204:207], a[188:191], a[128:131]
    v_accvgpr_read_b32 v102, a62
    v_accvgpr_read_b32 v103, a63
    v_mfma_f32_16x16x32_bf16 a[128:131], v[180:183], a[184:187], a[128:131]
    v_mfma_f32_16x16x32_bf16 a[140:143], v[192:195], a[184:187], a[140:143]
    v_mfma_f32_16x16x32_bf16 a[140:143], v[216:219], a[188:191], a[140:143]
    v_mfma_f32_16x16x32_bf16 a[140:143], v[220:223], a[192:195], a[140:143]
    v_mfma_f32_16x16x32_bf16 a[140:143], v[224:227], a[196:199], a[140:143]
    s_waitcnt lgkmcnt(2)
    v_add_f32 v60, v60, v61
    v_add_f32 v62, v62, v63
    v_mfma_f32_16x16x32_bf16 a[140:143], v[228:231], a[200:203], a[140:143]
    s_waitcnt lgkmcnt(1)
    v_add_f32 v64, v64, v65
    v_add_f32 v66, v66, v67
    v_mfma_f32_16x16x32_bf16 a[140:143], v[232:235], a[204:207], a[140:143]
    v_add_f32 v60, v60, v62
    v_add_f32 v64, v64, v66
    v_mfma_f32_16x16x32_bf16 a[140:143], v[236:239], a[208:211], a[140:143]
    v_add_f32 v60, v60, v64
    v_min_u32 v60, -2, v60
    v_mfma_f32_16x16x32_bf16 a[140:143], v[240:243], a[212:215], a[140:143]
    buffer_store_dword v60, v27, s[24:27], s74 offen sc1
    v_mfma_f32_16x16x32_bf16 a[140:143], v[244:247], a[216:219], a[140:143]
    s_waitcnt lgkmcnt(0)
    s_barrier
    v_mfma_f32_16x16x32_bf16 a[124:127], v[228:231], a[216:219], a[124:127]
    ds_read2st64_b64 v[104:107], v23 offset0:84 offset1:85
    v_mov_b32 v27, 2.0
    v_mfma_f32_16x16x32_bf16 a[124:127], v[224:227], a[212:215], a[124:127]
    v_accvgpr_read_b32 v96, a128
    v_accvgpr_read_b32 v97, a129
    v_mfma_f32_16x16x32_bf16 a[124:127], v[220:223], a[208:211], a[124:127]
    ds_write_b64 v23, a[140:141] offset:53248
    v_mfma_f32_16x16x32_bf16 a[124:127], v[216:219], a[204:207], a[124:127]
    ds_read2st64_b64 v[108:111], v23 offset0:86 offset1:87
    v_accvgpr_read_b32 v98, a130
    v_mfma_f32_16x16x32_bf16 a[124:127], v[212:215], a[200:203], a[124:127]
    ds_write_b64 v23, a[142:143] offset:53760
    v_mfma_f32_16x16x32_bf16 a[124:127], v[208:211], a[196:199], a[124:127]
    ds_read2st64_b64 v[112:115], v23 offset0:88 offset1:89
    v_accvgpr_read_b32 v99, a131
    v_mfma_f32_16x16x32_bf16 a[124:127], v[204:207], a[192:195], a[124:127]
    s_waitcnt vmcnt(1)
    v_max3_u32 v39, v6, v7, v8
    v_max3_u32 v39, v39, v10, v11
    v_mfma_f32_16x16x32_bf16 a[124:127], v[200:203], a[188:191], a[124:127]
    v_max_u32 v39, v39, v9
    v_cmp_eq_u32 vcc, -1, v39
    v_mfma_f32_16x16x32_bf16 a[124:127], v[176:179], a[184:187], a[124:127]
    s_waitcnt lgkmcnt(4)
    v_add_f32 v96, v96, v104
    v_add_f32 v97, v97, v105
    v_mfma_f32_16x16x32_bf16 a[136:139], v[188:191], a[184:187], a[136:139]
    s_cbranch_vccnz Lg1_0
Lh1_0:
    v_add_f32 v6, v6, v8
    v_add_f32 v7, v7, v9
    v_mfma_f32_16x16x32_bf16 a[136:139], v[212:215], a[188:191], a[136:139]
    v_add_f32 v6, v6, v10
    v_add_f32 v7, v7, v11
    v_mfma_f32_16x16x32_bf16 a[136:139], v[216:219], a[192:195], a[136:139]
    ds_write_b64 v23, a[124:125] offset:39936
    v_mfma_f32_16x16x32_bf16 a[136:139], v[220:223], a[196:199], a[136:139]
    v_permlane32_swap_b32 v6, v7
    v_add_f32 v6, v6, v7
    v_mfma_f32_16x16x32_bf16 a[136:139], v[224:227], a[200:203], a[136:139]
    ds_write_b64 v23, a[126:127] offset:40448
    v_mfma_f32_16x16x32_bf16 a[136:139], v[228:231], a[204:207], a[136:139]
    v_mov_b32 v7, v6
    v_add_f32 v98, v98, v106
    v_mfma_f32_16x16x32_bf16 a[136:139], v[232:235], a[208:211], a[136:139]
    s_waitcnt lgkmcnt(2)
    v_add_f32 v99, v99, v107
    v_add_f32 v108, v108, v112
    v_mfma_f32_16x16x32_bf16 a[136:139], v[236:239], a[212:215], a[136:139]
    v_permlane16_swap_b32 v6, v7
    v_add_f32 v6, v6, v7
    v_mfma_f32_16x16x32_bf16 a[136:139], v[240:243], a[216:219], a[136:139]
    s_waitcnt lgkmcnt(0)
    s_barrier
    v_mfma_f32_16x16x32_bf16 v[40:43], v[132:135], a[152:155], 0
    ds_write_b32 v117, v6 offset:0
    v_mfma_f32_16x16x32_bf16 v[40:43], v[136:139], a[156:159], v[40:43]
    v_add_f32 v109, v109, v113
    v_add_f32 v110, v110, v114
    v_mfma_f32_16x16x32_bf16 v[40:43], v[140:143], a[160:163], v[40:43]
    ds_write_b64 v23, a[136:137] offset:50176
    v_mfma_f32_16x16x32_bf16 v[40:43], v[144:147], a[164:167], v[40:43]
    v_add_f32 v111, v111, v115
    v_sub_f32 v96, -v96, v108
    v_mfma_f32_16x16x32_bf16 v[40:43], v[148:151], a[168:171], v[40:43]
    ds_write_b64 v23, a[138:139] offset:50688
    v_mfma_f32_16x16x32_bf16 v[40:43], v[152:155], a[172:175], v[40:43]
    v_sub_f32 v97, -v97, v109
    v_sub_f32 v98, -v98, v110
    v_mfma_f32_16x16x32_bf16 v[40:43], v[156:159], a[176:179], v[40:43]
    v_sub_f32 v99, -v99, v111
    v_cndmask_b32 v97, 0, v97, s[76:77]
    v_mfma_f32_16x16x32_bf16 v[40:43], v[160:163], a[180:183], v[40:43]
    v_cndmask_b32 v98, 0, v98, s[76:77]
    v_cndmask_b32 v99, 0, v99, s[76:77]
    v_mfma_f32_16x16x32_bf16 v[40:43], v[184:187], a[184:187], v[40:43]
    s_waitcnt lgkmcnt(0)
    s_barrier
    v_mfma_f32_16x16x32_bf16 v[40:43], v[208:211], a[188:191], v[40:43]
    v_add_f32 v35, v35, v96
    v_fmac_f32 v38, v96, v96
    v_mfma_f32_16x16x32_bf16 v[40:43], v[212:215], a[192:195], v[40:43]
    v_add_f32 v35, v35, v97
    v_fmac_f32 v38, v97, v97
    v_mfma_f32_16x16x32_bf16 v[40:43], v[216:219], a[196:199], v[40:43]
    v_add_f32 v35, v35, v98
    v_fmac_f32 v38, v98, v98
    v_mfma_f32_16x16x32_bf16 v[40:43], v[220:223], a[200:203], v[40:43]
    v_add_f32 v35, v35, v99
    v_fmac_f32 v38, v99, v99
    v_mfma_f32_16x16x32_bf16 v[40:43], v[224:227], a[204:207], v[40:43]
    ds_read2st64_b64 v[52:55], v23 offset0:92 offset1:93
    ds_read2st64_b64 v[56:59], v23 offset0:94 offset1:95
    v_mfma_f32_16x16x32_bf16 v[40:43], v[228:231], a[208:211], v[40:43]
    ds_read2st64_b64 v[48:51], v23 offset0:90 offset1:91
    v_mfma_f32_16x16x32_bf16 v[40:43], v[232:235], a[212:215], v[40:43]
    v_mfma_f32_16x16x32_bf16 v[40:43], v[236:239], a[216:219], v[40:43]
    s_waitcnt lgkmcnt(1)
Lt6:
    s_cbranch_execz Lt7
    v_add_f32 v52, v52, v56
    v_add_f32 v53, v53, v57
    v_add_f32 v54, v54, v58
    v_add_f32 v55, v55, v59
    v_add_f32 v100, v100, v52
    v_add_f32 v101, v101, v53
    v_add_f32 v102, v102, v54
    v_add_f32 v103, v103, v55
    s_waitcnt lgkmcnt(0)
    v_add_f32 v100, v100, v48
    v_add_f32 v101, v101, v49
    v_add_f32 v102, v102, v50
    v_add_f32 v103, v103, v51
    v_sub_f32 v100, -v100, v40
    v_sub_f32 v101, -v101, v41
    v_sub_f32 v102, -v102, v42
    v_sub_f32 v103, -v103, v43
    v_cndmask_b32 v101, 0, v101, s[76:77]
    v_cndmask_b32 v102, 0, v102, s[76:77]
    v_cndmask_b32 v103, 0, v103, s[76:77]
    v_add_f32 v35, v35, v100
    v_fmac_f32 v38, v100, v100
    v_add_f32 v35, v35, v101
    v_fmac_f32 v38, v101, v101
    v_add_f32 v35, v35, v102
    v_fmac_f32 v38, v102, v102
    v_add_f32 v35, v35, v103
    v_fmac_f32 v38, v103, v103
    s_nop 1
    v_permlane32_swap_b32 v35, v38
    v_add_f32 v35, v35, v38
    ds_write_b32 v24, v35 offset:2048
    buffer_load_dwordx2 v[120:121], v28, s[24:27], s74 offen offset:0 sc1
    buffer_load_dwordx2 v[122:123], v28, s[24:27], s74 offen offset:2048 sc1
    buffer_load_dwordx2 v[124:125], v3, s[24:27], s74 offen offset:0 sc1
    s_waitcnt lgkmcnt(0)
    s_barrier
    s_branch Lepi
Lg1_0:
    s_mov_b64 exec, vcc
    buffer_load_dwordx2 v[6:7], v28, s[24:27], 0 offen offset:0 sc1
    buffer_load_dwordx2 v[8:9], v28, s[24:27], 0 offen offset:2048 sc1
    buffer_load_dwordx2 v[10:11], v3, s[24:27], 0 offen offset:0 sc1
    s_mov_b64 exec, -1
    s_waitcnt vmcnt(0)
    v_max3_u32 v39, v6, v7, v8
    v_max3_u32 v39, v39, v10, v11
    v_max_u32 v39, v39, v9
    v_cmp_eq_u32 vcc, -1, v39
    s_sub_u32 s85, s85, 1
    s_cmp_lt_i32 s85, 0
    s_cbranch_scc1 Lh1_0
    s_cbranch_vccnz Lg1_0
    s_branch Lh1_0
Lcom1:
    ds_read_b128 v[132:135], v48 offset:144
    ds_read_b128 v[136:139], v49 offset:144
    ds_read_b128 v[140:143], v48 offset:288
    ds_read_b128 v[144:147], v49 offset:288
    ds_read_b128 v[148:151], v48 offset:432
    ds_read_b128 v[152:155], v49 offset:432
    ds_read_b128 v[156:159], v48 offset:576
    ds_read_b128 v[160:163], v49 offset:576
    s_waitcnt lgkmcnt(7)
    v_lshlrev_b32 v52, 16, v132
    v_and_b32 v53, s84, v132
    s_waitcnt lgkmcnt(6)
    v_lshlrev_b32 v54, 16, v136
    v_and_b32 v55, s84, v136
    v_pk_add_f32 v[52:53], v[52:53], v[54:55]
    v_cvt_pk_bf16_f32 v172, v52, v53
    v_lshlrev_b32 v56, 16, v133
    v_and_b32 v57, s84, v133
    v_lshlrev_b32 v58, 16, v137
    v_and_b32 v59, s84, v137
    v_pk_add_f32 v[56:57], v[56:57], v[58:59]
    v_cvt_pk_bf16_f32 v173, v56, v57
    v_lshlrev_b32 v52, 16, v134
    v_and_b32 v53, s84, v134
    v_lshlrev_b32 v54, 16, v138
    v_and_b32 v55, s84, v138
    v_pk_add_f32 v[52:53], v[52:53], v[54:55]
    v_cvt_pk_bf16_f32 v174, v52, v53
    v_lshlrev_b32 v56, 16, v135
    v_and_b32 v57, s84, v135
    v_lshlrev_b32 v58, 16, v139
    v_and_b32 v59, s84, v139
    v_pk_add_f32 v[56:57], v[56:57], v[58:59]
    v_cvt_pk_bf16_f32 v175, v56, v57
    ds_read_b128 v[208:211], v48 offset:720
    ds_read_b128 v[212:215], v49 offset:720
    s_waitcnt lgkmcnt(7)
    v_lshlrev_b32 v52, 16, v140
    v_and_b32 v53, s84, v140
    s_waitcnt lgkmcnt(6)
    v_lshlrev_b32 v54, 16, v144
    v_and_b32 v55, s84, v144
    v_pk_add_f32 v[52:53], v[52:53], v[54:55]
    v_cvt_pk_bf16_f32 v176, v52, v53
    v_lshlrev_b32 v56, 16, v141
    v_and_b32 v57, s84, v141
    v_lshlrev_b32 v58, 16, v145
    v_and_b32 v59, s84, v145
    v_pk_add_f32 v[56:57], v[56:57], v[58:59]
    v_cvt_pk_bf16_f32 v177, v56, v57
    v_lshlrev_b32 v52, 16, v142
    v_and_b32 v53, s84, v142
    v_lshlrev_b32 v54, 16, v146
    v_and_b32 v55, s84, v146
    v_pk_add_f32 v[52:53], v[52:53], v[54:55]
    v_cvt_pk_bf16_f32 v178, v52, v53
    v_lshlrev_b32 v56, 16, v143
    v_and_b32 v57, s84, v143
    v_lshlrev_b32 v58, 16, v147
    v_and_b32 v59, s84, v147
    v_pk_add_f32 v[56:57], v[56:57], v[58:59]
    v_cvt_pk_bf16_f32 v179, v56, v57
    ds_read_b128 v[216:219], v48 offset:864
    ds_read_b128 v[220:223], v49 offset:864
    s_waitcnt lgkmcnt(7)
    v_lshlrev_b32 v52, 16, v148
    v_and_b32 v53, s84, v148
    s_waitcnt lgkmcnt(6)
    v_lshlrev_b32 v54, 16, v152
    v_and_b32 v55, s84, v152
    v_pk_add_f32 v[52:53], v[52:53], v[54:55]
    v_cvt_pk_bf16_f32 v180, v52, v53
    v_lshlrev_b32 v56, 16, v149
    v_and_b32 v57, s84, v149
    v_lshlrev_b32 v58, 16, v153
    v_and_b32 v59, s84, v153
    v_pk_add_f32 v[56:57], v[56:57], v[58:59]
    v_cvt_pk_bf16_f32 v181, v56, v57
    v_lshlrev_b32 v52, 16, v150
    v_and_b32 v53, s84, v150
    v_lshlrev_b32 v54, 16, v154
    v_and_b32 v55, s84, v154
    v_pk_add_f32 v[52:53], v[52:53], v[54:55]
    v_cvt_pk_bf16_f32 v182, v52, v53
    v_lshlrev_b32 v56, 16, v151
    v_and_b32 v57, s84, v151
    v_lshlrev_b32 v58, 16, v155
    v_and_b32 v59, s84, v155
    v_pk_add_f32 v[56:57], v[56:57], v[58:59]
    v_cvt_pk_bf16_f32 v183, v56, v57
    ds_read_b128 v[224:227], v48 offset:1008
    ds_read_b128 v[228:231], v49 offset:1008
    s_waitcnt lgkmcnt(7)
    v_lshlrev_b32 v52, 16, v156
    v_and_b32 v53, s84, v156
    s_waitcnt lgkmcnt(6)
    v_lshlrev_b32 v54, 16, v160
    v_and_b32 v55, s84, v160
    v_pk_add_f32 v[52:53], v[52:53], v[54:55]
    v_cvt_pk_bf16_f32 v184, v52, v53
    v_lshlrev_b32 v56, 16, v157
    v_and_b32 v57, s84, v157
    v_lshlrev_b32 v58, 16, v161
    v_and_b32 v59, s84, v161
    v_pk_add_f32 v[56:57], v[56:57], v[58:59]
    v_cvt_pk_bf16_f32 v185, v56, v57
    v_lshlrev_b32 v52, 16, v158
    v_and_b32 v53, s84, v158
    v_lshlrev_b32 v54, 16, v162
    v_and_b32 v55, s84, v162
    v_pk_add_f32 v[52:53], v[52:53], v[54:55]
    v_cvt_pk_bf16_f32 v186, v52, v53
    v_lshlrev_b32 v56, 16, v159
    v_and_b32 v57, s84, v159
    v_lshlrev_b32 v58, 16, v163
    v_and_b32 v59, s84, v163
    v_pk_add_f32 v[56:57], v[56:57], v[58:59]
    v_cvt_pk_bf16_f32 v187, v56, v57
    ds_read_b128 v[232:235], v48 offset:1152
    ds_read_b128 v[236:239], v49 offset:1152
    s_waitcnt lgkmcnt(7)
    v_lshlrev_b32 v52, 16, v208
    v_and_b32 v53, s84, v208
    s_waitcnt lgkmcnt(6)
    v_lshlrev_b32 v54, 16, v212
    v_and_b32 v55, s84, v212
    v_pk_add_f32 v[52:53], v[52:53], v[54:55]
    v_cvt_pk_bf16_f32 v188, v52, v53
    v_lshlrev_b32 v56, 16, v209
    v_and_b32 v57, s84, v209
    v_lshlrev_b32 v58, 16, v213
    v_and_b32 v59, s84, v213
    v_pk_add_f32 v[56:57], v[56:57], v[58:59]
    v_cvt_pk_bf16_f32 v189, v56, v57
    v_lshlrev_b32 v52, 16, v210
    v_and_b32 v53, s84, v210
    v_lshlrev_b32 v54, 16, v214
    v_and_b32 v55, s84, v214
    v_pk_add_f32 v[52:53], v[52:53], v[54:55]
    v_cvt_pk_bf16_f32 v190, v52, v53
    v_lshlrev_b32 v56, 16, v211
    v_and_b32 v57, s84, v211
    v_lshlrev_b32 v58, 16, v215
    v_and_b32 v59, s84, v215
    v_pk_add_f32 v[56:57], v[56:57], v[58:59]
    v_cvt_pk_bf16_f32 v191, v56, v57
    s_waitcnt lgkmcnt(5)
    v_lshlrev_b32 v52, 16, v216
    v_and_b32 v53, s84, v216
    s_waitcnt lgkmcnt(4)
    v_lshlrev_b32 v54, 16, v220
    v_and_b32 v55, s84, v220
    v_pk_add_f32 v[52:53], v[52:53], v[54:55]
    v_cvt_pk_bf16_f32 v192, v52, v53
    v_lshlrev_b32 v56, 16, v217
    v_and_b32 v57, s84, v217
    v_lshlrev_b32 v58, 16, v221
    v_and_b32 v59, s84, v221
    v_pk_add_f32 v[56:57], v[56:57], v[58:59]
    v_cvt_pk_bf16_f32 v193, v56, v57
    v_lshlrev_b32 v52, 16, v218
    v_and_b32 v53, s84, v218
    v_lshlrev_b32 v54, 16, v222
    v_and_b32 v55, s84, v222
    v_pk_add_f32 v[52:53], v[52:53], v[54:55]
    v_cvt_pk_bf16_f32 v194, v52, v53
    v_lshlrev_b32 v56, 16, v219
    v_and_b32 v57, s84, v219
    v_lshlrev_b32 v58, 16, v223
    v_and_b32 v59, s84, v223
    v_pk_add_f32 v[56:57], v[56:57], v[58:59]
    v_cvt_pk_bf16_f32 v195, v56, v57
    s_waitcnt lgkmcnt(3)
    v_lshlrev_b32 v52, 16, v224
    v_and_b32 v53, s84, v224
    s_waitcnt lgkmcnt(2)
    v_lshlrev_b32 v54, 16, v228
    v_and_b32 v55, s84, v228
    v_pk_add_f32 v[52:53], v[52:53], v[54:55]
    v_cvt_pk_bf16_f32 v196, v52, v53
    v_lshlrev_b32 v56, 16, v225
    v_and_b32 v57, s84, v225
    v_lshlrev_b32 v58, 16, v229
    v_and_b32 v59, s84, v229
    v_pk_add_f32 v[56:57], v[56:57], v[58:59]
    v_cvt_pk_bf16_f32 v197, v56, v57
    v_lshlrev_b32 v52, 16, v226
    v_and_b32 v53, s84, v226
    v_lshlrev_b32 v54, 16, v230
    v_and_b32 v55, s84, v230
    v_pk_add_f32 v[52:53], v[52:53], v[54:55]
    v_cvt_pk_bf16_f32 v198, v52, v53
    v_lshlrev_b32 v56, 16, v227
    v_and_b32 v57, s84, v227
    v_lshlrev_b32 v58, 16, v231
    v_and_b32 v59, s84, v231
    v_pk_add_f32 v[56:57], v[56:57], v[58:59]
    v_cvt_pk_bf16_f32 v199, v56, v57
    s_waitcnt lgkmcnt(1)
    v_lshlrev_b32 v52, 16, v232
    v_and_b32 v53, s84, v232
    s_waitcnt lgkmcnt(0)
    v_lshlrev_b32 v54, 16, v236
    v_and_b32 v55, s84, v236
    v_pk_add_f32 v[52:53], v[52:53], v[54:55]
    v_cvt_pk_bf16_f32 v200, v52, v53
    v_lshlrev_b32 v56, 16, v233
    v_and_b32 v57, s84, v233
    v_lshlrev_b32 v58, 16, v237
    v_and_b32 v59, s84, v237
    v_pk_add_f32 v[56:57], v[56:57], v[58:59]
    v_cvt_pk_bf16_f32 v201, v56, v57
    v_lshlrev_b32 v52, 16, v234
    v_and_b32 v53, s84, v234
    v_lshlrev_b32 v54, 16, v238
    v_and_b32 v55, s84, v238
    v_pk_add_f32 v[52:53], v[52:53], v[54:55]
    v_cvt_pk_bf16_f32 v202, v52, v53
    v_lshlrev_b32 v56, 16, v235
    v_and_b32 v57, s84, v235
    v_lshlrev_b32 v58, 16, v239
    v_and_b32 v59, s84, v239
    v_pk_add_f32 v[56:57], v[56:57], v[58:59]
    v_cvt_pk_bf16_f32 v203, v56, v57
    s_waitcnt vmcnt(0)
    v_min_u32 v122, v120, v121
    v_cmp_eq_u32 vcc, 0, v122
    s_cbranch_vccnz Lsf
Lrf:
    s_setprio 3
    s_barrier
    s_mov_b32 s28, 221184
    buffer_load_dwordx4 a[144:147], v2, s[12:15], s28 offen offset:0 sc1
    s_mov_b32 s36, 248832
    buffer_load_dwordx4 a[148:151], v2, s[12:15], s36 offen offset:0 sc1
    s_setprio 2
    buffer_load_dwordx4 a[152:155], v2, s[12:15], s36 offen offset:1024 sc1
    buffer_load_dwordx4 a[156:159], v2, s[12:15], s28 offen offset:1024 sc1
    s_setprio 1
    buffer_load_dwordx4 a[160:163], v2, s[12:15], s28 offen offset:2048 sc1
    buffer_load_dwordx4 a[164:167], v2, s[12:15], s36 offen offset:2048 sc1
    s_setprio 0
    s_waitcnt vmcnt(5)
    v_mfma_f32_16x16x32_bf16 a[0:3], v[68:71], a[144:147], 0
    s_waitcnt vmcnt(4)
    s_mov_b32 s37, 276480
    v_mfma_f32_16x16x32_bf16 a[0:3], v[72:75], a[148:151], a[0:3]
    buffer_load_dwordx4 a[168:171], v2, s[12:15], s37 offen offset:0 sc1
    v_mfma_f32_16x16x32_bf16 a[4:7], v[72:75], a[144:147], 0
    ds_read_b128 v[48:51], v10 offset:15136
    v_mfma_f32_16x16x32_bf16 a[4:7], v[76:79], a[148:151], a[4:7]
    ds_read_b128 v[52:55], v12 offset:15136
    v_mfma_f32_16x16x32_bf16 a[8:11], v[76:79], a[144:147], 0
    s_mov_b32 s28, 304128
    v_mfma_f32_16x16x32_bf16 a[8:11], v[80:83], a[148:151], a[8:11]
    buffer_load_dwordx4 a[172:175], v2, s[12:15], s28 offen offset:0 sc1
    v_mfma_f32_16x16x32_bf16 a[12:15], v[80:83], a[144:147], 0
    v_mfma_f32_16x16x32_bf16 a[12:15], v[84:87], a[148:151], a[12:15]
    ds_read_b128 v[100:103], v5 offset:1152
    v_mfma_f32_16x16x32_bf16 a[16:19], v[84:87], a[144:147], 0
    v_mfma_f32_16x16x32_bf16 a[16:19], v[88:91], a[148:151], a[16:19]
    s_waitcnt lgkmcnt(2)
    v_lshlrev_b32 v40, 16, v48
    v_and_b32 v41, s84, v48
    v_mfma_f32_16x16x32_bf16 a[20:23], v[88:91], a[144:147], 0
    buffer_load_dwordx4 a[176:179], v2, s[12:15], s28 offen offset:1024 sc1
    v_mfma_f32_16x16x32_bf16 a[20:23], v[92:95], a[148:151], a[20:23]
    s_waitcnt vmcnt(6) lgkmcnt(1)
    ds_read_b128 v[56:59], v6 offset:15136
    v_lshlrev_b32 v42, 16, v52
    v_mfma_f32_16x16x32_bf16 a[44:47], v[92:95], a[152:155], 0
    s_waitcnt vmcnt(5)
    ds_read_b128 v[60:63], v8 offset:15136
    v_and_b32 v43, s84, v52
    v_mfma_f32_16x16x32_bf16 a[44:47], v[88:91], a[156:159], a[44:47]
    v_add_f32 v40, v40, v42
    v_add_f32 v41, v41, v43
    v_mfma_f32_16x16x32_bf16 a[40:43], v[88:91], a[152:155], 0
    v_lshlrev_b32 v44, 16, v49
    v_and_b32 v45, s84, v49
    v_mfma_f32_16x16x32_bf16 a[40:43], v[84:87], a[156:159], a[40:43]
    buffer_load_dwordx4 a[180:183], v2, s[12:15], s37 offen offset:1024 sc1
    v_mfma_f32_16x16x32_bf16 a[36:39], v[84:87], a[152:155], 0
    v_lshlrev_b32 v46, 16, v53
    v_and_b32 v47, s84, v53
    v_mfma_f32_16x16x32_bf16 a[36:39], v[80:83], a[156:159], a[36:39]
    v_add_f32 v44, v44, v46
    v_mfma_f32_16x16x32_bf16 a[32:35], v[80:83], a[152:155], 0
    v_add_f32 v45, v45, v47
    v_mfma_f32_16x16x32_bf16 a[32:35], v[76:79], a[156:159], a[32:35]
    v_cvt_pk_bf16_f32 v64, v40, v41
    v_mfma_f32_16x16x32_bf16 a[28:31], v[76:79], a[152:155], 0
    buffer_load_dwordx4 a[184:187], v2, s[12:15], s37 offen offset:2048 sc1
    v_mfma_f32_16x16x32_bf16 a[28:31], v[72:75], a[156:159], a[28:31]
    v_cvt_pk_bf16_f32 v65, v44, v45
    v_lshlrev_b32 v40, 16, v50
    v_mfma_f32_16x16x32_bf16 a[24:27], v[72:75], a[152:155], 0
    v_mfma_f32_16x16x32_bf16 a[24:27], v[68:71], a[156:159], a[24:27]
    s_waitcnt vmcnt(6)
    v_and_b32 v41, s84, v50
    v_mfma_f32_16x16x32_bf16 a[48:51], v[68:71], a[160:163], 0
    s_waitcnt vmcnt(5)
    v_lshlrev_b32 v42, 16, v54
    v_mfma_f32_16x16x32_bf16 a[48:51], v[72:75], a[164:167], a[48:51]
    buffer_load_dwordx4 a[188:191], v2, s[12:15], s28 offen offset:2048 sc1
    v_mfma_f32_16x16x32_bf16 a[52:55], v[72:75], a[160:163], 0
    v_and_b32 v43, s84, v54
    v_add_f32 v40, v40, v42
    v_mfma_f32_16x16x32_bf16 a[52:55], v[76:79], a[164:167], a[52:55]
    v_add_f32 v41, v41, v43
    v_mfma_f32_16x16x32_bf16 a[56:59], v[76:79], a[160:163], 0
    v_lshlrev_b32 v44, 16, v51
    v_mfma_f32_16x16x32_bf16 a[56:59], v[80:83], a[164:167], a[56:59]
    s_mov_b32 s36, 331776
    v_and_b32 v45, s84, v51
    v_mfma_f32_16x16x32_bf16 a[60:63], v[80:83], a[160:163], 0
    buffer_load_dwordx4 a[192:195], v2, s[12:15], s36 offen offset:0 sc1
    v_mfma_f32_16x16x32_bf16 a[60:63], v[84:87], a[164:167], a[60:63]
    v_lshlrev_b32 v46, 16, v55
    v_and_b32 v47, s84, v55
    v_mfma_f32_16x16x32_bf16 a[64:67], v[84:87], a[160:163], 0
    v_mfma_f32_16x16x32_bf16 a[64:67], v[88:91], a[164:167], a[64:67]
    s_mov_b32 s37, 359424
    v_add_f32 v44, v44, v46
    v_mfma_f32_16x16x32_bf16 a[68:71], v[88:91], a[160:163], 0
    buffer_load_dwordx4 a[196:199], v2, s[12:15], s37 offen offset:0 sc1
    v_mfma_f32_16x16x32_bf16 a[68:71], v[92:95], a[164:167], a[68:71]
    s_waitcnt vmcnt(7)
    v_add_f32 v45, v45, v47
    v_cvt_pk_bf16_f32 v66, v40, v41
    v_mfma_f32_16x16x32_bf16 a[0:3], v[76:79], a[168:171], a[0:3]
    s_waitcnt vmcnt(6)
    v_cvt_pk_bf16_f32 v67, v44, v45
    v_mfma_f32_16x16x32_bf16 a[0:3], v[80:83], a[172:175], a[0:3]
    s_waitcnt lgkmcnt(1)
    v_lshlrev_b32 v40, 16, v56
    v_mfma_f32_16x16x32_bf16 a[4:7], v[80:83], a[168:171], a[4:7]
    v_and_b32 v41, s84, v56
    v_mfma_f32_16x16x32_bf16 a[4:7], v[84:87], a[172:175], a[4:7]
    buffer_load_dwordx4 a[200:203], v2, s[12:15], s37 offen offset:1024 sc1
    v_mfma_f32_16x16x32_bf16 a[8:11], v[84:87], a[168:171], a[8:11]
    s_waitcnt lgkmcnt(0)
    ds_read_b128 v[48:51], v6 offset:15280
    v_lshlrev_b32 v42, 16, v60
    v_mfma_f32_16x16x32_bf16 a[8:11], v[88:91], a[172:175], a[8:11]
    ds_read_b128 v[104:107], v5 offset:1296
    ds_read_b128 v[52:55], v8 offset:15280
    v_mfma_f32_16x16x32_bf16 a[12:15], v[88:91], a[168:171], a[12:15]
    v_mfma_f32_16x16x32_bf16 a[12:15], v[92:95], a[172:175], a[12:15]
    ds_read_b128 v[108:111], v5 offset:1440
    v_and_b32 v43, s84, v60
    v_mfma_f32_16x16x32_bf16 a[16:19], v[92:95], a[168:171], a[16:19]
    buffer_load_dwordx4 a[204:207], v2, s[12:15], s36 offen offset:1024 sc1
    v_mfma_f32_16x16x32_bf16 a[16:19], v[96:99], a[172:175], a[16:19]
    v_add_f32 v40, v40, v42
    v_add_f32 v41, v41, v43
    v_mfma_f32_16x16x32_bf16 a[20:23], v[96:99], a[168:171], a[20:23]
    v_lshlrev_b32 v44, 16, v57
    v_mfma_f32_16x16x32_bf16 a[20:23], v[100:103], a[172:175], a[20:23]
    s_waitcnt vmcnt(7)
    v_and_b32 v45, s84, v57
    v_mfma_f32_16x16x32_bf16 a[44:47], v[100:103], a[176:179], a[44:47]
    s_waitcnt vmcnt(6)
    v_lshlrev_b32 v46, 16, v61
    v_mfma_f32_16x16x32_bf16 a[44:47], v[96:99], a[180:183], a[44:47]
    buffer_load_dwordx4 a[208:211], v2, s[12:15], s36 offen offset:2048 sc1
    v_mfma_f32_16x16x32_bf16 a[40:43], v[96:99], a[176:179], a[40:43]
    v_and_b32 v47, s84, v61
    v_add_f32 v44, v44, v46
    v_mfma_f32_16x16x32_bf16 a[40:43], v[92:95], a[180:183], a[40:43]
    v_add_f32 v45, v45, v47
    v_mfma_f32_16x16x32_bf16 a[36:39], v[92:95], a[176:179], a[36:39]
    v_mfma_f32_16x16x32_bf16 a[36:39], v[88:91], a[180:183], a[36:39]
    v_cvt_pk_bf16_f32 v120, v40, v41
    v_mfma_f32_16x16x32_bf16 a[32:35], v[88:91], a[176:179], a[32:35]
    buffer_load_dwordx4 a[212:215], v2, s[12:15], s37 offen offset:2048 sc1
    v_mfma_f32_16x16x32_bf16 a[32:35], v[84:87], a[180:183], a[32:35]
    v_cvt_pk_bf16_f32 v121, v44, v45
    v_lshlrev_b32 v40, 16, v58
    v_mfma_f32_16x16x32_bf16 a[28:31], v[84:87], a[176:179], a[28:31]
    v_and_b32 v41, s84, v58
    v_mfma_f32_16x16x32_bf16 a[28:31], v[80:83], a[180:183], a[28:31]
    s_add_u32 s29, s83, 8960
    v_lshlrev_b32 v42, 16, v62
    v_mfma_f32_16x16x32_bf16 a[24:27], v[80:83], a[176:179], a[24:27]
    s_mov_b32 s28, 387072
    s_add_u32 m0, s55, 106960
    v_and_b32 v43, s84, v62
    v_mfma_f32_16x16x32_bf16 a[24:27], v[76:79], a[180:183], a[24:27]
    s_waitcnt vmcnt(7)
    buffer_load_dwordx4 a[216:219], v2, s[12:15], s28 offen offset:0 sc1
    v_mfma_f32_16x16x32_bf16 a[48:51], v[76:79], a[184:187], a[48:51]
    s_waitcnt vmcnt(7)
    buffer_load_dwordx4 v4, s[8:11], s29 offen  lds
    v_mfma_f32_16x16x32_bf16 a[48:51], v[80:83], a[188:191], a[48:51]
    v_add_f32 v40, v40, v42
    v_add_f32 v41, v41, v43
    v_mfma_f32_16x16x32_bf16 a[52:55], v[80:83], a[184:187], a[52:55]
    v_lshlrev_b32 v44, 16, v59
    v_and_b32 v45, s84, v59
    v_mfma_f32_16x16x32_bf16 a[52:55], v[84:87], a[188:191], a[52:55]
    s_mov_b32 s36, 414720
    v_mfma_f32_16x16x32_bf16 a[56:59], v[84:87], a[184:187], a[56:59]
    buffer_load_dwordx4 a[220:223], v2, s[12:15], s36 offen offset:0 sc1
    v_mfma_f32_16x16x32_bf16 a[56:59], v[88:91], a[188:191], a[56:59]
    v_lshlrev_b32 v46, 16, v63
    v_and_b32 v47, s84, v63
    v_mfma_f32_16x16x32_bf16 a[60:63], v[88:91], a[184:187], a[60:63]
    v_add_f32 v44, v44, v46
    v_mfma_f32_16x16x32_bf16 a[60:63], v[92:95], a[188:191], a[60:63]
    v_add_f32 v45, v45, v47
    v_mfma_f32_16x16x32_bf16 a[64:67], v[92:95], a[184:187], a[64:67]
    buffer_load_dwordx4 a[224:227], v2, s[12:15], s36 offen offset:1024 sc1
    v_mfma_f32_16x16x32_bf16 a[64:67], v[96:99], a[188:191], a[64:67]
    v_cvt_pk_bf16_f32 v122, v40, v41
    v_cvt_pk_bf16_f32 v123, v44, v45
    v_mfma_f32_16x16x32_bf16 a[68:71], v[96:99], a[184:187], a[68:71]
    s_waitcnt lgkmcnt(3)
    v_lshlrev_b32 v40, 16, v48
    v_mfma_f32_16x16x32_bf16 a[68:71], v[100:103], a[188:191], a[68:71]
    s_waitcnt vmcnt(9)
    v_and_b32 v41, s84, v48
    v_mfma_f32_16x16x32_bf16 a[0:3], v[84:87], a[192:195], a[0:3]
    s_waitcnt vmcnt(8) lgkmcnt(1)
    v_lshlrev_b32 v42, 16, v52
    v_mfma_f32_16x16x32_bf16 a[0:3], v[88:91], a[196:199], a[0:3]
    buffer_load_dwordx4 a[228:231], v2, s[12:15], s28 offen offset:1024 sc1
    v_mfma_f32_16x16x32_bf16 a[4:7], v[88:91], a[192:195], a[4:7]
    ds_read_b128 v[56:59], v6 offset:15424
    v_mfma_f32_16x16x32_bf16 a[4:7], v[92:95], a[196:199], a[4:7]
    ds_read_b128 v[60:63], v8 offset:15424
    v_mfma_f32_16x16x32_bf16 a[8:11], v[92:95], a[192:195], a[8:11]
    v_and_b32 v43, s84, v52
    v_mfma_f32_16x16x32_bf16 a[8:11], v[96:99], a[196:199], a[8:11]
    ds_read_b128 v[112:115], v5 offset:1584
    v_add_f32 v40, v40, v42
    v_mfma_f32_16x16x32_bf16 a[12:15], v[96:99], a[192:195], a[12:15]
    buffer_load_dwordx4 a[232:235], v2, s[12:15], s28 offen offset:2048 sc1
    v_mfma_f32_16x16x32_bf16 a[12:15], v[100:103], a[196:199], a[12:15]
    ds_read_b128 v[68:71], v5 offset:1728
    v_add_f32 v41, v41, v43
    v_mfma_f32_16x16x32_bf16 a[16:19], v[100:103], a[192:195], a[16:19]
    v_lshlrev_b32 v44, 16, v49
    v_and_b32 v45, s84, v49
    v_mfma_f32_16x16x32_bf16 a[16:19], v[104:107], a[196:199], a[16:19]
    v_lshlrev_b32 v46, 16, v53
    v_mfma_f32_16x16x32_bf16 a[20:23], v[104:107], a[192:195], a[20:23]
    s_waitcnt lgkmcnt(4)
    v_and_b32 v47, s84, v53
    v_mfma_f32_16x16x32_bf16 a[20:23], v[108:111], a[196:199], a[20:23]
    s_waitcnt vmcnt(9)
    buffer_load_dwordx4 a[236:239], v2, s[12:15], s36 offen offset:2048 sc1
    v_mfma_f32_16x16x32_bf16 a[44:47], v[108:111], a[200:203], a[44:47]
    s_waitcnt vmcnt(9)
    v_add_f32 v44, v44, v46
    v_mfma_f32_16x16x32_bf16 a[44:47], v[104:107], a[204:207], a[44:47]
    v_add_f32 v45, v45, v47
    v_mfma_f32_16x16x32_bf16 a[40:43], v[104:107], a[200:203], a[40:43]
    v_cvt_pk_bf16_f32 v124, v40, v41
    v_mfma_f32_16x16x32_bf16 a[40:43], v[100:103], a[204:207], a[40:43]
    s_mov_b32 s37, 227328
    s_add_u32 s29, s83, 25088
    v_cvt_pk_bf16_f32 v125, v44, v45
    v_mfma_f32_16x16x32_bf16 a[36:39], v[100:103], a[200:203], a[36:39]
    buffer_load_dwordx4 a[240:243], v2, s[12:15], s37 offen offset:0 sc1
    v_mfma_f32_16x16x32_bf16 a[36:39], v[96:99], a[204:207], a[36:39]
    s_add_u32 m0, s55, 108976
    v_lshlrev_b32 v40, 16, v50
    v_and_b32 v41, s84, v50
    v_mfma_f32_16x16x32_bf16 a[32:35], v[96:99], a[200:203], a[32:35]
    buffer_load_dwordx4 v4, s[8:11], s29 offen  lds
    v_mfma_f32_16x16x32_bf16 a[32:35], v[92:95], a[204:207], a[32:35]
    v_lshlrev_b32 v42, 16, v54
    v_and_b32 v43, s84, v54
    v_mfma_f32_16x16x32_bf16 a[28:31], v[92:95], a[200:203], a[28:31]
    s_mov_b32 s28, 254976
    v_add_f32 v40, v40, v42
    v_mfma_f32_16x16x32_bf16 a[28:31], v[88:91], a[204:207], a[28:31]
    buffer_load_dwordx4 a[244:247], v2, s[12:15], s28 offen offset:0 sc1
    v_mfma_f32_16x16x32_bf16 a[24:27], v[88:91], a[200:203], a[24:27]
    v_add_f32 v41, v41, v43
    v_mfma_f32_16x16x32_bf16 a[24:27], v[84:87], a[204:207], a[24:27]
    s_waitcnt vmcnt(11)
    v_lshlrev_b32 v44, 16, v51
    v_mfma_f32_16x16x32_bf16 a[48:51], v[84:87], a[208:211], a[48:51]
    s_waitcnt vmcnt(10)
    v_and_b32 v45, s84, v51
    v_mfma_f32_16x16x32_bf16 a[48:51], v[88:91], a[212:215], a[48:51]
    v_lshlrev_b32 v46, 16, v55
    v_mfma_f32_16x16x32_bf16 a[52:55], v[88:91], a[208:211], a[52:55]
    buffer_load_dwordx4 a[248:251], v2, s[12:15], s28 offen offset:1024 sc1
    v_mfma_f32_16x16x32_bf16 a[52:55], v[92:95], a[212:215], a[52:55]
    v_and_b32 v47, s84, v55
    v_add_f32 v44, v44, v46
    v_mfma_f32_16x16x32_bf16 a[56:59], v[92:95], a[208:211], a[56:59]
    v_add_f32 v45, v45, v47
    v_mfma_f32_16x16x32_bf16 a[56:59], v[96:99], a[212:215], a[56:59]
    v_cvt_pk_bf16_f32 v126, v40, v41
    v_mfma_f32_16x16x32_bf16 a[60:63], v[96:99], a[208:211], a[60:63]
    v_cvt_pk_bf16_f32 v127, v44, v45
    v_mfma_f32_16x16x32_bf16 a[60:63], v[100:103], a[212:215], a[60:63]
    v_mfma_f32_16x16x32_bf16 a[64:67], v[100:103], a[208:211], a[64:67]
    buffer_load_dwordx4 a[252:255], v2, s[12:15], s37 offen offset:1024 sc1
    v_mfma_f32_16x16x32_bf16 a[64:67], v[104:107], a[212:215], a[64:67]
    s_waitcnt lgkmcnt(3)
    ds_read_b128 v[72:75], v5 offset:15136
    v_lshlrev_b32 v40, 16, v56
    v_mfma_f32_16x16x32_bf16 a[68:71], v[104:107], a[208:211], a[68:71]
    s_waitcnt lgkmcnt(3)
    v_and_b32 v41, s84, v56
    v_lshlrev_b32 v42, 16, v60
    v_mfma_f32_16x16x32_bf16 a[68:71], v[108:111], a[212:215], a[68:71]
    s_waitcnt vmcnt(11)
    ds_read_b128 v[76:79], v5 offset:15280
    ds_read_b128 v[48:51], v6 offset:15568
    v_mfma_f32_16x16x32_bf16 a[0:3], v[92:95], a[216:219], a[0:3]
    s_waitcnt vmcnt(9)
    ds_read_b128 v[52:55], v8 offset:15568
    v_mfma_f32_16x16x32_bf16 a[0:3], v[96:99], a[220:223], a[0:3]
    ds_read_b128 v[80:83], v5 offset:15424
    v_and_b32 v43, s84, v60
    v_mfma_f32_16x16x32_bf16 a[4:7], v[96:99], a[216:219], a[4:7]
    buffer_load_dwordx4 a[144:147], v2, s[12:15], s37 offen offset:2048 sc1
    v_mfma_f32_16x16x32_bf16 a[4:7], v[100:103], a[220:223], a[4:7]
    ds_read_b128 v[84:87], v5 offset:15568
    v_add_f32 v40, v40, v42
    v_mfma_f32_16x16x32_bf16 a[8:11], v[100:103], a[216:219], a[8:11]
    v_add_f32 v41, v41, v43
    v_lshlrev_b32 v44, 16, v57
    v_mfma_f32_16x16x32_bf16 a[8:11], v[104:107], a[220:223], a[8:11]
    ds_read_b128 v[88:91], v5 offset:15712
    v_mfma_f32_16x16x32_bf16 a[12:15], v[104:107], a[216:219], a[12:15]
    v_and_b32 v45, s84, v57
    v_mfma_f32_16x16x32_bf16 a[12:15], v[108:111], a[220:223], a[12:15]
    v_lshlrev_b32 v46, 16, v61
    v_mfma_f32_16x16x32_bf16 a[16:19], v[108:111], a[216:219], a[16:19]
    s_waitcnt lgkmcnt(8)
    buffer_load_dwordx4 a[148:151], v2, s[12:15], s28 offen offset:2048 sc1
    v_mfma_f32_16x16x32_bf16 a[16:19], v[112:115], a[220:223], a[16:19]
    v_and_b32 v47, s84, v61
    v_add_f32 v44, v44, v46
    v_mfma_f32_16x16x32_bf16 a[20:23], v[112:115], a[216:219], a[20:23]
    s_waitcnt lgkmcnt(7)
    s_add_u32 s29, s83, 384
    v_add_f32 v45, v45, v47
    v_mfma_f32_16x16x32_bf16 a[20:23], v[68:71], a[220:223], a[20:23]
    s_waitcnt vmcnt(10)
    s_add_u32 m0, s55, 45408
    v_cvt_pk_bf16_f32 v128, v40, v41
    v_mfma_f32_16x16x32_bf16 a[44:47], v[68:71], a[224:227], a[44:47]
    s_waitcnt vmcnt(9)
    buffer_load_dwordx4 v4, s[8:11], s29 offen  lds
    v_mfma_f32_16x16x32_bf16 a[44:47], v[112:115], a[228:231], a[44:47]
    s_mov_b32 s36, 282624
    v_cvt_pk_bf16_f32 v129, v44, v45
    v_lshlrev_b32 v40, 16, v58
    v_mfma_f32_16x16x32_bf16 a[40:43], v[112:115], a[224:227], a[40:43]
    buffer_load_dwordx4 a[152:155], v2, s[12:15], s36 offen offset:0 sc1
    v_mfma_f32_16x16x32_bf16 a[40:43], v[108:111], a[228:231], a[40:43]
    v_and_b32 v41, s84, v58
    v_lshlrev_b32 v42, 16, v62
    v_mfma_f32_16x16x32_bf16 a[36:39], v[108:111], a[224:227], a[36:39]
    v_mfma_f32_16x16x32_bf16 a[36:39], v[104:107], a[228:231], a[36:39]
    v_and_b32 v43, s84, v62
    v_mfma_f32_16x16x32_bf16 a[32:35], v[104:107], a[224:227], a[32:35]
    v_add_f32 v40, v40, v42
    v_mfma_f32_16x16x32_bf16 a[32:35], v[100:103], a[228:231], a[32:35]
    s_mov_b32 s37, 310272
    v_add_f32 v41, v41, v43
    v_mfma_f32_16x16x32_bf16 a[28:31], v[100:103], a[224:227], a[28:31]
    buffer_load_dwordx4 a[156:159], v2, s[12:15], s37 offen offset:0 sc1
    v_mfma_f32_16x16x32_bf16 a[28:31], v[96:99], a[228:231], a[28:31]
    v_lshlrev_b32 v44, 16, v59
    v_and_b32 v45, s84, v59
    v_mfma_f32_16x16x32_bf16 a[24:27], v[96:99], a[224:227], a[24:27]
    v_lshlrev_b32 v46, 16, v63
    v_mfma_f32_16x16x32_bf16 a[24:27], v[92:95], a[228:231], a[24:27]
    s_waitcnt vmcnt(11)
    v_and_b32 v47, s84, v63
    v_mfma_f32_16x16x32_bf16 a[48:51], v[92:95], a[232:235], a[48:51]
    s_waitcnt vmcnt(10)
    ds_read_b128 v[92:95], v5 offset:15856
    v_add_f32 v44, v44, v46
    v_mfma_f32_16x16x32_bf16 a[48:51], v[96:99], a[236:239], a[48:51]
    v_add_f32 v45, v45, v47
    v_mfma_f32_16x16x32_bf16 a[52:55], v[96:99], a[232:235], a[52:55]
    buffer_load_dwordx4 a[160:163], v2, s[12:15], s37 offen offset:1024 sc1
    v_mfma_f32_16x16x32_bf16 a[52:55], v[100:103], a[236:239], a[52:55]
    ds_read_b128 v[96:99], v5 offset:16000
    v_cvt_pk_bf16_f32 v130, v40, v41
    v_mfma_f32_16x16x32_bf16 a[56:59], v[100:103], a[232:235], a[56:59]
    v_cvt_pk_bf16_f32 v131, v44, v45
    v_mfma_f32_16x16x32_bf16 a[56:59], v[104:107], a[236:239], a[56:59]
    s_waitcnt lgkmcnt(6)
    v_lshlrev_b32 v40, 16, v48
    v_mfma_f32_16x16x32_bf16 a[60:63], v[104:107], a[232:235], a[60:63]
    v_and_b32 v41, s84, v48
    v_mfma_f32_16x16x32_bf16 a[60:63], v[108:111], a[236:239], a[60:63]
    s_waitcnt lgkmcnt(5)
    v_lshlrev_b32 v42, 16, v52
    v_mfma_f32_16x16x32_bf16 a[64:67], v[108:111], a[232:235], a[64:67]
    buffer_load_dwordx4 a[164:167], v2, s[12:15], s36 offen offset:1024 sc1
    v_mfma_f32_16x16x32_bf16 a[64:67], v[112:115], a[236:239], a[64:67]
    ds_read_b128 v[56:59], v6 offset:15712
    ds_read_b128 v[60:63], v8 offset:15712
    v_mfma_f32_16x16x32_bf16 a[68:71], v[112:115], a[232:235], a[68:71]
    v_and_b32 v43, s84, v52
    v_mfma_f32_16x16x32_bf16 a[68:71], v[68:71], a[236:239], a[68:71]
    s_waitcnt vmcnt(11)
    v_add_f32 v40, v40, v42
    v_mfma_f32_16x16x32_bf16 a[0:3], v[72:75], a[240:243], a[0:3]
    s_waitcnt vmcnt(9)
    v_mfma_f32_16x16x32_bf16 a[0:3], v[76:79], a[244:247], a[0:3]
    v_add_f32 v41, v41, v43
    v_mfma_f32_16x16x32_bf16 a[4:7], v[76:79], a[240:243], a[4:7]
    s_waitcnt lgkmcnt(6)
    buffer_load_dwordx4 a[168:171], v2, s[12:15], s36 offen offset:2048 sc1
    v_mfma_f32_16x16x32_bf16 a[4:7], v[80:83], a[244:247], a[4:7]
    v_lshlrev_b32 v44, 16, v49
    v_and_b32 v45, s84, v49
    v_mfma_f32_16x16x32_bf16 a[8:11], v[80:83], a[240:243], a[8:11]
    s_waitcnt lgkmcnt(5)
    s_add_u32 s29, s83, 16512
    v_lshlrev_b32 v46, 16, v53
    v_mfma_f32_16x16x32_bf16 a[8:11], v[84:87], a[244:247], a[8:11]
    s_add_u32 m0, s55, 47424
    ds_read_b128 v[100:103], v5 offset:16144
    v_and_b32 v47, s84, v53
    v_mfma_f32_16x16x32_bf16 a[12:15], v[84:87], a[240:243], a[12:15]
    s_waitcnt lgkmcnt(5)
    buffer_load_dwordx4 v4, s[8:11], s29 offen  lds
    v_mfma_f32_16x16x32_bf16 a[12:15], v[88:91], a[244:247], a[12:15]
Lt7:
    s_cbranch_execz Lpr1
    ds_read_b128 v[104:107], v5 offset:16288
    v_add_f32 v44, v44, v46
    v_mfma_f32_16x16x32_bf16 a[16:19], v[88:91], a[240:243], a[16:19]
    s_waitcnt lgkmcnt(5)
    buffer_load_dwordx4 a[172:175], v2, s[12:15], s37 offen offset:2048 sc1
    v_mfma_f32_16x16x32_bf16 a[16:19], v[92:95], a[244:247], a[16:19]
    v_add_f32 v45, v45, v47
    v_cvt_pk_bf16_f32 v132, v40, v41
    v_mfma_f32_16x16x32_bf16 a[20:23], v[92:95], a[240:243], a[20:23]
    s_waitcnt lgkmcnt(4)
    v_cvt_pk_bf16_f32 v133, v44, v45
    v_mfma_f32_16x16x32_bf16 a[20:23], v[96:99], a[244:247], a[20:23]
    s_waitcnt vmcnt(11)
    v_lshlrev_b32 v40, 16, v50
    v_mfma_f32_16x16x32_bf16 a[44:47], v[96:99], a[248:251], a[44:47]
    s_waitcnt vmcnt(10)
    v_and_b32 v41, s84, v50
    v_mfma_f32_16x16x32_bf16 a[44:47], v[92:95], a[252:255], a[44:47]
    s_mov_b32 s28, 337920
    v_lshlrev_b32 v42, 16, v54
    v_mfma_f32_16x16x32_bf16 a[40:43], v[92:95], a[248:251], a[40:43]
    buffer_load_dwordx4 a[176:179], v2, s[12:15], s28 offen offset:0 sc1
    v_mfma_f32_16x16x32_bf16 a[40:43], v[88:91], a[252:255], a[40:43]
    v_and_b32 v43, s84, v54
    v_add_f32 v40, v40, v42
    v_mfma_f32_16x16x32_bf16 a[36:39], v[88:91], a[248:251], a[36:39]
    v_add_f32 v41, v41, v43
    v_mfma_f32_16x16x32_bf16 a[36:39], v[84:87], a[252:255], a[36:39]
    v_lshlrev_b32 v44, 16, v51
    v_mfma_f32_16x16x32_bf16 a[32:35], v[84:87], a[248:251], a[32:35]
    v_and_b32 v45, s84, v51
    v_mfma_f32_16x16x32_bf16 a[32:35], v[80:83], a[252:255], a[32:35]
    s_mov_b32 s36, 365568
    v_lshlrev_b32 v46, 16, v55
    v_mfma_f32_16x16x32_bf16 a[28:31], v[80:83], a[248:251], a[28:31]
    buffer_load_dwordx4 a[180:183], v2, s[12:15], s36 offen offset:0 sc1
    v_mfma_f32_16x16x32_bf16 a[28:31], v[76:79], a[252:255], a[28:31]
    v_and_b32 v47, s84, v55
    v_mfma_f32_16x16x32_bf16 a[24:27], v[76:79], a[248:251], a[24:27]
    v_add_f32 v44, v44, v46
    v_mfma_f32_16x16x32_bf16 a[24:27], v[72:75], a[252:255], a[24:27]
    s_waitcnt vmcnt(11)
    v_add_f32 v45, v45, v47
    v_mfma_f32_16x16x32_bf16 a[48:51], v[72:75], a[144:147], a[48:51]
    s_waitcnt vmcnt(10)
    v_cvt_pk_bf16_f32 v134, v40, v41
    v_mfma_f32_16x16x32_bf16 a[48:51], v[76:79], a[148:151], a[48:51]
    v_cvt_pk_bf16_f32 v135, v44, v45
    v_mfma_f32_16x16x32_bf16 a[52:55], v[76:79], a[144:147], a[52:55]
    buffer_load_dwordx4 a[184:187], v2, s[12:15], s36 offen offset:1024 sc1
    v_mfma_f32_16x16x32_bf16 a[52:55], v[80:83], a[148:151], a[52:55]
    s_waitcnt lgkmcnt(3)
    v_lshlrev_b32 v40, 16, v56
    v_and_b32 v41, s84, v56
    v_mfma_f32_16x16x32_bf16 a[56:59], v[80:83], a[144:147], a[56:59]
    s_waitcnt lgkmcnt(2)
    v_lshlrev_b32 v42, 16, v60
    v_mfma_f32_16x16x32_bf16 a[56:59], v[84:87], a[148:151], a[56:59]
    ds_read_b128 v[48:51], v6 offset:15856
    v_mfma_f32_16x16x32_bf16 a[60:63], v[84:87], a[144:147], a[60:63]
    v_mfma_f32_16x16x32_bf16 a[60:63], v[88:91], a[148:151], a[60:63]
    ds_read_b128 v[52:55], v8 offset:15856
    v_mfma_f32_16x16x32_bf16 a[64:67], v[88:91], a[144:147], a[64:67]
    buffer_load_dwordx4 a[188:191], v2, s[12:15], s28 offen offset:1024 sc1
    v_mfma_f32_16x16x32_bf16 a[64:67], v[92:95], a[148:151], a[64:67]
    v_and_b32 v43, s84, v60
    v_add_f32 v40, v40, v42
    v_mfma_f32_16x16x32_bf16 a[68:71], v[92:95], a[144:147], a[68:71]
    s_add_u32 s29, s83, 32640
    v_add_f32 v41, v41, v43
    v_mfma_f32_16x16x32_bf16 a[68:71], v[96:99], a[148:151], a[68:71]
    s_waitcnt vmcnt(10)
    s_add_u32 m0, s55, 49440
    v_lshlrev_b32 v44, 16, v57
    v_mfma_f32_16x16x32_bf16 a[0:3], v[80:83], a[152:155], a[0:3]
    s_waitcnt vmcnt(9)
    buffer_load_dwordx4 v4, s[8:11], s29 offen  lds
    v_mfma_f32_16x16x32_bf16 a[0:3], v[84:87], a[156:159], a[0:3]
    v_and_b32 v45, s84, v57
    v_lshlrev_b32 v46, 16, v61
    v_mfma_f32_16x16x32_bf16 a[4:7], v[84:87], a[152:155], a[4:7]
    buffer_load_dwordx4 a[192:195], v2, s[12:15], s28 offen offset:2048 sc1
    v_mfma_f32_16x16x32_bf16 a[4:7], v[88:91], a[156:159], a[4:7]
    v_and_b32 v47, s84, v61
    v_add_f32 v44, v44, v46
    v_mfma_f32_16x16x32_bf16 a[8:11], v[88:91], a[152:155], a[8:11]
    v_add_f32 v45, v45, v47
    v_mfma_f32_16x16x32_bf16 a[8:11], v[92:95], a[156:159], a[8:11]
    ds_read_b128 v[108:111], v5 offset:16432
    v_mfma_f32_16x16x32_bf16 a[12:15], v[92:95], a[152:155], a[12:15]
    v_cvt_pk_bf16_f32 v136, v40, v41
    v_mfma_f32_16x16x32_bf16 a[12:15], v[96:99], a[156:159], a[12:15]
    ds_read_b128 v[112:115], v5 offset:16576
    v_cvt_pk_bf16_f32 v137, v44, v45
    v_mfma_f32_16x16x32_bf16 a[16:19], v[96:99], a[152:155], a[16:19]
    s_waitcnt lgkmcnt(5)
    buffer_load_dwordx4 a[196:199], v2, s[12:15], s36 offen offset:2048 sc1
    v_mfma_f32_16x16x32_bf16 a[16:19], v[100:103], a[156:159], a[16:19]
    v_lshlrev_b32 v40, 16, v58
    v_and_b32 v41, s84, v58
    v_mfma_f32_16x16x32_bf16 a[20:23], v[100:103], a[152:155], a[20:23]
    s_waitcnt lgkmcnt(4)
    v_lshlrev_b32 v42, 16, v62
    v_mfma_f32_16x16x32_bf16 a[20:23], v[104:107], a[156:159], a[20:23]
    s_waitcnt vmcnt(11)
    v_and_b32 v43, s84, v62
    v_mfma_f32_16x16x32_bf16 a[44:47], v[104:107], a[160:163], a[44:47]
    s_waitcnt vmcnt(10)
    v_add_f32 v40, v40, v42
    v_mfma_f32_16x16x32_bf16 a[44:47], v[100:103], a[164:167], a[44:47]
    s_mov_b32 s37, 393216
    v_add_f32 v41, v41, v43
    v_mfma_f32_16x16x32_bf16 a[40:43], v[100:103], a[160:163], a[40:43]
    buffer_load_dwordx4 a[200:203], v2, s[12:15], s37 offen offset:0 sc1
    v_mfma_f32_16x16x32_bf16 a[40:43], v[96:99], a[164:167], a[40:43]
    v_lshlrev_b32 v44, 16, v59
    v_mfma_f32_16x16x32_bf16 a[36:39], v[96:99], a[160:163], a[36:39]
    v_and_b32 v45, s84, v59
    v_mfma_f32_16x16x32_bf16 a[36:39], v[92:95], a[164:167], a[36:39]
    v_lshlrev_b32 v46, 16, v63
    v_mfma_f32_16x16x32_bf16 a[32:35], v[92:95], a[160:163], a[32:35]
    v_and_b32 v47, s84, v63
    v_mfma_f32_16x16x32_bf16 a[32:35], v[88:91], a[164:167], a[32:35]
    s_mov_b32 s28, 420864
    v_add_f32 v44, v44, v46
    v_mfma_f32_16x16x32_bf16 a[28:31], v[88:91], a[160:163], a[28:31]
    buffer_load_dwordx4 a[204:207], v2, s[12:15], s28 offen offset:0 sc1
    v_mfma_f32_16x16x32_bf16 a[28:31], v[84:87], a[164:167], a[28:31]
    v_add_f32 v45, v45, v47
    v_cvt_pk_bf16_f32 v138, v40, v41
    v_mfma_f32_16x16x32_bf16 a[24:27], v[84:87], a[160:163], a[24:27]
    v_cvt_pk_bf16_f32 v139, v44, v45
    v_mfma_f32_16x16x32_bf16 a[24:27], v[80:83], a[164:167], a[24:27]
    s_waitcnt vmcnt(11) lgkmcnt(3)
    v_lshlrev_b32 v40, 16, v48
    v_mfma_f32_16x16x32_bf16 a[48:51], v[80:83], a[168:171], a[48:51]
    s_waitcnt vmcnt(9)
    v_and_b32 v41, s84, v48
    v_mfma_f32_16x16x32_bf16 a[48:51], v[84:87], a[172:175], a[48:51]
    v_mfma_f32_16x16x32_bf16 a[52:55], v[84:87], a[168:171], a[52:55]
    buffer_load_dwordx4 a[208:211], v2, s[12:15], s28 offen offset:1024 sc1
    v_mfma_f32_16x16x32_bf16 a[52:55], v[88:91], a[172:175], a[52:55]
    s_waitcnt lgkmcnt(2)
    v_lshlrev_b32 v42, 16, v52
    v_and_b32 v43, s84, v52
    v_mfma_f32_16x16x32_bf16 a[56:59], v[88:91], a[168:171], a[56:59]
    v_add_f32 v40, v40, v42
    v_mfma_f32_16x16x32_bf16 a[56:59], v[92:95], a[172:175], a[56:59]
    s_add_u32 m0, s55, 122096
    s_add_u32 s29, s83, 9088
    v_add_f32 v41, v41, v43
    v_mfma_f32_16x16x32_bf16 a[60:63], v[92:95], a[168:171], a[60:63]
    buffer_load_dwordx4 v4, s[8:11], s29 offen  lds
    v_mfma_f32_16x16x32_bf16 a[60:63], v[96:99], a[172:175], a[60:63]
    v_lshlrev_b32 v44, 16, v49
    v_and_b32 v45, s84, v49
    v_mfma_f32_16x16x32_bf16 a[64:67], v[96:99], a[168:171], a[64:67]
    buffer_load_dwordx4 a[212:215], v2, s[12:15], s37 offen offset:1024 sc1
    v_mfma_f32_16x16x32_bf16 a[64:67], v[100:103], a[172:175], a[64:67]
    v_lshlrev_b32 v46, 16, v53
    v_and_b32 v47, s84, v53
    v_mfma_f32_16x16x32_bf16 a[68:71], v[100:103], a[168:171], a[68:71]
    v_add_f32 v44, v44, v46
    v_mfma_f32_16x16x32_bf16 a[68:71], v[104:107], a[172:175], a[68:71]
    s_waitcnt vmcnt(11)
    v_mfma_f32_16x16x32_bf16 a[0:3], v[88:91], a[176:179], a[0:3]
    s_waitcnt vmcnt(10)
    v_add_f32 v45, v45, v47
    v_mfma_f32_16x16x32_bf16 a[0:3], v[92:95], a[180:183], a[0:3]
    v_cvt_pk_bf16_f32 v140, v40, v41
    v_mfma_f32_16x16x32_bf16 a[4:7], v[92:95], a[176:179], a[4:7]
    buffer_load_dwordx4 a[216:219], v2, s[12:15], s37 offen offset:2048 sc1
    v_mfma_f32_16x16x32_bf16 a[4:7], v[96:99], a[180:183], a[4:7]
    v_cvt_pk_bf16_f32 v141, v44, v45
    v_lshlrev_b32 v40, 16, v50
    v_mfma_f32_16x16x32_bf16 a[8:11], v[96:99], a[176:179], a[8:11]
    v_and_b32 v41, s84, v50
    v_mfma_f32_16x16x32_bf16 a[8:11], v[100:103], a[180:183], a[8:11]
    ds_read_b128 v[68:71], v5 offset:16720
    v_lshlrev_b32 v42, 16, v54
    v_mfma_f32_16x16x32_bf16 a[12:15], v[100:103], a[176:179], a[12:15]
    v_and_b32 v43, s84, v54
    v_mfma_f32_16x16x32_bf16 a[12:15], v[104:107], a[180:183], a[12:15]
    ds_read_b128 v[72:75], v5 offset:16864
    v_add_f32 v40, v40, v42
    v_mfma_f32_16x16x32_bf16 a[16:19], v[104:107], a[176:179], a[16:19]
    s_waitcnt lgkmcnt(3)
    buffer_load_dwordx4 a[220:223], v2, s[12:15], s28 offen offset:2048 sc1
    v_mfma_f32_16x16x32_bf16 a[16:19], v[108:111], a[180:183], a[16:19]
    v_add_f32 v41, v41, v43
    v_mfma_f32_16x16x32_bf16 a[20:23], v[108:111], a[176:179], a[20:23]
    s_waitcnt lgkmcnt(2)
    v_lshlrev_b32 v44, 16, v51
    v_mfma_f32_16x16x32_bf16 a[20:23], v[112:115], a[180:183], a[20:23]
    s_waitcnt vmcnt(11)
    v_and_b32 v45, s84, v51
    v_mfma_f32_16x16x32_bf16 a[44:47], v[112:115], a[184:187], a[44:47]
    s_waitcnt vmcnt(10)
    v_lshlrev_b32 v46, 16, v55
    v_mfma_f32_16x16x32_bf16 a[44:47], v[108:111], a[188:191], a[44:47]
    s_mov_b32 s36, 233472
    v_and_b32 v47, s84, v55
    v_mfma_f32_16x16x32_bf16 a[40:43], v[108:111], a[184:187], a[40:43]
    buffer_load_dwordx4 a[224:227], v35, s[12:15], s36 offen offset:0 sc1
    v_mfma_f32_16x16x32_bf16 a[40:43], v[104:107], a[188:191], a[40:43]
    v_add_f32 v44, v44, v46
    v_add_f32 v45, v45, v47
    v_mfma_f32_16x16x32_bf16 a[36:39], v[104:107], a[184:187], a[36:39]
    v_cvt_pk_bf16_f32 v142, v40, v41
    v_mfma_f32_16x16x32_bf16 a[36:39], v[100:103], a[188:191], a[36:39]
    v_cvt_pk_bf16_f32 v143, v44, v45
    v_mfma_f32_16x16x32_bf16 a[32:35], v[100:103], a[184:187], a[32:35]
    v_mov_b32_dpp v144, v64 row_shr:15 row_mask:0xf bank_mask:0xf
    v_mfma_f32_16x16x32_bf16 a[32:35], v[96:99], a[188:191], a[32:35]
    s_mov_b32 s37, 261120
    v_mfma_f32_16x16x32_bf16 a[28:31], v[96:99], a[184:187], a[28:31]
    buffer_load_dwordx4 a[228:231], v35, s[12:15], s37 offen offset:0 sc1
    v_mfma_f32_16x16x32_bf16 a[28:31], v[92:95], a[188:191], a[28:31]
    v_mov_b32_dpp v145, v65 row_shr:15 row_mask:0xf bank_mask:0xf
    v_mov_b32_dpp v146, v66 row_shr:15 row_mask:0xf bank_mask:0xf
    v_mfma_f32_16x16x32_bf16 a[24:27], v[92:95], a[184:187], a[24:27]
    s_add_u32 s29, s83, 25216
    v_mov_b32_dpp v147, v67 row_shr:15 row_mask:0xf bank_mask:0xf
    v_mfma_f32_16x16x32_bf16 a[24:27], v[88:91], a[188:191], a[24:27]
    s_waitcnt vmcnt(10)
    s_add_u32 m0, s55, 124112
    v_mov_b32_dpp v144, v120 row_shl:1 row_mask:0xf bank_mask:0xf
    v_mfma_f32_16x16x32_bf16 a[48:51], v[88:91], a[192:195], a[48:51]
    s_waitcnt vmcnt(9)
    buffer_load_dwordx4 v4, s[8:11], s29 offen  lds
    v_mfma_f32_16x16x32_bf16 a[48:51], v[92:95], a[196:199], a[48:51]
    v_mov_b32_dpp v145, v121 row_shl:1 row_mask:0xf bank_mask:0xf
    v_mov_b32_dpp v146, v122 row_shl:1 row_mask:0xf bank_mask:0xf
    v_mfma_f32_16x16x32_bf16 a[52:55], v[92:95], a[192:195], a[52:55]
    buffer_load_dwordx4 a[232:235], v35, s[12:15], s37 offen offset:1024 sc1
    v_mfma_f32_16x16x32_bf16 a[52:55], v[96:99], a[196:199], a[52:55]
    v_mov_b32_dpp v147, v123 row_shl:1 row_mask:0xf bank_mask:0xf
    v_mov_b32_dpp v148, v64 row_shr:14 row_mask:0xf bank_mask:0xf
    v_mfma_f32_16x16x32_bf16 a[56:59], v[96:99], a[192:195], a[56:59]
    v_mov_b32_dpp v149, v65 row_shr:14 row_mask:0xf bank_mask:0xf
    v_mfma_f32_16x16x32_bf16 a[56:59], v[100:103], a[196:199], a[56:59]
    v_mov_b32_dpp v150, v66 row_shr:14 row_mask:0xf bank_mask:0xf
    v_mfma_f32_16x16x32_bf16 a[60:63], v[100:103], a[192:195], a[60:63]
    v_mfma_f32_16x16x32_bf16 a[60:63], v[104:107], a[196:199], a[60:63]
    v_mov_b32_dpp v151, v67 row_shr:14 row_mask:0xf bank_mask:0xf
    v_mfma_f32_16x16x32_bf16 a[64:67], v[104:107], a[192:195], a[64:67]
    buffer_load_dwordx4 a[236:239], v35, s[12:15], s36 offen offset:1024 sc1
    v_mfma_f32_16x16x32_bf16 a[64:67], v[108:111], a[196:199], a[64:67]
    ds_read_b128 v[76:79], v33 offset:0
    v_mov_b32_dpp v148, v124 row_shl:1 row_mask:0xf bank_mask:0xf
    v_mfma_f32_16x16x32_bf16 a[68:71], v[108:111], a[192:195], a[68:71]
    v_mov_b32_dpp v149, v125 row_shl:1 row_mask:0xf bank_mask:0xf
    v_mov_b32_dpp v150, v126 row_shl:1 row_mask:0xf bank_mask:0xf
    v_mfma_f32_16x16x32_bf16 a[68:71], v[112:115], a[196:199], a[68:71]
    s_waitcnt vmcnt(11)
    ds_read_b128 v[80:83], v33 offset:144
    v_mov_b32_dpp v151, v127 row_shl:1 row_mask:0xf bank_mask:0xf
    v_mfma_f32_16x16x32_bf16 a[0:3], v[96:99], a[200:203], a[0:3]
    s_waitcnt vmcnt(10)
    v_mov_b32_dpp v152, v64 row_shr:13 row_mask:0xf bank_mask:0xf
    v_mfma_f32_16x16x32_bf16 a[0:3], v[100:103], a[204:207], a[0:3]
    ds_read_b128 v[84:87], v33 offset:288
    v_mov_b32_dpp v153, v65 row_shr:13 row_mask:0xf bank_mask:0xf
    v_mfma_f32_16x16x32_bf16 a[4:7], v[100:103], a[200:203], a[4:7]
    buffer_load_dwordx4 a[240:243], v35, s[12:15], s36 offen offset:2048 sc1
    v_mfma_f32_16x16x32_bf16 a[4:7], v[104:107], a[204:207], a[4:7]
    ds_read_b128 v[88:91], v33 offset:432
    v_mov_b32_dpp v154, v66 row_shr:13 row_mask:0xf bank_mask:0xf
    v_mfma_f32_16x16x32_bf16 a[8:11], v[104:107], a[200:203], a[8:11]
    v_mov_b32_dpp v155, v67 row_shr:13 row_mask:0xf bank_mask:0xf
    v_mfma_f32_16x16x32_bf16 a[8:11], v[108:111], a[204:207], a[8:11]
    ds_read_b128 v[92:95], v33 offset:576
    v_mov_b32_dpp v152, v128 row_shl:1 row_mask:0xf bank_mask:0xf
    v_mfma_f32_16x16x32_bf16 a[12:15], v[108:111], a[200:203], a[12:15]
    v_mov_b32_dpp v153, v129 row_shl:1 row_mask:0xf bank_mask:0xf
    v_mfma_f32_16x16x32_bf16 a[12:15], v[112:115], a[204:207], a[12:15]
    v_mov_b32_dpp v154, v130 row_shl:1 row_mask:0xf bank_mask:0xf
    v_mfma_f32_16x16x32_bf16 a[16:19], v[112:115], a[200:203], a[16:19]
    s_waitcnt lgkmcnt(6)
    buffer_load_dwordx4 a[244:247], v35, s[12:15], s37 offen offset:2048 sc1
    v_mfma_f32_16x16x32_bf16 a[16:19], v[68:71], a[204:207], a[16:19]
    v_mov_b32_dpp v155, v131 row_shl:1 row_mask:0xf bank_mask:0xf
    v_mov_b32_dpp v156, v64 row_shr:12 row_mask:0xf bank_mask:0xf
    v_mfma_f32_16x16x32_bf16 a[20:23], v[68:71], a[200:203], a[20:23]
    s_waitcnt lgkmcnt(5)
    v_mov_b32_dpp v157, v65 row_shr:12 row_mask:0xf bank_mask:0xf
    v_mfma_f32_16x16x32_bf16 a[20:23], v[72:75], a[204:207], a[20:23]
    s_waitcnt vmcnt(11)
    v_mov_b32_dpp v158, v66 row_shr:12 row_mask:0xf bank_mask:0xf
    v_mfma_f32_16x16x32_bf16 a[44:47], v[72:75], a[208:211], a[44:47]
    s_waitcnt vmcnt(9)
    v_mov_b32_dpp v159, v67 row_shr:12 row_mask:0xf bank_mask:0xf
    v_mfma_f32_16x16x32_bf16 a[44:47], v[68:71], a[212:215], a[44:47]
    s_mov_b32 s28, 288768
    v_mov_b32_dpp v156, v132 row_shl:1 row_mask:0xf bank_mask:0xf
    v_mfma_f32_16x16x32_bf16 a[40:43], v[68:71], a[208:211], a[40:43]
    buffer_load_dwordx4 a[248:251], v35, s[12:15], s28 offen offset:0 sc1
    v_mfma_f32_16x16x32_bf16 a[40:43], v[112:115], a[212:215], a[40:43]
    v_mov_b32_dpp v157, v133 row_shl:1 row_mask:0xf bank_mask:0xf
    v_mfma_f32_16x16x32_bf16 a[36:39], v[112:115], a[208:211], a[36:39]
    v_mov_b32_dpp v158, v134 row_shl:1 row_mask:0xf bank_mask:0xf
    v_mfma_f32_16x16x32_bf16 a[36:39], v[108:111], a[212:215], a[36:39]
    v_mov_b32_dpp v159, v135 row_shl:1 row_mask:0xf bank_mask:0xf
    v_mfma_f32_16x16x32_bf16 a[32:35], v[108:111], a[208:211], a[32:35]
    v_mov_b32_dpp v160, v64 row_shr:11 row_mask:0xf bank_mask:0xf
    v_mfma_f32_16x16x32_bf16 a[32:35], v[104:107], a[212:215], a[32:35]
    s_mov_b32 s36, 316416
    v_mov_b32_dpp v161, v65 row_shr:11 row_mask:0xf bank_mask:0xf
    v_mfma_f32_16x16x32_bf16 a[28:31], v[104:107], a[208:211], a[28:31]
    buffer_load_dwordx4 a[252:255], v35, s[12:15], s36 offen offset:0 sc1
    v_mfma_f32_16x16x32_bf16 a[28:31], v[100:103], a[212:215], a[28:31]
    v_mov_b32_dpp v162, v66 row_shr:11 row_mask:0xf bank_mask:0xf
    v_mov_b32_dpp v163, v67 row_shr:11 row_mask:0xf bank_mask:0xf
    v_mfma_f32_16x16x32_bf16 a[24:27], v[100:103], a[208:211], a[24:27]
    v_mov_b32_dpp v160, v136 row_shl:1 row_mask:0xf bank_mask:0xf
    v_mfma_f32_16x16x32_bf16 a[24:27], v[96:99], a[212:215], a[24:27]
    s_waitcnt vmcnt(10)
    v_mov_b32_dpp v161, v137 row_shl:1 row_mask:0xf bank_mask:0xf
    v_mfma_f32_16x16x32_bf16 a[48:51], v[96:99], a[216:219], a[48:51]
    s_waitcnt vmcnt(9)
    ds_read_b128 v[96:99], v33 offset:720
    v_mfma_f32_16x16x32_bf16 a[48:51], v[100:103], a[220:223], a[48:51]
    v_mov_b32_dpp v162, v138 row_shl:1 row_mask:0xf bank_mask:0xf
    v_mfma_f32_16x16x32_bf16 a[52:55], v[100:103], a[216:219], a[52:55]
    buffer_load_dwordx4 a[144:147], v35, s[12:15], s36 offen offset:1024 sc1
    v_mfma_f32_16x16x32_bf16 a[52:55], v[104:107], a[220:223], a[52:55]
    ds_read_b128 v[100:103], v33 offset:864
    v_mov_b32_dpp v163, v139 row_shl:1 row_mask:0xf bank_mask:0xf
    v_mfma_f32_16x16x32_bf16 a[56:59], v[104:107], a[216:219], a[56:59]
    v_mov_b32 v13, 0
    v_mov_b32_dpp v164, v64 row_shr:10 row_mask:0xf bank_mask:0xf
    v_mfma_f32_16x16x32_bf16 a[56:59], v[108:111], a[220:223], a[56:59]
    v_mov_b32_dpp v165, v65 row_shr:10 row_mask:0xf bank_mask:0xf
    v_mov_b32_dpp v166, v66 row_shr:10 row_mask:0xf bank_mask:0xf
    v_mfma_f32_16x16x32_bf16 a[60:63], v[108:111], a[216:219], a[60:63]
    v_mov_b32 v14, 0
    v_mov_b32_dpp v167, v67 row_shr:10 row_mask:0xf bank_mask:0xf
    v_mfma_f32_16x16x32_bf16 a[60:63], v[112:115], a[220:223], a[60:63]
    v_mov_b32_dpp v164, v140 row_shl:1 row_mask:0xf bank_mask:0xf
    v_mfma_f32_16x16x32_bf16 a[64:67], v[112:115], a[216:219], a[64:67]
    buffer_load_dwordx4 a[148:151], v35, s[12:15], s28 offen offset:1024 sc1
    v_mfma_f32_16x16x32_bf16 a[64:67], v[68:71], a[220:223], a[64:67]
    v_mov_b32 v15, 0
    v_mov_b32_dpp v165, v141 row_shl:1 row_mask:0xf bank_mask:0xf
    v_mfma_f32_16x16x32_bf16 a[68:71], v[68:71], a[216:219], a[68:71]
    v_mov_b32 v16, 0
    v_mov_b32_dpp v166, v142 row_shl:1 row_mask:0xf bank_mask:0xf
    v_mfma_f32_16x16x32_bf16 a[68:71], v[72:75], a[220:223], a[68:71]
    s_waitcnt vmcnt(10) lgkmcnt(6)
    v_mov_b32_dpp v167, v143 row_shl:1 row_mask:0xf bank_mask:0xf
    v_mfma_f32_16x16x32_bf16 a[0:3], v[76:79], a[224:227], a[0:3]
    s_waitcnt vmcnt(9) lgkmcnt(5)
    v_mov_b32 v17, 0
    v_mov_b32_dpp v168, v64 row_shr:9 row_mask:0xf bank_mask:0xf
    v_mfma_f32_16x16x32_bf16 a[0:3], v[80:83], a[228:231], a[0:3]
    v_mov_b32_dpp v169, v65 row_shr:9 row_mask:0xf bank_mask:0xf
    v_mfma_f32_16x16x32_bf16 a[4:7], v[80:83], a[224:227], a[4:7]
    s_waitcnt lgkmcnt(4)
    buffer_load_dwordx4 a[152:155], v35, s[12:15], s28 offen offset:2048 sc1
    v_mfma_f32_16x16x32_bf16 a[4:7], v[84:87], a[228:231], a[4:7]
    v_mov_b32 v18, 0
    v_mov_b32_dpp v170, v66 row_shr:9 row_mask:0xf bank_mask:0xf
    v_mfma_f32_16x16x32_bf16 a[8:11], v[84:87], a[224:227], a[8:11]
    s_waitcnt lgkmcnt(3)
    v_mov_b32 v19, 0
    v_mov_b32_dpp v171, v67 row_shr:9 row_mask:0xf bank_mask:0xf
    v_mfma_f32_16x16x32_bf16 a[8:11], v[88:91], a[228:231], a[8:11]
    ds_read_b128 v[104:107], v33 offset:1008
    v_mov_b32_dpp v168, v144 row_shl:1 row_mask:0xf bank_mask:0xf
    v_mfma_f32_16x16x32_bf16 a[12:15], v[88:91], a[224:227], a[12:15]
    s_waitcnt lgkmcnt(3)
    v_mov_b32 v20, 0
    v_mov_b32_dpp v169, v145 row_shl:1 row_mask:0xf bank_mask:0xf
    v_mfma_f32_16x16x32_bf16 a[12:15], v[92:95], a[228:231], a[12:15]
    ds_read_b128 v[108:111], v33 offset:1152
    v_mov_b32_dpp v170, v146 row_shl:1 row_mask:0xf bank_mask:0xf
    v_mfma_f32_16x16x32_bf16 a[16:19], v[92:95], a[224:227], a[16:19]
    s_waitcnt lgkmcnt(3)
    buffer_load_dwordx4 a[156:159], v35, s[12:15], s36 offen offset:2048 sc1
    v_mfma_f32_16x16x32_bf16 a[16:19], v[96:99], a[228:231], a[16:19]
    v_mov_b32 v21, 0
    v_mov_b32_dpp v171, v147 row_shl:1 row_mask:0xf bank_mask:0xf
    v_mfma_f32_16x16x32_bf16 a[20:23], v[96:99], a[224:227], a[20:23]
    s_waitcnt lgkmcnt(2)
    v_mfma_f32_16x16x32_bf16 a[20:23], v[100:103], a[228:231], a[20:23]
    s_waitcnt vmcnt(9)
    v_mfma_f32_16x16x32_bf16 a[44:47], v[100:103], a[232:235], a[44:47]
    s_waitcnt vmcnt(8)
    s_barrier
    v_mfma_f32_16x16x32_bf16 a[44:47], v[96:99], a[236:239], a[44:47]
    s_mov_b32 s37, 236544
    ds_read_b128 v[56:59], v10 offset:30272
    v_mfma_f32_16x16x32_bf16 a[40:43], v[96:99], a[232:235], a[40:43]
    buffer_load_dwordx4 a[160:163], v2, s[12:15], s37 offen offset:0 sc1
    v_mfma_f32_16x16x32_bf16 a[40:43], v[92:95], a[236:239], a[40:43]
    ds_read_b128 v[60:63], v12 offset:30272
    v_mfma_f32_16x16x32_bf16 a[36:39], v[92:95], a[232:235], a[36:39]
    v_mfma_f32_16x16x32_bf16 a[36:39], v[88:91], a[236:239], a[36:39]
    s_mov_b32 s28, 264192
    v_mfma_f32_16x16x32_bf16 a[32:35], v[88:91], a[232:235], a[32:35]
    buffer_load_dwordx4 a[164:167], v2, s[12:15], s28 offen offset:0 sc1
    v_mfma_f32_16x16x32_bf16 a[32:35], v[84:87], a[236:239], a[32:35]
    v_mfma_f32_16x16x32_bf16 a[28:31], v[84:87], a[232:235], a[28:31]
    v_mfma_f32_16x16x32_bf16 a[28:31], v[80:83], a[236:239], a[28:31]
    s_waitcnt lgkmcnt(1)
    v_lshlrev_b32 v40, 16, v56
    v_and_b32 v41, s84, v56
    v_mfma_f32_16x16x32_bf16 a[24:27], v[80:83], a[232:235], a[24:27]
    s_waitcnt lgkmcnt(0)
    ds_read_b128 v[48:51], v6 offset:30272
    v_lshlrev_b32 v42, 16, v60
    v_mfma_f32_16x16x32_bf16 a[24:27], v[76:79], a[236:239], a[24:27]
    s_waitcnt vmcnt(9)
    buffer_load_dwordx4 a[168:171], v2, s[12:15], s28 offen offset:1024 sc1
    v_mfma_f32_16x16x32_bf16 a[48:51], v[76:79], a[240:243], a[48:51]
    s_waitcnt vmcnt(9)
    ds_read_b128 v[52:55], v8 offset:30272
    v_and_b32 v43, s84, v60
    v_mfma_f32_16x16x32_bf16 a[48:51], v[80:83], a[244:247], a[48:51]
    v_add_f32 v40, v40, v42
    v_add_f32 v41, v41, v43
    v_mfma_f32_16x16x32_bf16 a[52:55], v[80:83], a[240:243], a[52:55]
    v_lshlrev_b32 v44, 16, v57
    v_and_b32 v45, s84, v57
    v_mfma_f32_16x16x32_bf16 a[52:55], v[84:87], a[244:247], a[52:55]
    v_lshlrev_b32 v46, 16, v61
    v_and_b32 v47, s84, v61
    v_mfma_f32_16x16x32_bf16 a[56:59], v[84:87], a[240:243], a[56:59]
    buffer_load_dwordx4 a[172:175], v2, s[12:15], s37 offen offset:1024 sc1
    v_mfma_f32_16x16x32_bf16 a[56:59], v[88:91], a[244:247], a[56:59]
    v_add_f32 v44, v44, v46
    v_add_f32 v45, v45, v47
    v_mfma_f32_16x16x32_bf16 a[60:63], v[88:91], a[240:243], a[60:63]
    v_cvt_pk_bf16_f32 v64, v40, v41
    v_cvt_pk_bf16_f32 v65, v44, v45
    v_mfma_f32_16x16x32_bf16 a[60:63], v[92:95], a[244:247], a[60:63]
    v_lshlrev_b32 v40, 16, v58
    v_mfma_f32_16x16x32_bf16 a[64:67], v[92:95], a[240:243], a[64:67]
    ds_read_b128 v[112:115], v6 offset:30272
    v_and_b32 v41, s84, v58
    v_mfma_f32_16x16x32_bf16 a[64:67], v[96:99], a[244:247], a[64:67]
    buffer_load_dwordx4 a[176:179], v2, s[12:15], s37 offen offset:2048 sc1
    v_mfma_f32_16x16x32_bf16 a[68:71], v[96:99], a[240:243], a[68:71]
    ds_read_b128 v[68:71], v6 offset:30416
    v_lshlrev_b32 v42, 16, v62
    v_mfma_f32_16x16x32_bf16 a[68:71], v[100:103], a[244:247], a[68:71]
    s_waitcnt vmcnt(10)
    v_and_b32 v43, s84, v62
    v_add_f32 v40, v40, v42
    v_mfma_f32_16x16x32_bf16 a[0:3], v[84:87], a[248:251], a[0:3]
    s_waitcnt vmcnt(9)
    ds_read_b128 v[72:75], v6 offset:30560
    v_add_f32 v41, v41, v43
    v_mfma_f32_16x16x32_bf16 a[0:3], v[88:91], a[252:255], a[0:3]
    v_lshlrev_b32 v44, 16, v59
    v_mfma_f32_16x16x32_bf16 a[4:7], v[88:91], a[248:251], a[4:7]
    buffer_load_dwordx4 a[180:183], v2, s[12:15], s28 offen offset:2048 sc1
    v_mfma_f32_16x16x32_bf16 a[4:7], v[92:95], a[252:255], a[4:7]
    ds_read_b128 v[76:79], v6 offset:30704
    v_and_b32 v45, s84, v59
    v_mfma_f32_16x16x32_bf16 a[8:11], v[92:95], a[248:251], a[8:11]
    v_lshlrev_b32 v46, 16, v63
    v_and_b32 v47, s84, v63
    v_mfma_f32_16x16x32_bf16 a[8:11], v[96:99], a[252:255], a[8:11]
    ds_read_b128 v[80:83], v6 offset:30848
    v_add_f32 v44, v44, v46
    v_mfma_f32_16x16x32_bf16 a[12:15], v[96:99], a[248:251], a[12:15]
    s_mov_b32 s36, 291840
    v_add_f32 v45, v45, v47
    v_mfma_f32_16x16x32_bf16 a[12:15], v[100:103], a[252:255], a[12:15]
    buffer_load_dwordx4 a[184:187], v2, s[12:15], s36 offen offset:0 sc1
    v_mfma_f32_16x16x32_bf16 a[16:19], v[100:103], a[248:251], a[16:19]
    v_cvt_pk_bf16_f32 v66, v40, v41
    v_cvt_pk_bf16_f32 v67, v44, v45
    v_mfma_f32_16x16x32_bf16 a[16:19], v[104:107], a[252:255], a[16:19]
    s_waitcnt lgkmcnt(6)
    v_lshlrev_b32 v40, 16, v48
    v_mfma_f32_16x16x32_bf16 a[20:23], v[104:107], a[248:251], a[20:23]
    v_and_b32 v41, s84, v48
    v_mfma_f32_16x16x32_bf16 a[20:23], v[108:111], a[252:255], a[20:23]
    s_waitcnt vmcnt(10) lgkmcnt(5)
    s_mov_b32 s37, 319488
    v_lshlrev_b32 v42, 16, v52
    v_mfma_f32_16x16x32_bf16 a[44:47], v[108:111], a[144:147], a[44:47]
    s_waitcnt vmcnt(9)
    buffer_load_dwordx4 a[188:191], v2, s[12:15], s37 offen offset:0 sc1
    v_mfma_f32_16x16x32_bf16 a[44:47], v[104:107], a[148:151], a[44:47]
    ds_read_b128 v[56:59], v6 offset:30416
    ds_read_b128 v[60:63], v8 offset:30416
    v_mfma_f32_16x16x32_bf16 a[40:43], v[104:107], a[144:147], a[40:43]
    v_and_b32 v43, s84, v52
    v_mfma_f32_16x16x32_bf16 a[40:43], v[100:103], a[148:151], a[40:43]
    v_add_f32 v40, v40, v42
    v_mfma_f32_16x16x32_bf16 a[36:39], v[100:103], a[144:147], a[36:39]
    v_add_f32 v41, v41, v43
    v_mfma_f32_16x16x32_bf16 a[36:39], v[96:99], a[148:151], a[36:39]
    buffer_load_dwordx4 a[192:195], v2, s[12:15], s37 offen offset:1024 sc1
    v_mfma_f32_16x16x32_bf16 a[32:35], v[96:99], a[144:147], a[32:35]
    v_lshlrev_b32 v44, 16, v49
    v_and_b32 v45, s84, v49
    v_mfma_f32_16x16x32_bf16 a[32:35], v[92:95], a[148:151], a[32:35]
    v_lshlrev_b32 v46, 16, v53
    v_mfma_f32_16x16x32_bf16 a[28:31], v[92:95], a[144:147], a[28:31]
    v_and_b32 v47, s84, v53
    v_mfma_f32_16x16x32_bf16 a[28:31], v[88:91], a[148:151], a[28:31]
    v_add_f32 v44, v44, v46
    v_mfma_f32_16x16x32_bf16 a[24:27], v[88:91], a[144:147], a[24:27]
    buffer_load_dwordx4 a[196:199], v2, s[12:15], s36 offen offset:1024 sc1
    v_mfma_f32_16x16x32_bf16 a[24:27], v[84:87], a[148:151], a[24:27]
    s_waitcnt vmcnt(11)
    v_add_f32 v45, v45, v47
    v_cvt_pk_bf16_f32 v204, v40, v41
    v_mfma_f32_16x16x32_bf16 a[48:51], v[84:87], a[152:155], a[48:51]
    s_waitcnt vmcnt(10)
    ds_read_b128 v[84:87], v6 offset:30992
    v_cvt_pk_bf16_f32 v205, v44, v45
    v_mfma_f32_16x16x32_bf16 a[48:51], v[88:91], a[156:159], a[48:51]
    v_lshlrev_b32 v40, 16, v50
    v_mfma_f32_16x16x32_bf16 a[52:55], v[88:91], a[152:155], a[52:55]
    ds_read_b128 v[88:91], v6 offset:31136
    v_and_b32 v41, s84, v50
    v_mfma_f32_16x16x32_bf16 a[52:55], v[92:95], a[156:159], a[52:55]
    buffer_load_dwordx4 a[200:203], v2, s[12:15], s36 offen offset:2048 sc1
    v_mfma_f32_16x16x32_bf16 a[56:59], v[92:95], a[152:155], a[56:59]
    v_lshlrev_b32 v42, 16, v54
    v_and_b32 v43, s84, v54
    v_mfma_f32_16x16x32_bf16 a[56:59], v[96:99], a[156:159], a[56:59]
    v_add_f32 v40, v40, v42
    v_mfma_f32_16x16x32_bf16 a[60:63], v[96:99], a[152:155], a[60:63]
    v_add_f32 v41, v41, v43
    v_mfma_f32_16x16x32_bf16 a[60:63], v[100:103], a[156:159], a[60:63]
    v_lshlrev_b32 v44, 16, v51
    v_mfma_f32_16x16x32_bf16 a[64:67], v[100:103], a[152:155], a[64:67]
    buffer_load_dwordx4 a[204:207], v2, s[12:15], s37 offen offset:2048 sc1
    v_mfma_f32_16x16x32_bf16 a[64:67], v[104:107], a[156:159], a[64:67]
    v_and_b32 v45, s84, v51
    v_lshlrev_b32 v46, 16, v55
    v_mfma_f32_16x16x32_bf16 a[68:71], v[104:107], a[152:155], a[68:71]
    v_and_b32 v47, s84, v55
    v_mfma_f32_16x16x32_bf16 a[68:71], v[108:111], a[156:159], a[68:71]
    s_waitcnt vmcnt(11) lgkmcnt(8)
    v_add_f32 v44, v44, v46
    v_mfma_f32_16x16x32_bf16 a[0:3], v[112:115], a[160:163], a[0:3]
    s_waitcnt vmcnt(10) lgkmcnt(7)
    s_mov_b32 s28, 347136
    v_add_f32 v45, v45, v47
    v_mfma_f32_16x16x32_bf16 a[0:3], v[68:71], a[164:167], a[0:3]
    buffer_load_dwordx4 a[208:211], v2, s[12:15], s28 offen offset:0 sc1
    v_mfma_f32_16x16x32_bf16 a[4:7], v[68:71], a[160:163], a[4:7]
    s_waitcnt lgkmcnt(6)
    v_cvt_pk_bf16_f32 v206, v40, v41
    v_cvt_pk_bf16_f32 v207, v44, v45
    v_mfma_f32_16x16x32_bf16 a[4:7], v[72:75], a[164:167], a[4:7]
    s_waitcnt lgkmcnt(3)
    v_lshlrev_b32 v40, 16, v56
    v_mfma_f32_16x16x32_bf16 a[8:11], v[72:75], a[160:163], a[8:11]
    s_mov_b32 s36, 374784
    v_and_b32 v41, s84, v56
    v_mfma_f32_16x16x32_bf16 a[8:11], v[76:79], a[164:167], a[8:11]
    s_waitcnt lgkmcnt(2)
    ds_read_b128 v[92:95], v6 offset:31280
    v_lshlrev_b32 v42, 16, v60
    v_mfma_f32_16x16x32_bf16 a[12:15], v[76:79], a[160:163], a[12:15]
    buffer_load_dwordx4 a[212:215], v2, s[12:15], s36 offen offset:0 sc1
    v_mfma_f32_16x16x32_bf16 a[12:15], v[80:83], a[164:167], a[12:15]
    ds_read_b128 v[96:99], v6 offset:31424
    ds_read_b128 v[48:51], v6 offset:30560
    v_mfma_f32_16x16x32_bf16 a[16:19], v[80:83], a[160:163], a[16:19]
    s_waitcnt lgkmcnt(4)
    ds_read_b128 v[52:55], v8 offset:30560
    v_and_b32 v43, s84, v60
    v_mfma_f32_16x16x32_bf16 a[16:19], v[84:87], a[164:167], a[16:19]
    v_add_f32 v40, v40, v42
    v_mfma_f32_16x16x32_bf16 a[20:23], v[84:87], a[160:163], a[20:23]
    s_waitcnt lgkmcnt(4)
    s_mov_b32 s37, 402432
    v_add_f32 v41, v41, v43
    v_mfma_f32_16x16x32_bf16 a[20:23], v[88:91], a[164:167], a[20:23]
    s_waitcnt vmcnt(11)
    buffer_load_dwordx4 a[216:219], v2, s[12:15], s37 offen offset:0 sc1
    v_mfma_f32_16x16x32_bf16 a[44:47], v[88:91], a[168:171], a[44:47]
    s_waitcnt vmcnt(11)
    v_lshlrev_b32 v44, 16, v57
    v_and_b32 v45, s84, v57
    v_mfma_f32_16x16x32_bf16 a[44:47], v[84:87], a[172:175], a[44:47]
    v_lshlrev_b32 v46, 16, v61
    v_mfma_f32_16x16x32_bf16 a[40:43], v[84:87], a[168:171], a[40:43]
    v_and_b32 v47, s84, v61
    v_mfma_f32_16x16x32_bf16 a[40:43], v[80:83], a[172:175], a[40:43]
    buffer_load_dwordx4 a[220:223], v2, s[12:15], s28 offen offset:1024 sc1
    v_mfma_f32_16x16x32_bf16 a[36:39], v[80:83], a[168:171], a[36:39]
    v_add_f32 v44, v44, v46
    v_add_f32 v45, v45, v47
    v_mfma_f32_16x16x32_bf16 a[36:39], v[76:79], a[172:175], a[36:39]
    v_cvt_pk_bf16_f32 v208, v40, v41
    v_mfma_f32_16x16x32_bf16 a[32:35], v[76:79], a[168:171], a[32:35]
    v_cvt_pk_bf16_f32 v209, v44, v45
    v_mfma_f32_16x16x32_bf16 a[32:35], v[72:75], a[172:175], a[32:35]
    v_lshlrev_b32 v40, 16, v58
    v_mfma_f32_16x16x32_bf16 a[28:31], v[72:75], a[168:171], a[28:31]
    buffer_load_dwordx4 a[224:227], v2, s[12:15], s36 offen offset:1024 sc1
    v_mfma_f32_16x16x32_bf16 a[28:31], v[68:71], a[172:175], a[28:31]
    buffer_load_dword v119, v118, s[20:23], 0 offen sc1
    v_mfma_f32_16x16x32_bf16 a[24:27], v[68:71], a[168:171], a[24:27]
    v_and_b32 v41, s84, v58
    v_lshlrev_b32 v42, 16, v62
    v_mfma_f32_16x16x32_bf16 a[24:27], v[112:115], a[172:175], a[24:27]
    s_waitcnt vmcnt(13)
    v_and_b32 v43, s84, v62
    v_add_f32 v40, v40, v42
    v_mfma_f32_16x16x32_bf16 a[48:51], v[112:115], a[176:179], a[48:51]
Lq2:
    s_cbranch_execz Lt9
    s_waitcnt vmcnt(12)
    v_add_f32 v41, v41, v43
    v_mfma_f32_16x16x32_bf16 a[48:51], v[68:71], a[180:183], a[48:51]
    buffer_load_dwordx4 a[228:231], v2, s[12:15], s37 offen offset:1024 sc1
    v_mfma_f32_16x16x32_bf16 a[52:55], v[68:71], a[176:179], a[52:55]
    v_lshlrev_b32 v44, 16, v59
    v_and_b32 v45, s84, v59
    v_mfma_f32_16x16x32_bf16 a[52:55], v[72:75], a[180:183], a[52:55]
    v_lshlrev_b32 v46, 16, v63
    v_mfma_f32_16x16x32_bf16 a[56:59], v[72:75], a[176:179], a[56:59]
    v_and_b32 v47, s84, v63
    v_mfma_f32_16x16x32_bf16 a[56:59], v[76:79], a[180:183], a[56:59]
    v_add_f32 v44, v44, v46
    v_mfma_f32_16x16x32_bf16 a[60:63], v[76:79], a[176:179], a[60:63]
    buffer_load_dwordx4 a[232:235], v2, s[12:15], s28 offen offset:2048 sc1
    v_mfma_f32_16x16x32_bf16 a[60:63], v[80:83], a[180:183], a[60:63]
    v_add_f32 v45, v45, v47
    v_mfma_f32_16x16x32_bf16 a[64:67], v[80:83], a[176:179], a[64:67]
    v_cvt_pk_bf16_f32 v210, v40, v41
    v_mfma_f32_16x16x32_bf16 a[64:67], v[84:87], a[180:183], a[64:67]
    v_cvt_pk_bf16_f32 v211, v44, v45
    v_mfma_f32_16x16x32_bf16 a[68:71], v[84:87], a[176:179], a[68:71]
    s_waitcnt lgkmcnt(1)
    v_lshlrev_b32 v40, 16, v48
    v_mfma_f32_16x16x32_bf16 a[68:71], v[88:91], a[180:183], a[68:71]
    s_waitcnt vmcnt(13)
    buffer_load_dwordx4 a[236:239], v2, s[12:15], s36 offen offset:2048 sc1
    v_mfma_f32_16x16x32_bf16 a[0:3], v[72:75], a[184:187], a[0:3]
    s_waitcnt vmcnt(13) lgkmcnt(0)
    v_and_b32 v41, s84, v48
    v_lshlrev_b32 v42, 16, v52
    v_mfma_f32_16x16x32_bf16 a[0:3], v[76:79], a[188:191], a[0:3]
    ds_read_b128 v[56:59], v6 offset:30704
    v_mfma_f32_16x16x32_bf16 a[4:7], v[76:79], a[184:187], a[4:7]
    ds_read_b128 v[60:63], v8 offset:30704
    v_mfma_f32_16x16x32_bf16 a[4:7], v[80:83], a[188:191], a[4:7]
    v_and_b32 v43, s84, v52
    v_mfma_f32_16x16x32_bf16 a[8:11], v[80:83], a[184:187], a[8:11]
    buffer_load_dwordx4 a[240:243], v2, s[12:15], s37 offen offset:2048 sc1
    v_mfma_f32_16x16x32_bf16 a[8:11], v[84:87], a[188:191], a[8:11]
    ds_read_b128 v[100:103], v6 offset:31568
    v_add_f32 v40, v40, v42
    v_mfma_f32_16x16x32_bf16 a[12:15], v[84:87], a[184:187], a[12:15]
    v_add_f32 v41, v41, v43
    v_lshlrev_b32 v44, 16, v49
    v_mfma_f32_16x16x32_bf16 a[12:15], v[88:91], a[188:191], a[12:15]
    v_and_b32 v45, s84, v49
    v_mfma_f32_16x16x32_bf16 a[16:19], v[88:91], a[184:187], a[16:19]
    s_mov_b32 s28, 242688
    v_lshlrev_b32 v46, 16, v53
    v_mfma_f32_16x16x32_bf16 a[16:19], v[92:95], a[188:191], a[16:19]
    buffer_load_dwordx4 a[244:247], v2, s[12:15], s28 offen offset:0 sc1
    v_mfma_f32_16x16x32_bf16 a[20:23], v[92:95], a[184:187], a[20:23]
    ds_read_b128 v[104:107], v6 offset:31712
    v_and_b32 v47, s84, v53
    v_mfma_f32_16x16x32_bf16 a[20:23], v[96:99], a[188:191], a[20:23]
    s_waitcnt vmcnt(14)
    v_add_f32 v44, v44, v46
    v_add_f32 v45, v45, v47
    v_mfma_f32_16x16x32_bf16 a[44:47], v[96:99], a[192:195], a[44:47]
    s_waitcnt vmcnt(13)
    ds_read_b128 v[108:111], v6 offset:31856
    v_cvt_pk_bf16_f32 v212, v40, v41
    v_mfma_f32_16x16x32_bf16 a[44:47], v[92:95], a[196:199], a[44:47]
    v_cvt_pk_bf16_f32 v213, v44, v45
    v_mfma_f32_16x16x32_bf16 a[40:43], v[92:95], a[192:195], a[40:43]
    buffer_load_dwordx4 a[248:251], v2, s[12:15], s28 offen offset:1024 sc1
    v_mfma_f32_16x16x32_bf16 a[40:43], v[88:91], a[196:199], a[40:43]
    v_lshlrev_b32 v40, 16, v50
    v_and_b32 v41, s84, v50
    v_mfma_f32_16x16x32_bf16 a[36:39], v[88:91], a[192:195], a[36:39]
    v_lshlrev_b32 v42, 16, v54
    v_mfma_f32_16x16x32_bf16 a[36:39], v[84:87], a[196:199], a[36:39]
    v_and_b32 v43, s84, v54
    v_mfma_f32_16x16x32_bf16 a[32:35], v[84:87], a[192:195], a[32:35]
    v_add_f32 v40, v40, v42
    v_mfma_f32_16x16x32_bf16 a[32:35], v[80:83], a[196:199], a[32:35]
    buffer_load_dwordx4 a[252:255], v2, s[12:15], s28 offen offset:2048 sc1
    v_mfma_f32_16x16x32_bf16 a[28:31], v[80:83], a[192:195], a[28:31]
    v_add_f32 v41, v41, v43
    v_lshlrev_b32 v44, 16, v51
    v_mfma_f32_16x16x32_bf16 a[28:31], v[76:79], a[196:199], a[28:31]
    v_and_b32 v45, s84, v51
    v_mfma_f32_16x16x32_bf16 a[24:27], v[76:79], a[192:195], a[24:27]
    v_lshlrev_b32 v46, 16, v55
    v_mfma_f32_16x16x32_bf16 a[24:27], v[72:75], a[196:199], a[24:27]
    s_waitcnt vmcnt(14)
    s_mov_b32 s36, 270336
    v_and_b32 v47, s84, v55
    v_mfma_f32_16x16x32_bf16 a[48:51], v[72:75], a[200:203], a[48:51]
    s_waitcnt vmcnt(13)
    buffer_load_dwordx4 a[144:147], v2, s[12:15], s36 offen offset:0 sc1
    v_mfma_f32_16x16x32_bf16 a[48:51], v[76:79], a[204:207], a[48:51]
    v_add_f32 v44, v44, v46
    v_add_f32 v45, v45, v47
    v_mfma_f32_16x16x32_bf16 a[52:55], v[76:79], a[200:203], a[52:55]
    v_cvt_pk_bf16_f32 v214, v40, v41
    v_mfma_f32_16x16x32_bf16 a[52:55], v[80:83], a[204:207], a[52:55]
    v_cvt_pk_bf16_f32 v215, v44, v45
    v_mfma_f32_16x16x32_bf16 a[56:59], v[80:83], a[200:203], a[56:59]
    s_waitcnt lgkmcnt(4)
    s_mov_b32 s37, 297984
    v_lshlrev_b32 v40, 16, v56
    v_mfma_f32_16x16x32_bf16 a[56:59], v[84:87], a[204:207], a[56:59]
    buffer_load_dwordx4 a[148:151], v2, s[12:15], s37 offen offset:0 sc1
    v_mfma_f32_16x16x32_bf16 a[60:63], v[84:87], a[200:203], a[60:63]
    s_waitcnt lgkmcnt(3)
    v_and_b32 v41, s84, v56
    v_lshlrev_b32 v42, 16, v60
    v_mfma_f32_16x16x32_bf16 a[60:63], v[88:91], a[204:207], a[60:63]
    ds_read_b128 v[48:51], v6 offset:30848
    v_mfma_f32_16x16x32_bf16 a[64:67], v[88:91], a[200:203], a[64:67]
    ds_read_b128 v[52:55], v8 offset:30848
    v_mfma_f32_16x16x32_bf16 a[64:67], v[92:95], a[204:207], a[64:67]
    s_mov_b32 s28, 353280
    v_and_b32 v43, s84, v60
    v_mfma_f32_16x16x32_bf16 a[68:71], v[92:95], a[200:203], a[68:71]
    buffer_load_dwordx4 a[152:155], v2, s[12:15], s28 offen offset:0 sc1
    v_mfma_f32_16x16x32_bf16 a[68:71], v[96:99], a[204:207], a[68:71]
    s_waitcnt vmcnt(15)
    v_add_f32 v40, v40, v42
    v_add_f32 v41, v41, v43
    v_mfma_f32_16x16x32_bf16 a[0:3], v[80:83], a[208:211], a[0:3]
    s_waitcnt vmcnt(14)
    v_lshlrev_b32 v44, 16, v57
    v_mfma_f32_16x16x32_bf16 a[0:3], v[84:87], a[212:215], a[0:3]
    s_waitcnt vmcnt(13)
    v_and_b32 v45, s84, v57
    v_mfma_f32_16x16x32_bf16 a[0:3], v[88:91], a[216:219], a[0:3]
    s_mov_b32 s36, 325632
    v_lshlrev_b32 v46, 16, v61
    v_mfma_f32_16x16x32_bf16 a[4:7], v[92:95], a[216:219], a[4:7]
    buffer_load_dwordx4 a[156:159], v2, s[12:15], s36 offen offset:0 sc1
    v_mfma_f32_16x16x32_bf16 a[4:7], v[88:91], a[212:215], a[4:7]
    v_and_b32 v47, s84, v61
    v_add_f32 v44, v44, v46
    v_mfma_f32_16x16x32_bf16 a[4:7], v[84:87], a[208:211], a[4:7]
    v_add_f32 v45, v45, v47
    v_mfma_f32_16x16x32_bf16 a[8:11], v[88:91], a[208:211], a[8:11]
    v_cvt_pk_bf16_f32 v216, v40, v41
    v_mfma_f32_16x16x32_bf16 a[8:11], v[92:95], a[212:215], a[8:11]
    s_mov_b32 s37, 380928
    v_cvt_pk_bf16_f32 v217, v44, v45
    v_mfma_f32_16x16x32_bf16 a[8:11], v[96:99], a[216:219], a[8:11]
    s_waitcnt lgkmcnt(4)
    buffer_load_dwordx4 a[160:163], v2, s[12:15], s37 offen offset:0 sc1
    v_mfma_f32_16x16x32_bf16 a[12:15], v[100:103], a[216:219], a[12:15]
    v_lshlrev_b32 v40, 16, v58
    v_and_b32 v41, s84, v58
    v_mfma_f32_16x16x32_bf16 a[12:15], v[96:99], a[212:215], a[12:15]
    v_lshlrev_b32 v42, 16, v62
    v_mfma_f32_16x16x32_bf16 a[12:15], v[92:95], a[208:211], a[12:15]
    s_mov_b32 s28, 408576
    v_and_b32 v43, s84, v62
    v_mfma_f32_16x16x32_bf16 a[16:19], v[96:99], a[208:211], a[16:19]
    buffer_load_dwordx4 a[164:167], v2, s[12:15], s28 offen offset:0 sc1
    v_mfma_f32_16x16x32_bf16 a[16:19], v[100:103], a[212:215], a[16:19]
    s_waitcnt lgkmcnt(3)
    v_add_f32 v40, v40, v42
    v_add_f32 v41, v41, v43
    v_mfma_f32_16x16x32_bf16 a[16:19], v[104:107], a[216:219], a[16:19]
    s_waitcnt lgkmcnt(2)
    ds_read_b128 v[112:115], v6 offset:45408
    v_lshlrev_b32 v44, 16, v59
    v_mfma_f32_16x16x32_bf16 a[20:23], v[108:111], a[216:219], a[20:23]
    v_and_b32 v45, s84, v59
    v_mfma_f32_16x16x32_bf16 a[20:23], v[104:107], a[212:215], a[20:23]
    s_mov_b32 s36, 270336
    ds_read_b128 v[68:71], v6 offset:45552
    v_lshlrev_b32 v46, 16, v63
    v_mfma_f32_16x16x32_bf16 a[20:23], v[100:103], a[208:211], a[20:23]
    s_waitcnt vmcnt(15)
    buffer_load_dwordx4 a[168:171], v2, s[12:15], s36 offen offset:1024 sc1
    v_mfma_f32_16x16x32_bf16 a[44:47], v[100:103], a[220:223], a[44:47]
    s_waitcnt vmcnt(15)
    ds_read_b128 v[72:75], v6 offset:45696
    v_and_b32 v47, s84, v63
    v_mfma_f32_16x16x32_bf16 a[44:47], v[104:107], a[224:227], a[44:47]
    s_waitcnt vmcnt(13)
    v_add_f32 v44, v44, v46
    v_add_f32 v45, v45, v47
    v_mfma_f32_16x16x32_bf16 a[44:47], v[108:111], a[228:231], a[44:47]
    ds_read_b128 v[76:79], v6 offset:45840
    v_cvt_pk_bf16_f32 v218, v40, v41
    v_mfma_f32_16x16x32_bf16 a[40:43], v[104:107], a[228:231], a[40:43]
    s_mov_b32 s37, 297984
    v_cvt_pk_bf16_f32 v219, v44, v45
    v_mfma_f32_16x16x32_bf16 a[40:43], v[100:103], a[224:227], a[40:43]
    buffer_load_dwordx4 a[172:175], v2, s[12:15], s37 offen offset:1024 sc1
    v_mfma_f32_16x16x32_bf16 a[40:43], v[96:99], a[220:223], a[40:43]
    s_waitcnt lgkmcnt(5)
    v_lshlrev_b32 v40, 16, v48
    v_and_b32 v41, s84, v48
    v_mfma_f32_16x16x32_bf16 a[36:39], v[92:95], a[220:223], a[36:39]
    s_waitcnt lgkmcnt(4)
    v_lshlrev_b32 v42, 16, v52
    v_mfma_f32_16x16x32_bf16 a[36:39], v[96:99], a[224:227], a[36:39]
    ds_read_b128 v[56:59], v6 offset:30992
    v_mfma_f32_16x16x32_bf16 a[36:39], v[100:103], a[228:231], a[36:39]
    s_mov_b32 s28, 353280
    ds_read_b128 v[60:63], v8 offset:30992
    v_mfma_f32_16x16x32_bf16 a[32:35], v[96:99], a[228:231], a[32:35]
    buffer_load_dwordx4 a[176:179], v2, s[12:15], s28 offen offset:1024 sc1
    v_mfma_f32_16x16x32_bf16 a[32:35], v[92:95], a[224:227], a[32:35]
    v_and_b32 v43, s84, v52
    v_add_f32 v40, v40, v42
    v_mfma_f32_16x16x32_bf16 a[32:35], v[88:91], a[220:223], a[32:35]
    v_add_f32 v41, v41, v43
    v_mfma_f32_16x16x32_bf16 a[28:31], v[84:87], a[220:223], a[28:31]
    v_lshlrev_b32 v44, 16, v49
    v_mfma_f32_16x16x32_bf16 a[28:31], v[88:91], a[224:227], a[28:31]
    s_mov_b32 s36, 325632
    v_and_b32 v45, s84, v49
    v_mfma_f32_16x16x32_bf16 a[28:31], v[92:95], a[228:231], a[28:31]
    buffer_load_dwordx4 a[180:183], v2, s[12:15], s36 offen offset:1024 sc1
    v_mfma_f32_16x16x32_bf16 a[24:27], v[88:91], a[228:231], a[24:27]
    v_lshlrev_b32 v46, 16, v53
    v_and_b32 v47, s84, v53
    v_mfma_f32_16x16x32_bf16 a[24:27], v[84:87], a[224:227], a[24:27]
    v_add_f32 v44, v44, v46
    v_mfma_f32_16x16x32_bf16 a[24:27], v[80:83], a[220:223], a[24:27]
    s_waitcnt vmcnt(15)
    s_mov_b32 s37, 380928
    v_add_f32 v45, v45, v47
    v_mfma_f32_16x16x32_bf16 a[48:51], v[80:83], a[232:235], a[48:51]
    s_waitcnt vmcnt(14)
    ds_read_b128 v[80:83], v6 offset:45984
    v_cvt_pk_bf16_f32 v220, v40, v41
    v_mfma_f32_16x16x32_bf16 a[48:51], v[84:87], a[236:239], a[48:51]
    s_waitcnt vmcnt(13)
    buffer_load_dwordx4 a[184:187], v2, s[12:15], s37 offen offset:1024 sc1
    v_mfma_f32_16x16x32_bf16 a[48:51], v[88:91], a[240:243], a[48:51]
    v_cmp_ne_u32 vcc, 1, v119
    v_cvt_pk_bf16_f32 v221, v44, v45
    v_mfma_f32_16x16x32_bf16 a[52:55], v[92:95], a[240:243], a[52:55]
    v_lshlrev_b32 v40, 16, v50
    v_and_b32 v41, s84, v50
    v_mfma_f32_16x16x32_bf16 a[52:55], v[88:91], a[236:239], a[52:55]
    s_cbranch_vccnz Lsn
Lrn:
    v_lshlrev_b32 v42, 16, v54
    v_mfma_f32_16x16x32_bf16 a[52:55], v[84:87], a[232:235], a[52:55]
    s_mov_b32 s28, 408576
    ds_read_b128 v[84:87], v6 offset:46128
    v_and_b32 v43, s84, v54
    v_mfma_f32_16x16x32_bf16 a[56:59], v[88:91], a[232:235], a[56:59]
    buffer_load_dwordx4 a[188:191], v2, s[12:15], s28 offen offset:1024 sc1
    v_mfma_f32_16x16x32_bf16 a[56:59], v[92:95], a[236:239], a[56:59]
    ds_read_b128 v[88:91], v6 offset:46272
    v_add_f32 v40, v40, v42
    v_mfma_f32_16x16x32_bf16 a[56:59], v[96:99], a[240:243], a[56:59]
    v_add_f32 v41, v41, v43
    v_lshlrev_b32 v44, 16, v51
    v_mfma_f32_16x16x32_bf16 a[60:63], v[100:103], a[240:243], a[60:63]
    v_and_b32 v45, s84, v51
    v_mfma_f32_16x16x32_bf16 a[60:63], v[96:99], a[236:239], a[60:63]
    s_mov_b32 s36, 270336
    v_lshlrev_b32 v46, 16, v55
    v_mfma_f32_16x16x32_bf16 a[60:63], v[92:95], a[232:235], a[60:63]
    buffer_load_dwordx4 a[192:195], v2, s[12:15], s36 offen offset:2048 sc1
    v_mfma_f32_16x16x32_bf16 a[64:67], v[96:99], a[232:235], a[64:67]
    ds_read_b128 v[92:95], v6 offset:46416
    v_and_b32 v47, s84, v55
    v_mfma_f32_16x16x32_bf16 a[64:67], v[100:103], a[236:239], a[64:67]
    v_add_f32 v44, v44, v46
    v_mfma_f32_16x16x32_bf16 a[64:67], v[104:107], a[240:243], a[64:67]
    ds_read_b128 v[96:99], v6 offset:46560
    v_add_f32 v45, v45, v47
    v_mfma_f32_16x16x32_bf16 a[68:71], v[108:111], a[240:243], a[68:71]
    s_mov_b32 s37, 297984
    v_cvt_pk_bf16_f32 v222, v40, v41
    v_mfma_f32_16x16x32_bf16 a[68:71], v[104:107], a[236:239], a[68:71]
    buffer_load_dwordx4 a[196:199], v2, s[12:15], s37 offen offset:2048 sc1
    v_mfma_f32_16x16x32_bf16 a[68:71], v[100:103], a[232:235], a[68:71]
    s_waitcnt vmcnt(16) lgkmcnt(10)
    ds_read_b128 v[100:103], v6 offset:46704
    v_cvt_pk_bf16_f32 v223, v44, v45
    v_mfma_f32_16x16x32_bf16 a[0:3], v[112:115], a[244:247], a[0:3]
    s_waitcnt lgkmcnt(7)
    v_lshlrev_b32 v40, 16, v56
    v_and_b32 v41, s84, v56
    v_mfma_f32_16x16x32_bf16 a[4:7], v[68:71], a[244:247], a[4:7]
    s_waitcnt lgkmcnt(6)
    v_lshlrev_b32 v42, 16, v60
    v_mfma_f32_16x16x32_bf16 a[8:11], v[72:75], a[244:247], a[8:11]
    s_mov_b32 s28, 353280
    v_and_b32 v43, s84, v60
    v_mfma_f32_16x16x32_bf16 a[12:15], v[76:79], a[244:247], a[12:15]
    s_waitcnt lgkmcnt(5)
    buffer_load_dwordx4 a[200:203], v2, s[12:15], s28 offen offset:2048 sc1
    v_mfma_f32_16x16x32_bf16 a[16:19], v[80:83], a[244:247], a[16:19]
    s_waitcnt lgkmcnt(4)
    v_add_f32 v40, v40, v42
    v_add_f32 v41, v41, v43
    v_mfma_f32_16x16x32_bf16 a[20:23], v[84:87], a[244:247], a[20:23]
    s_waitcnt vmcnt(16)
    v_lshlrev_b32 v44, 16, v57
    v_mfma_f32_16x16x32_bf16 a[44:47], v[84:87], a[248:251], a[44:47]
    v_and_b32 v45, s84, v57
    v_mfma_f32_16x16x32_bf16 a[40:43], v[80:83], a[248:251], a[40:43]
    s_mov_b32 s36, 325632
    v_lshlrev_b32 v46, 16, v61
    v_mfma_f32_16x16x32_bf16 a[36:39], v[76:79], a[248:251], a[36:39]
    buffer_load_dwordx4 a[204:207], v2, s[12:15], s36 offen offset:2048 sc1
    v_mfma_f32_16x16x32_bf16 a[32:35], v[72:75], a[248:251], a[32:35]
    v_and_b32 v47, s84, v61
    v_add_f32 v44, v44, v46
    v_mfma_f32_16x16x32_bf16 a[28:31], v[68:71], a[248:251], a[28:31]
    v_add_f32 v45, v45, v47
    v_mfma_f32_16x16x32_bf16 a[24:27], v[112:115], a[248:251], a[24:27]
    s_waitcnt vmcnt(16)
    ds_read_b128 v[104:107], v6 offset:46848
    v_cvt_pk_bf16_f32 v224, v40, v41
    v_mfma_f32_16x16x32_bf16 a[48:51], v[112:115], a[252:255], a[48:51]
    s_mov_b32 s37, 380928
    v_cvt_pk_bf16_f32 v225, v44, v45
    v_mfma_f32_16x16x32_bf16 a[52:55], v[68:71], a[252:255], a[52:55]
    buffer_load_dwordx4 a[208:211], v2, s[12:15], s37 offen offset:2048 sc1
    v_mfma_f32_16x16x32_bf16 a[56:59], v[72:75], a[252:255], a[56:59]
    global_load_short_d16_hi v13, v0, s[40:41] offset:0
    v_mfma_f32_16x16x32_bf16 a[60:63], v[76:79], a[252:255], a[60:63]
    ds_read_b128 v[108:111], v6 offset:46992
    v_lshlrev_b32 v40, 16, v58
    v_mfma_f32_16x16x32_bf16 a[64:67], v[80:83], a[252:255], a[64:67]
    s_mov_b32 s28, 408576
    v_and_b32 v41, s84, v58
    v_lshlrev_b32 v42, 16, v62
    v_mfma_f32_16x16x32_bf16 a[68:71], v[84:87], a[252:255], a[68:71]
    s_waitcnt vmcnt(17)
    v_and_b32 v43, s84, v62
    v_add_f32 v40, v40, v42
    v_mfma_f32_16x16x32_bf16 a[0:3], v[68:71], a[144:147], a[0:3]
    s_waitcnt vmcnt(16)
    buffer_load_dwordx4 a[212:215], v2, s[12:15], s28 offen offset:2048 sc1
    v_mfma_f32_16x16x32_bf16 a[0:3], v[72:75], a[148:151], a[0:3]
    global_load_short_d16_hi v14, v0, s[40:41] offset:32
    v_mfma_f32_16x16x32_bf16 a[4:7], v[72:75], a[144:147], a[4:7]
    v_add_f32 v41, v41, v43
    v_lshlrev_b32 v44, 16, v59
    v_mfma_f32_16x16x32_bf16 a[4:7], v[76:79], a[148:151], a[4:7]
    v_and_b32 v45, s84, v59
    v_lshlrev_b32 v46, 16, v63
    v_mfma_f32_16x16x32_bf16 a[8:11], v[76:79], a[144:147], a[8:11]
    s_mov_b32 s36, 451584
    v_and_b32 v47, s84, v63
    v_mfma_f32_16x16x32_bf16 a[8:11], v[80:83], a[148:151], a[8:11]
    buffer_load_dwordx4 a[216:219], v2, s[12:15], s36 offen offset:0 sc1
    v_mfma_f32_16x16x32_bf16 a[12:15], v[80:83], a[144:147], a[12:15]
    s_mov_b32 s37, 479232
    v_add_f32 v44, v44, v46
    v_add_f32 v45, v45, v47
    v_mfma_f32_16x16x32_bf16 a[12:15], v[84:87], a[148:151], a[12:15]
    global_load_short_d16_hi v15, v0, s[40:41] offset:64
    v_mfma_f32_16x16x32_bf16 a[16:19], v[84:87], a[144:147], a[16:19]
    s_waitcnt lgkmcnt(5)
    v_cvt_pk_bf16_f32 v226, v40, v41
    v_cvt_pk_bf16_f32 v227, v44, v45
    v_mfma_f32_16x16x32_bf16 a[16:19], v[88:91], a[148:151], a[16:19]
    buffer_load_dwordx4 a[220:223], v2, s[12:15], s37 offen offset:0 sc1
    v_mfma_f32_16x16x32_bf16 a[20:23], v[88:91], a[144:147], a[20:23]
    s_waitcnt lgkmcnt(4)
    v_mov_b32_dpp v228, v64 row_shr:15 row_mask:0xf bank_mask:0xf
    v_mov_b32_dpp v229, v65 row_shr:15 row_mask:0xf bank_mask:0xf
    v_mfma_f32_16x16x32_bf16 a[20:23], v[92:95], a[148:151], a[20:23]
    s_waitcnt vmcnt(20) lgkmcnt(2)
    v_mov_b32_dpp v230, v66 row_shr:15 row_mask:0xf bank_mask:0xf
    v_mfma_f32_16x16x32_bf16 a[20:23], v[100:103], a[152:155], a[20:23]
    s_waitcnt vmcnt(19)
    global_load_short_d16_hi v16, v0, s[42:43] offset:0
    v_mfma_f32_16x16x32_bf16 a[20:23], v[96:99], a[156:159], a[20:23]
    s_mov_b32 s28, 506880
    v_mov_b32_dpp v231, v67 row_shr:15 row_mask:0xf bank_mask:0xf
    v_mov_b32_dpp v228, v204 row_shl:1 row_mask:0xf bank_mask:0xf
    v_mfma_f32_16x16x32_bf16 a[16:19], v[96:99], a[152:155], a[16:19]
    buffer_load_dwordx4 a[224:227], v2, s[12:15], s28 offen offset:0 sc1
    v_mfma_f32_16x16x32_bf16 a[16:19], v[92:95], a[156:159], a[16:19]
    v_mov_b32_dpp v229, v205 row_shl:1 row_mask:0xf bank_mask:0xf
    v_mov_b32_dpp v230, v206 row_shl:1 row_mask:0xf bank_mask:0xf
    v_mfma_f32_16x16x32_bf16 a[12:15], v[92:95], a[152:155], a[12:15]
    v_mov_b32_dpp v231, v207 row_shl:1 row_mask:0xf bank_mask:0xf
    v_mfma_f32_16x16x32_bf16 a[12:15], v[88:91], a[156:159], a[12:15]
    s_mov_b32 s36, 534528
    v_mov_b32_dpp v232, v64 row_shr:14 row_mask:0xf bank_mask:0xf
    v_mfma_f32_16x16x32_bf16 a[8:11], v[88:91], a[152:155], a[8:11]
    global_load_short_d16_hi v17, v0, s[42:43] offset:32
    v_mfma_f32_16x16x32_bf16 a[8:11], v[84:87], a[156:159], a[8:11]
    buffer_load_dwordx4 a[228:231], v2, s[12:15], s36 offen offset:0 sc1
    v_mfma_f32_16x16x32_bf16 a[4:7], v[84:87], a[152:155], a[4:7]
    v_mov_b32_dpp v233, v65 row_shr:14 row_mask:0xf bank_mask:0xf
    v_mov_b32_dpp v234, v66 row_shr:14 row_mask:0xf bank_mask:0xf
    v_mfma_f32_16x16x32_bf16 a[4:7], v[80:83], a[156:159], a[4:7]
    v_mov_b32_dpp v235, v67 row_shr:14 row_mask:0xf bank_mask:0xf
    v_mov_b32_dpp v232, v208 row_shl:1 row_mask:0xf bank_mask:0xf
    v_mfma_f32_16x16x32_bf16 a[0:3], v[80:83], a[152:155], a[0:3]
    s_mov_b32 s37, 562176
    v_mov_b32_dpp v233, v209 row_shl:1 row_mask:0xf bank_mask:0xf
    v_mfma_f32_16x16x32_bf16 a[0:3], v[76:79], a[156:159], a[0:3]
    s_waitcnt vmcnt(22)
    global_load_short_d16_hi v18, v0, s[42:43] offset:64
    v_mfma_f32_16x16x32_bf16 a[0:3], v[84:87], a[160:163], a[0:3]
    s_waitcnt vmcnt(22)
    buffer_load_dwordx4 a[232:235], v2, s[12:15], s37 offen offset:0 sc1
    v_mfma_f32_16x16x32_bf16 a[0:3], v[88:91], a[164:167], a[0:3]
    v_mov_b32_dpp v234, v210 row_shl:1 row_mask:0xf bank_mask:0xf
    v_mov_b32_dpp v235, v211 row_shl:1 row_mask:0xf bank_mask:0xf
    v_mfma_f32_16x16x32_bf16 a[4:7], v[88:91], a[160:163], a[4:7]
    v_mov_b32_dpp v236, v64 row_shr:13 row_mask:0xf bank_mask:0xf
    v_mov_b32_dpp v237, v65 row_shr:13 row_mask:0xf bank_mask:0xf
    v_mfma_f32_16x16x32_bf16 a[4:7], v[92:95], a[164:167], a[4:7]
    v_mov_b32_dpp v238, v66 row_shr:13 row_mask:0xf bank_mask:0xf
    v_mfma_f32_16x16x32_bf16 a[8:11], v[92:95], a[160:163], a[8:11]
    s_mov_b32 s28, 589824
    v_mov_b32_dpp v239, v67 row_shr:13 row_mask:0xf bank_mask:0xf
    v_mfma_f32_16x16x32_bf16 a[8:11], v[96:99], a[164:167], a[8:11]
    buffer_load_dwordx4 a[236:239], v2, s[12:15], s28 offen offset:0 sc1
    v_mfma_f32_16x16x32_bf16 a[12:15], v[96:99], a[160:163], a[12:15]
    global_load_short_d16_hi v19, v0, s[44:45] offset:0
    v_mfma_f32_16x16x32_bf16 a[12:15], v[100:103], a[164:167], a[12:15]
    v_mov_b32_dpp v236, v212 row_shl:1 row_mask:0xf bank_mask:0xf
    v_mov_b32_dpp v237, v213 row_shl:1 row_mask:0xf bank_mask:0xf
    v_mfma_f32_16x16x32_bf16 a[16:19], v[100:103], a[160:163], a[16:19]
    s_waitcnt lgkmcnt(1)
    v_mov_b32_dpp v238, v214 row_shl:1 row_mask:0xf bank_mask:0xf
    v_mov_b32_dpp v239, v215 row_shl:1 row_mask:0xf bank_mask:0xf
    v_mfma_f32_16x16x32_bf16 a[16:19], v[104:107], a[164:167], a[16:19]
    s_mov_b32 s36, 617472
    v_mov_b32_dpp v240, v64 row_shr:12 row_mask:0xf bank_mask:0xf
    v_mfma_f32_16x16x32_bf16 a[20:23], v[104:107], a[160:163], a[20:23]
    s_waitcnt lgkmcnt(0)
    buffer_load_dwordx4 a[240:243], v2, s[12:15], s36 offen offset:0 sc1
    v_mfma_f32_16x16x32_bf16 a[20:23], v[108:111], a[164:167], a[20:23]
    s_waitcnt vmcnt(25)
    global_load_short_d16_hi v20, v0, s[44:45] offset:32
    v_mfma_f32_16x16x32_bf16 a[24:27], v[68:71], a[168:171], a[24:27]
    s_waitcnt vmcnt(25)
    v_mov_b32_dpp v241, v65 row_shr:12 row_mask:0xf bank_mask:0xf
    v_mov_b32_dpp v242, v66 row_shr:12 row_mask:0xf bank_mask:0xf
    v_mfma_f32_16x16x32_bf16 a[24:27], v[72:75], a[172:175], a[24:27]
    v_mov_b32_dpp v243, v67 row_shr:12 row_mask:0xf bank_mask:0xf
    v_mov_b32_dpp v240, v216 row_shl:1 row_mask:0xf bank_mask:0xf
    v_mfma_f32_16x16x32_bf16 a[28:31], v[72:75], a[168:171], a[28:31]
    s_mov_b32 s37, 645120
    v_mov_b32_dpp v241, v217 row_shl:1 row_mask:0xf bank_mask:0xf
    v_mfma_f32_16x16x32_bf16 a[28:31], v[76:79], a[172:175], a[28:31]
    buffer_load_dwordx4 a[244:247], v2, s[12:15], s37 offen offset:0 sc1
    v_mfma_f32_16x16x32_bf16 a[32:35], v[76:79], a[168:171], a[32:35]
    global_load_short_d16_hi v21, v0, s[44:45] offset:64
    v_mfma_f32_16x16x32_bf16 a[32:35], v[80:83], a[172:175], a[32:35]
    v_mov_b32_dpp v242, v218 row_shl:1 row_mask:0xf bank_mask:0xf
    v_mov_b32_dpp v243, v219 row_shl:1 row_mask:0xf bank_mask:0xf
    v_mfma_f32_16x16x32_bf16 a[36:39], v[80:83], a[168:171], a[36:39]
    v_mov_b32_dpp v244, v64 row_shr:11 row_mask:0xf bank_mask:0xf
    v_mov_b32_dpp v245, v65 row_shr:11 row_mask:0xf bank_mask:0xf
    v_mfma_f32_16x16x32_bf16 a[36:39], v[84:87], a[172:175], a[36:39]
    s_mov_b32 s28, 470016
    v_mov_b32_dpp v246, v66 row_shr:11 row_mask:0xf bank_mask:0xf
    v_mfma_f32_16x16x32_bf16 a[40:43], v[84:87], a[168:171], a[40:43]
    buffer_load_dwordx4 a[248:251], v35, s[12:15], s28 offen offset:0 sc1
    v_mfma_f32_16x16x32_bf16 a[40:43], v[88:91], a[172:175], a[40:43]
    v_mov_b32_dpp v247, v67 row_shr:11 row_mask:0xf bank_mask:0xf
    v_mov_b32_dpp v244, v220 row_shl:1 row_mask:0xf bank_mask:0xf
    v_mfma_f32_16x16x32_bf16 a[44:47], v[88:91], a[168:171], a[44:47]
    v_mov_b32_dpp v245, v221 row_shl:1 row_mask:0xf bank_mask:0xf
    v_mfma_f32_16x16x32_bf16 a[44:47], v[92:95], a[172:175], a[44:47]
    s_waitcnt vmcnt(27)
    v_mov_b32_dpp v246, v222 row_shl:1 row_mask:0xf bank_mask:0xf
    v_mfma_f32_16x16x32_bf16 a[44:47], v[100:103], a[176:179], a[44:47]
    s_waitcnt vmcnt(26)
    s_mov_b32 s36, 497664
    v_mov_b32_dpp v247, v223 row_shl:1 row_mask:0xf bank_mask:0xf
    v_mfma_f32_16x16x32_bf16 a[44:47], v[96:99], a[180:183], a[44:47]
    buffer_load_dwordx4 a[252:255], v35, s[12:15], s36 offen offset:0 sc1
    v_mfma_f32_16x16x32_bf16 a[40:43], v[96:99], a[176:179], a[40:43]
    v_mov_b32_dpp v248, v64 row_shr:10 row_mask:0xf bank_mask:0xf
    v_mov_b32_dpp v249, v65 row_shr:10 row_mask:0xf bank_mask:0xf
    v_mfma_f32_16x16x32_bf16 a[40:43], v[92:95], a[180:183], a[40:43]
    v_mov_b32_dpp v250, v66 row_shr:10 row_mask:0xf bank_mask:0xf
    v_mfma_f32_16x16x32_bf16 a[36:39], v[92:95], a[176:179], a[36:39]
    v_mov_b32_dpp v251, v67 row_shr:10 row_mask:0xf bank_mask:0xf
    v_mfma_f32_16x16x32_bf16 a[36:39], v[88:91], a[180:183], a[36:39]
    s_mov_b32 s37, 525312
    v_mov_b32_dpp v248, v224 row_shl:1 row_mask:0xf bank_mask:0xf
    v_mfma_f32_16x16x32_bf16 a[32:35], v[88:91], a[176:179], a[32:35]
    buffer_load_dwordx4 a[144:147], v35, s[12:15], s37 offen offset:0 sc1
    v_mfma_f32_16x16x32_bf16 a[32:35], v[84:87], a[180:183], a[32:35]
    s_bitcmp1_b32 s30, 0
    v_mov_b32_dpp v249, v225 row_shl:1 row_mask:0xf bank_mask:0xf
    v_mov_b32_dpp v250, v226 row_shl:1 row_mask:0xf bank_mask:0xf
    v_mfma_f32_16x16x32_bf16 a[28:31], v[84:87], a[176:179], a[28:31]
    s_barrier
    v_mfma_f32_16x16x32_bf16 a[28:31], v[80:83], a[180:183], a[28:31]
    s_cbranch_scc1 Lsp3
Lsp2:
    v_mov_b32_dpp v251, v227 row_shl:1 row_mask:0xf bank_mask:0xf
    v_mov_b32_dpp v252, v64 row_shr:9 row_mask:0xf bank_mask:0xf
    v_mfma_f32_16x16x32_bf16 a[24:27], v[80:83], a[176:179], a[24:27]
    s_mov_b32 s28, 457728
    v_mov_b32 v118, 0xbdd2d3e8
    v_mov_b32 v119, 0xc0135761
    v_mfma_f32_16x16x32_bf16 a[24:27], v[76:79], a[180:183], a[24:27]
    s_waitcnt vmcnt(27)
    buffer_load_dwordx4 a[148:151], v2, s[12:15], s28 offen offset:0 sc1
    v_mfma_f32_16x16x32_bf16 a[24:27], v[84:87], a[184:187], a[24:27]
    s_waitcnt vmcnt(27)
    v_mov_b32 v4, 0x39035177
    v_mov_b32 v5, 0x3727c5ac
    v_mfma_f32_16x16x32_bf16 a[24:27], v[88:91], a[188:191], a[24:27]
    s_movk_i32 s48, 1440
    v_mov_b32 v33, 0
    v_mov_b32 v34, 0
    v_mfma_f32_16x16x32_bf16 a[28:31], v[88:91], a[184:187], a[28:31]
    s_lshl_b32 s6, s31, 5
    v_mov_b32 v36, 0
    v_mov_b32 v37, 0
    v_mfma_f32_16x16x32_bf16 a[28:31], v[92:95], a[188:191], a[28:31]
    s_mov_b32 s36, 485376
    v_mov_b32 v38, 0
    v_mov_b32 v35, 0
    v_mfma_f32_16x16x32_bf16 a[32:35], v[92:95], a[184:187], a[32:35]
    buffer_load_dwordx4 a[152:155], v2, s[12:15], s36 offen offset:0 sc1
    v_mfma_f32_16x16x32_bf16 a[32:35], v[96:99], a[188:191], a[32:35]
    s_movk_i32 s47, 864
    v_mov_b32_dpp v253, v65 row_shr:9 row_mask:0xf bank_mask:0xf
    v_mov_b32_dpp v254, v66 row_shr:9 row_mask:0xf bank_mask:0xf
    v_mfma_f32_16x16x32_bf16 a[36:39], v[96:99], a[184:187], a[36:39]
    s_movk_i32 s46, 1728
    v_mov_b32_dpp v255, v67 row_shr:9 row_mask:0xf bank_mask:0xf
    v_mov_b32_dpp v252, v228 row_shl:1 row_mask:0xf bank_mask:0xf
    v_mfma_f32_16x16x32_bf16 a[36:39], v[100:103], a[188:191], a[36:39]
    s_movk_i32 s39, 1152
    v_mov_b32_dpp v253, v229 row_shl:1 row_mask:0xf bank_mask:0xf
    v_mov_b32_dpp v254, v230 row_shl:1 row_mask:0xf bank_mask:0xf
    v_mfma_f32_16x16x32_bf16 a[40:43], v[100:103], a[184:187], a[40:43]
    s_mov_b32 s37, 513024
    s_movk_i32 s38, 2016
    v_mov_b32_dpp v255, v231 row_shl:1 row_mask:0xf bank_mask:0xf
    v_mfma_f32_16x16x32_bf16 a[40:43], v[104:107], a[188:191], a[40:43]
    buffer_load_dwordx4 a[156:159], v2, s[12:15], s37 offen offset:0 sc1
    v_mfma_f32_16x16x32_bf16 a[44:47], v[104:107], a[184:187], a[44:47]
    ds_write_b32 v22, a4 offset:1024
    v_mfma_f32_16x16x32_bf16 a[44:47], v[108:111], a[188:191], a[44:47]
    s_waitcnt vmcnt(28)
    ds_write_b32 v22, a5 offset:1028
    v_mfma_f32_16x16x32_bf16 a[48:51], v[68:71], a[192:195], a[48:51]
    s_waitcnt vmcnt(27)
    ds_write_b32 v22, a6 offset:1536
    v_mfma_f32_16x16x32_bf16 a[48:51], v[72:75], a[196:199], a[48:51]
    s_mov_b32 s28, 540672
    ds_write_b32 v22, a7 offset:1540
    v_mfma_f32_16x16x32_bf16 a[52:55], v[72:75], a[192:195], a[52:55]
    buffer_load_dwordx4 a[160:163], v2, s[12:15], s28 offen offset:0 sc1
    v_mfma_f32_16x16x32_bf16 a[52:55], v[76:79], a[196:199], a[52:55]
    ds_write_b32 v22, a8 offset:4096
    v_mfma_f32_16x16x32_bf16 a[56:59], v[76:79], a[192:195], a[56:59]
    ds_write_b32 v22, a9 offset:4100
    v_mfma_f32_16x16x32_bf16 a[56:59], v[80:83], a[196:199], a[56:59]
    s_mov_b32 s36, 568320
    ds_write_b32 v22, a10 offset:4608
    v_mfma_f32_16x16x32_bf16 a[60:63], v[80:83], a[192:195], a[60:63]
    buffer_load_dwordx4 a[164:167], v2, s[12:15], s36 offen offset:0 sc1
    v_mfma_f32_16x16x32_bf16 a[60:63], v[84:87], a[196:199], a[60:63]
    ds_write_b32 v22, a11 offset:4612
    v_mfma_f32_16x16x32_bf16 a[64:67], v[84:87], a[192:195], a[64:67]
    ds_write_b32 v22, a12 offset:7168
    v_mfma_f32_16x16x32_bf16 a[64:67], v[88:91], a[196:199], a[64:67]
    ds_write_b32 v22, a13 offset:7172
    v_mfma_f32_16x16x32_bf16 a[68:71], v[88:91], a[192:195], a[68:71]
    s_mov_b32 s37, 595968
    ds_write_b32 v22, a14 offset:7680
    v_mfma_f32_16x16x32_bf16 a[68:71], v[92:95], a[196:199], a[68:71]
    s_waitcnt vmcnt(28)
    buffer_load_dwordx4 a[168:171], v2, s[12:15], s37 offen offset:0 sc1
    v_mfma_f32_16x16x32_bf16 a[68:71], v[100:103], a[200:203], a[68:71]
    s_waitcnt vmcnt(28)
    ds_write_b32 v22, a15 offset:7684
    v_mfma_f32_16x16x32_bf16 a[68:71], v[96:99], a[204:207], a[68:71]
    ds_write_b32 v22, a20 offset:14336
    v_mfma_f32_16x16x32_bf16 a[64:67], v[96:99], a[200:203], a[64:67]
    ds_write_b32 v22, a21 offset:14340
    v_mfma_f32_16x16x32_bf16 a[64:67], v[92:95], a[204:207], a[64:67]
    s_mov_b32 s28, 623616
    ds_write_b32 v22, a22 offset:14848
    v_mfma_f32_16x16x32_bf16 a[60:63], v[92:95], a[200:203], a[60:63]
    buffer_load_dwordx4 a[172:175], v2, s[12:15], s28 offen offset:0 sc1
    v_mfma_f32_16x16x32_bf16 a[60:63], v[88:91], a[204:207], a[60:63]
    ds_write_b32 v22, a23 offset:14852
    v_mfma_f32_16x16x32_bf16 a[56:59], v[88:91], a[200:203], a[56:59]
    ds_write_b32 v22, a0 offset:17284
    v_mfma_f32_16x16x32_bf16 a[56:59], v[84:87], a[204:207], a[56:59]
    ds_write_b32 v22, a1 offset:16384
    v_mfma_f32_16x16x32_bf16 a[52:55], v[84:87], a[200:203], a[52:55]
    s_mov_b32 s36, 651264
    ds_write_b32 v22, a2 offset:16388
    v_mfma_f32_16x16x32_bf16 a[52:55], v[80:83], a[204:207], a[52:55]
    buffer_load_dwordx4 a[176:179], v2, s[12:15], s36 offen offset:0 sc1
    v_mfma_f32_16x16x32_bf16 a[48:51], v[80:83], a[200:203], a[48:51]
Lt9:
    s_cbranch_execz Lt10
    ds_write_b32 v22, a3 offset:17408
    v_mfma_f32_16x16x32_bf16 a[48:51], v[76:79], a[204:207], a[48:51]
    s_waitcnt vmcnt(29)
    s_movk_i32 s49, 2304
    ds_write_b32 v22, a28 offset:20480
    v_mfma_f32_16x16x32_bf16 a[48:51], v[84:87], a[208:211], a[48:51]
    s_waitcnt vmcnt(27)
    ds_write_b32 v22, a29 offset:20484
    v_mfma_f32_16x16x32_bf16 a[48:51], v[88:91], a[212:215], a[48:51]
    s_mov_b32 s37, 451584
    ds_write_b32 v22, a30 offset:20992
    v_mfma_f32_16x16x32_bf16 a[52:55], v[88:91], a[208:211], a[52:55]
    buffer_load_dwordx4 a[180:183], v2, s[12:15], s37 offen offset:1024 sc1
    v_mfma_f32_16x16x32_bf16 a[52:55], v[92:95], a[212:215], a[52:55]
    ds_write_b32 v22, a31 offset:20996
    v_mfma_f32_16x16x32_bf16 a[56:59], v[92:95], a[208:211], a[56:59]
    ds_write_b32 v22, a32 offset:23552
    v_mfma_f32_16x16x32_bf16 a[56:59], v[96:99], a[212:215], a[56:59]
    ds_write_b32 v22, a33 offset:23556
    v_mfma_f32_16x16x32_bf16 a[60:63], v[96:99], a[208:211], a[60:63]
    s_mov_b32 s28, 479232
    ds_write_b32 v22, a34 offset:24064
    v_mfma_f32_16x16x32_bf16 a[60:63], v[100:103], a[212:215], a[60:63]
    buffer_load_dwordx4 a[184:187], v2, s[12:15], s28 offen offset:1024 sc1
    v_mfma_f32_16x16x32_bf16 a[64:67], v[100:103], a[208:211], a[64:67]
    ds_write_b32 v22, a35 offset:24068
    v_mfma_f32_16x16x32_bf16 a[64:67], v[104:107], a[212:215], a[64:67]
    ds_write_b32 v22, a36 offset:26624
    v_mfma_f32_16x16x32_bf16 a[68:71], v[104:107], a[208:211], a[68:71]
    ds_write_b32 v22, a37 offset:26628
    v_mfma_f32_16x16x32_bf16 a[68:71], v[108:111], a[212:215], a[68:71]
    s_waitcnt vmcnt(27)
    s_mov_b32 s36, 506880
    ds_write_b32 v22, a38 offset:27136
    v_mfma_f32_16x16x32_bf16 a[72:75], v[120:123], a[216:219], a[0:3]
    s_waitcnt vmcnt(25)
    buffer_load_dwordx4 a[188:191], v2, s[12:15], s36 offen offset:1024 sc1
    v_mfma_f32_16x16x32_bf16 a[72:75], v[124:127], a[220:223], a[72:75]
    ds_write_b32 v22, a39 offset:27140
    v_mfma_f32_16x16x32_bf16 a[76:79], v[124:127], a[216:219], a[4:7]
    ds_write_b32 v22, a44 offset:33792
    v_mfma_f32_16x16x32_bf16 a[76:79], v[128:131], a[220:223], a[76:79]
    ds_write_b32 v22, a45 offset:33796
    v_mfma_f32_16x16x32_bf16 a[80:83], v[128:131], a[216:219], a[8:11]
    s_mov_b32 s37, 534528
    ds_write_b32 v22, a46 offset:34304
    v_mfma_f32_16x16x32_bf16 a[80:83], v[132:135], a[220:223], a[80:83]
    buffer_load_dwordx4 a[192:195], v2, s[12:15], s37 offen offset:1024 sc1
    v_mfma_f32_16x16x32_bf16 a[84:87], v[132:135], a[216:219], a[12:15]
    ds_write_b32 v22, a47 offset:34308
    v_mfma_f32_16x16x32_bf16 a[84:87], v[136:139], a[220:223], a[84:87]
    ds_write_b32 v22, a24 offset:36740
    v_mfma_f32_16x16x32_bf16 a[88:91], v[136:139], a[216:219], a[16:19]
    ds_write_b32 v22, a25 offset:35840
    v_mfma_f32_16x16x32_bf16 a[88:91], v[140:143], a[220:223], a[88:91]
    s_mov_b32 s28, 562176
    ds_write_b32 v22, a26 offset:35844
    v_mfma_f32_16x16x32_bf16 a[92:95], v[140:143], a[216:219], a[20:23]
    buffer_load_dwordx4 a[196:199], v2, s[12:15], s28 offen offset:1024 sc1
    v_mfma_f32_16x16x32_bf16 a[92:95], v[144:147], a[220:223], a[92:95]
    s_waitcnt vmcnt(24)
    ds_write_b32 v22, a27 offset:36864
    v_mfma_f32_16x16x32_bf16 a[92:95], v[152:155], a[228:231], a[92:95]
    ds_write_b32 v22, a52 offset:39936
    v_mfma_f32_16x16x32_bf16 a[92:95], v[148:151], a[224:227], a[92:95]
    ds_write_b32 v22, a53 offset:39940
    v_mfma_f32_16x16x32_bf16 a[88:91], v[148:151], a[228:231], a[88:91]
    s_mov_b32 s36, 589824
    ds_write_b32 v22, a54 offset:40448
    v_mfma_f32_16x16x32_bf16 a[88:91], v[144:147], a[224:227], a[88:91]
    buffer_load_dwordx4 a[200:203], v2, s[12:15], s36 offen offset:1024 sc1
    v_mfma_f32_16x16x32_bf16 a[84:87], v[144:147], a[228:231], a[84:87]
    ds_write_b32 v22, a55 offset:40452
    v_mfma_f32_16x16x32_bf16 a[84:87], v[140:143], a[224:227], a[84:87]
    ds_write_b32 v22, a64 offset:50176
    v_mfma_f32_16x16x32_bf16 a[80:83], v[140:143], a[228:231], a[80:83]
    ds_write_b32 v22, a65 offset:50180
    v_mfma_f32_16x16x32_bf16 a[80:83], v[136:139], a[224:227], a[80:83]
    s_mov_b32 s37, 617472
    ds_write_b32 v22, a66 offset:50688
    v_mfma_f32_16x16x32_bf16 a[76:79], v[136:139], a[228:231], a[76:79]
    buffer_load_dwordx4 a[204:207], v2, s[12:15], s37 offen offset:1024 sc1
    v_mfma_f32_16x16x32_bf16 a[76:79], v[132:135], a[224:227], a[76:79]
    ds_write_b32 v22, a67 offset:50692
    v_mfma_f32_16x16x32_bf16 a[72:75], v[132:135], a[228:231], a[72:75]
    ds_write_b32 v22, a68 offset:53248
    v_mfma_f32_16x16x32_bf16 a[72:75], v[128:131], a[224:227], a[72:75]
    s_waitcnt vmcnt(24)
    ds_write_b32 v22, a69 offset:53252
    v_mfma_f32_16x16x32_bf16 a[72:75], v[136:139], a[232:235], a[72:75]
    s_waitcnt vmcnt(23)
    s_mov_b32 s28, 645120
    ds_write_b32 v22, a70 offset:53760
    v_mfma_f32_16x16x32_bf16 a[72:75], v[140:143], a[236:239], a[72:75]
    buffer_load_dwordx4 a[208:211], v2, s[12:15], s28 offen offset:1024 sc1
    v_mfma_f32_16x16x32_bf16 a[76:79], v[140:143], a[232:235], a[76:79]
    ds_write_b32 v22, a71 offset:53764
    v_mfma_f32_16x16x32_bf16 a[76:79], v[144:147], a[236:239], a[76:79]
    ds_write_b32 v22, a48 offset:56196
    v_mfma_f32_16x16x32_bf16 a[80:83], v[144:147], a[232:235], a[80:83]
    s_waitcnt lgkmcnt(13)
    s_barrier
    v_mfma_f32_16x16x32_bf16 a[80:83], v[148:151], a[236:239], a[80:83]
    s_mov_b32 s36, 470016
    ds_write_b32 v22, a49 offset:55296
    v_mfma_f32_16x16x32_bf16 a[84:87], v[148:151], a[232:235], a[84:87]
    buffer_load_dwordx4 a[212:215], v2, s[12:15], s36 offen offset:1024 sc1
    v_mfma_f32_16x16x32_bf16 a[84:87], v[152:155], a[236:239], a[84:87]
    ds_write_b32 v22, a50 offset:55300
    v_mfma_f32_16x16x32_bf16 a[88:91], v[152:155], a[232:235], a[88:91]
    ds_write_b32 v22, a51 offset:56320
    v_mfma_f32_16x16x32_bf16 a[88:91], v[156:159], a[236:239], a[88:91]
    v_min_u32 v47, 35, v1
    v_add_u32 v47, 72, v47
    v_mfma_f32_16x16x32_bf16 a[92:95], v[156:159], a[232:235], a[92:95]
    s_mov_b32 s37, 497664
    v_mul_u32_u24 v47, 384, v47
    v_add_u32 v47, s6, v47
    v_mfma_f32_16x16x32_bf16 a[92:95], v[160:163], a[236:239], a[92:95]
    s_waitcnt vmcnt(21)
    buffer_load_dwordx4 a[216:219], v2, s[12:15], s37 offen offset:1024 sc1
    v_mfma_f32_16x16x32_bf16 a[92:95], v[168:171], a[244:247], a[92:95]
    ds_read2st64_b64 v[104:107], v22 offset0:20 offset1:21
    v_accvgpr_read_b32 v68, a16
    v_mfma_f32_16x16x32_bf16 a[92:95], v[164:167], a[240:243], a[92:95]
    v_accvgpr_read_b32 v69, a17
    v_accvgpr_read_b32 v70, a18
    v_mfma_f32_16x16x32_bf16 a[88:91], v[164:167], a[244:247], a[88:91]
    s_mov_b32 s28, 525312
    ds_read2st64_b64 v[108:111], v22 offset0:22 offset1:23
    v_accvgpr_read_b32 v71, a19
    v_mfma_f32_16x16x32_bf16 a[88:91], v[160:163], a[240:243], a[88:91]
    buffer_load_dwordx4 a[220:223], v2, s[12:15], s28 offen offset:1024 sc1
    v_mfma_f32_16x16x32_bf16 a[84:87], v[160:163], a[244:247], a[84:87]
    ds_read2st64_b64 v[112:115], v22 offset0:18 offset1:19
    v_lshrrev_b32 v45, 5, v1
    v_mfma_f32_16x16x32_bf16 a[84:87], v[156:159], a[240:243], a[84:87]
    v_mul_i32_i24 v46, 4608, v45
    v_add_u32 v46, -3072, v46
    v_mfma_f32_16x16x32_bf16 a[80:83], v[156:159], a[244:247], a[80:83]
    v_add_u32 v30, v116, v46
    v_mul_i32_i24 v46, 4608, v45
    v_mfma_f32_16x16x32_bf16 a[80:83], v[152:155], a[240:243], a[80:83]
    s_mov_b32 s36, 457728
    v_add_u32 v46, -2560, v46
    v_add_u32 v32, v116, v46
    v_mfma_f32_16x16x32_bf16 a[76:79], v[152:155], a[244:247], a[76:79]
    buffer_load_dwordx4 a[224:227], v2, s[12:15], s36 offen offset:1024 sc1
    v_mfma_f32_16x16x32_bf16 a[76:79], v[148:151], a[240:243], a[76:79]
    s_waitcnt lgkmcnt(2)
    ds_read2st64_b64 v[48:51], v22 offset0:58 offset1:59
    v_add_f32 v68, v68, v104
    v_mfma_f32_16x16x32_bf16 a[72:75], v[148:151], a[244:247], a[72:75]
    s_mov_b32 s37, 485376
    v_add_f32 v69, v69, v105
    v_add_f32 v70, v70, v106
    v_mfma_f32_16x16x32_bf16 a[72:75], v[144:147], a[240:243], a[72:75]
    s_waitcnt vmcnt(22)
    ds_read2st64_b64 v[52:55], v22 offset0:60 offset1:61
    v_add_f32 v71, v71, v107
    v_mfma_f32_16x16x32_bf16 a[72:75], v[172:175], a[248:251], a[72:75]
    s_waitcnt vmcnt(21) lgkmcnt(2)
    v_add_f32 v108, v108, v112
    v_add_f32 v109, v109, v113
    v_mfma_f32_16x16x32_bf16 a[72:75], v[176:179], a[252:255], a[72:75]
    buffer_load_dwordx4 a[228:231], v2, s[12:15], s37 offen offset:1024 sc1
    v_mfma_f32_16x16x32_bf16 a[76:79], v[176:179], a[248:251], a[76:79]
    ds_read2st64_b64 v[56:59], v22 offset0:56 offset1:57
    v_add_f32 v110, v110, v114
    v_mfma_f32_16x16x32_bf16 a[76:79], v[180:183], a[252:255], a[76:79]
    v_add_f32 v111, v111, v115
    v_add_f32 v68, v68, v108
    v_mfma_f32_16x16x32_bf16 a[80:83], v[180:183], a[248:251], a[80:83]
    v_add_f32 v69, v69, v109
    v_add_f32 v70, v70, v110
    v_mfma_f32_16x16x32_bf16 a[80:83], v[184:187], a[252:255], a[80:83]
    s_mov_b32 s28, 513024
    v_add_f32 v71, v71, v111
    v_cndmask_b32 v69, 0, v69, s[76:77]
    v_mfma_f32_16x16x32_bf16 a[84:87], v[184:187], a[248:251], a[84:87]
    buffer_load_dwordx4 a[232:235], v2, s[12:15], s28 offen offset:1024 sc1
    v_mfma_f32_16x16x32_bf16 a[84:87], v[188:191], a[252:255], a[84:87]
    v_cndmask_b32 v70, 0, v70, s[76:77]
    v_cndmask_b32 v71, 0, v71, s[76:77]
    v_mfma_f32_16x16x32_bf16 a[88:91], v[188:191], a[248:251], a[88:91]
    v_add_f32 v33, v33, v68
    v_fmac_f32 v36, v68, v68
    v_mfma_f32_16x16x32_bf16 a[88:91], v[192:195], a[252:255], a[88:91]
    v_add_f32 v33, v33, v69
    v_fmac_f32 v36, v69, v69
    v_mfma_f32_16x16x32_bf16 a[92:95], v[192:195], a[248:251], a[92:95]
    s_mov_b32 s36, 540672
    v_add_f32 v33, v33, v70
    v_fmac_f32 v36, v70, v70
    v_mfma_f32_16x16x32_bf16 a[92:95], v[196:199], a[252:255], a[92:95]
    s_waitcnt vmcnt(21)
    buffer_load_dwordx4 a[236:239], v2, s[12:15], s36 offen offset:1024 sc1
    v_mfma_f32_16x16x32_bf16 a[92:95], v[224:227], a[148:151], a[92:95]
    v_add_f32 v33, v33, v71
    v_fmac_f32 v36, v71, v71
    v_mfma_f32_16x16x32_bf16 a[92:95], v[200:203], a[144:147], a[92:95]
    v_accvgpr_read_b32 v80, a40
    v_accvgpr_read_b32 v81, a41
    v_mfma_f32_16x16x32_bf16 a[88:91], v[220:223], a[148:151], a[88:91]
    s_mov_b32 s37, 568320
    v_accvgpr_read_b32 v82, a42
    v_accvgpr_read_b32 v83, a43
    v_mfma_f32_16x16x32_bf16 a[88:91], v[196:199], a[144:147], a[88:91]
    s_waitcnt lgkmcnt(2)
    v_add_f32 v80, v80, v48
    v_add_f32 v81, v81, v49
    v_mfma_f32_16x16x32_bf16 a[84:87], v[216:219], a[148:151], a[84:87]
    buffer_load_dwordx4 a[240:243], v2, s[12:15], s37 offen offset:1024 sc1
    v_mfma_f32_16x16x32_bf16 a[84:87], v[192:195], a[144:147], a[84:87]
    v_add_f32 v82, v82, v50
    v_add_f32 v83, v83, v51
    v_mfma_f32_16x16x32_bf16 a[80:83], v[212:215], a[148:151], a[80:83]
    s_waitcnt lgkmcnt(0)
    v_add_f32 v52, v52, v56
    v_add_f32 v53, v53, v57
    v_mfma_f32_16x16x32_bf16 a[80:83], v[188:191], a[144:147], a[80:83]
    s_mov_b32 s28, 595968
    v_add_f32 v54, v54, v58
    v_add_f32 v55, v55, v59
    v_mfma_f32_16x16x32_bf16 a[76:79], v[208:211], a[148:151], a[76:79]
    s_barrier
    v_mfma_f32_16x16x32_bf16 a[76:79], v[184:187], a[144:147], a[76:79]
    buffer_load_dwordx4 a[244:247], v2, s[12:15], s28 offen offset:1024 sc1
    v_mfma_f32_16x16x32_bf16 a[72:75], v[204:207], a[148:151], a[72:75]
    v_add_f32 v80, v80, v52
    v_add_f32 v81, v81, v53
    v_mfma_f32_16x16x32_bf16 a[72:75], v[180:183], a[144:147], a[72:75]
    s_waitcnt vmcnt(23)
    v_add_f32 v82, v82, v54
    v_add_f32 v83, v83, v55
    v_mfma_f32_16x16x32_bf16 a[72:75], v[208:211], a[152:155], a[72:75]
    s_waitcnt vmcnt(22)
    v_cndmask_b32 v81, 0, v81, s[76:77]
    v_cndmask_b32 v82, 0, v82, s[76:77]
    v_mfma_f32_16x16x32_bf16 a[72:75], v[212:215], a[156:159], a[72:75]
    s_mov_b32 s36, 623616
    v_cndmask_b32 v83, 0, v83, s[76:77]
    v_add_f32 v34, v34, v80
    v_mfma_f32_16x16x32_bf16 a[76:79], v[212:215], a[152:155], a[76:79]
    buffer_load_dwordx4 a[248:251], v2, s[12:15], s36 offen offset:1024 sc1
    v_mfma_f32_16x16x32_bf16 a[76:79], v[216:219], a[156:159], a[76:79]
    v_fmac_f32 v37, v80, v80
    v_add_f32 v34, v34, v81
    v_mfma_f32_16x16x32_bf16 a[80:83], v[216:219], a[152:155], a[80:83]
    v_fmac_f32 v37, v81, v81
    v_add_f32 v34, v34, v82
    v_mfma_f32_16x16x32_bf16 a[80:83], v[220:223], a[156:159], a[80:83]
    v_fmac_f32 v37, v82, v82
    v_add_f32 v34, v34, v83
    v_mfma_f32_16x16x32_bf16 a[84:87], v[220:223], a[152:155], a[84:87]
    s_mov_b32 s37, 651264
    ds_read2st64_b64 v[104:107], v22 offset0:84 offset1:85
    v_fmac_f32 v37, v83, v83
    v_mfma_f32_16x16x32_bf16 a[84:87], v[224:227], a[156:159], a[84:87]
    buffer_load_dwordx4 a[252:255], v2, s[12:15], s37 offen offset:1024 sc1
    v_mfma_f32_16x16x32_bf16 a[88:91], v[224:227], a[152:155], a[88:91]
    v_accvgpr_read_b32 v92, a56
    v_accvgpr_read_b32 v93, a57
    v_mfma_f32_16x16x32_bf16 a[88:91], v[228:231], a[156:159], a[88:91]
    ds_read2st64_b64 v[108:111], v22 offset0:86 offset1:87
    v_accvgpr_read_b32 v94, a58
    v_mfma_f32_16x16x32_bf16 a[92:95], v[228:231], a[152:155], a[92:95]
    s_mov_b32 s28, 451584
    v_accvgpr_read_b32 v95, a59
    v_mul_i32_i24 v46, -4096, v45
    v_mfma_f32_16x16x32_bf16 a[92:95], v[232:235], a[156:159], a[92:95]
    s_waitcnt vmcnt(23)
    ds_read2st64_b64 v[112:115], v22 offset0:82 offset1:83
    v_add_u32 v46, 6656, v46
    v_mfma_f32_16x16x32_bf16 a[72:75], v[216:219], a[160:163], a[72:75]
    s_waitcnt vmcnt(22)
    buffer_load_dwordx4 a[144:147], v2, s[12:15], s28 offen offset:2048 sc1
    v_mfma_f32_16x16x32_bf16 a[72:75], v[220:223], a[164:167], a[72:75]
    s_waitcnt vmcnt(22)
    v_add_u32 v44, v116, v46
    v_mfma_f32_16x16x32_bf16 a[72:75], v[224:227], a[168:171], a[72:75]
    s_waitcnt vmcnt(21) lgkmcnt(2)
    ds_read2st64_b64 v[48:51], v22 offset0:90 offset1:91
    v_add_f32 v92, v92, v104
    v_mfma_f32_16x16x32_bf16 a[72:75], v[228:231], a[172:175], a[72:75]
    s_waitcnt vmcnt(20)
    v_add_f32 v93, v93, v105
    v_add_f32 v94, v94, v106
    v_mfma_f32_16x16x32_bf16 a[72:75], v[232:235], a[176:179], a[72:75]
    s_mov_b32 s36, 479232
    ds_read2st64_b64 v[52:55], v22 offset0:92 offset1:93
    v_add_f32 v95, v95, v107
    v_mfma_f32_16x16x32_bf16 a[76:79], v[236:239], a[176:179], a[76:79]
    buffer_load_dwordx4 a[148:151], v2, s[12:15], s36 offen offset:2048 sc1
    v_mfma_f32_16x16x32_bf16 a[76:79], v[232:235], a[172:175], a[76:79]
    s_waitcnt lgkmcnt(2)
    v_add_f32 v108, v108, v112
    v_add_f32 v109, v109, v113
    v_mfma_f32_16x16x32_bf16 a[76:79], v[228:231], a[168:171], a[76:79]
    ds_write_b64 v23, a[72:73] offset:1024
    v_mfma_f32_16x16x32_bf16 a[76:79], v[224:227], a[164:167], a[76:79]
    s_mov_b32 s37, 506880
    ds_read2st64_b64 v[56:59], v22 offset0:88 offset1:89
    v_add_f32 v110, v110, v114
    v_mfma_f32_16x16x32_bf16 a[76:79], v[220:223], a[160:163], a[76:79]
    ds_write_b64 v23, a[74:75] offset:1536
    v_mfma_f32_16x16x32_bf16 a[88:91], v[232:235], a[160:163], a[88:91]
    buffer_load_dwordx4 a[152:155], v2, s[12:15], s37 offen offset:2048 sc1
    v_mfma_f32_16x16x32_bf16 a[88:91], v[236:239], a[164:167], a[88:91]
    v_add_f32 v111, v111, v115
    v_add_f32 v92, v92, v108
    v_mfma_f32_16x16x32_bf16 a[88:91], v[240:243], a[168:171], a[88:91]
    ds_write_b64 v23, a[76:77] offset:4096
    v_mfma_f32_16x16x32_bf16 a[88:91], v[244:247], a[172:175], a[88:91]
    s_mov_b32 s28, 534528
    v_add_f32 v93, v93, v109
    v_add_f32 v94, v94, v110
    v_mfma_f32_16x16x32_bf16 a[88:91], v[248:251], a[176:179], a[88:91]
    ds_write_b64 v23, a[78:79] offset:4608
    v_mfma_f32_16x16x32_bf16 a[92:95], v[252:255], a[176:179], a[92:95]
    buffer_load_dwordx4 a[156:159], v2, s[12:15], s28 offen offset:2048 sc1
    v_mfma_f32_16x16x32_bf16 a[92:95], v[248:251], a[172:175], a[92:95]
    v_add_f32 v95, v95, v111
    v_cndmask_b32 v93, 0, v93, s[76:77]
    v_mfma_f32_16x16x32_bf16 a[92:95], v[244:247], a[168:171], a[92:95]
    ds_write_b64 v23, a[88:89] offset:14336
    v_mfma_f32_16x16x32_bf16 a[92:95], v[240:243], a[164:167], a[92:95]
    v_cndmask_b32 v94, 0, v94, s[76:77]
    v_cndmask_b32 v95, 0, v95, s[76:77]
    v_mfma_f32_16x16x32_bf16 a[92:95], v[236:239], a[160:163], a[92:95]
    ds_write_b64 v23, a[90:91] offset:14848
    v_mfma_f32_16x16x32_bf16 a[80:83], v[224:227], a[160:163], a[80:83]
    v_add_f32 v35, v35, v92
    v_fmac_f32 v38, v92, v92
    v_mfma_f32_16x16x32_bf16 a[80:83], v[228:231], a[164:167], a[80:83]
    v_add_f32 v35, v35, v93
    v_fmac_f32 v38, v93, v93
    v_mfma_f32_16x16x32_bf16 a[80:83], v[232:235], a[168:171], a[80:83]
    ds_write_b64 v23, a[92:93] offset:17408
    v_mfma_f32_16x16x32_bf16 a[80:83], v[236:239], a[172:175], a[80:83]
    v_add_f32 v35, v35, v94
    v_fmac_f32 v38, v94, v94
    v_mfma_f32_16x16x32_bf16 a[80:83], v[240:243], a[176:179], a[80:83]
    ds_write_b64 v23, a[94:95] offset:17920
    v_mfma_f32_16x16x32_bf16 a[84:87], v[244:247], a[176:179], a[84:87]
    v_add_f32 v35, v35, v95
    v_fmac_f32 v38, v95, v95
    v_mfma_f32_16x16x32_bf16 a[84:87], v[240:243], a[172:175], a[84:87]
    v_accvgpr_read_b32 v96, a60
    v_accvgpr_read_b32 v97, a61
    v_mfma_f32_16x16x32_bf16 a[84:87], v[236:239], a[168:171], a[84:87]
    s_mov_b32 s36, 562176
    v_accvgpr_read_b32 v98, a62
    v_accvgpr_read_b32 v99, a63
    v_mfma_f32_16x16x32_bf16 a[84:87], v[232:235], a[164:167], a[84:87]
    s_waitcnt lgkmcnt(10)
    v_add_f32 v96, v96, v48
    v_add_f32 v97, v97, v49
    v_mfma_f32_16x16x32_bf16 a[84:87], v[228:231], a[160:163], a[84:87]
    s_waitcnt vmcnt(22)
    buffer_load_dwordx4 a[160:163], v2, s[12:15], s36 offen offset:2048 sc1
    v_mfma_f32_16x16x32_bf16 a[96:99], v[120:123], a[180:183], a[24:27]
    s_waitcnt vmcnt(22)
    s_mov_b32 s37, 589824
    v_add_f32 v98, v98, v50
    v_add_f32 v99, v99, v51
    v_mfma_f32_16x16x32_bf16 a[96:99], v[124:127], a[184:187], a[96:99]
    buffer_load_dwordx4 a[164:167], v2, s[12:15], s37 offen offset:2048 sc1
    v_mfma_f32_16x16x32_bf16 a[100:103], v[124:127], a[180:183], a[28:31]
    s_waitcnt lgkmcnt(7)
    s_mov_b32 s28, 617472
    v_add_f32 v52, v52, v56
    v_add_f32 v53, v53, v57
    v_mfma_f32_16x16x32_bf16 a[100:103], v[128:131], a[184:187], a[100:103]
    buffer_load_dwordx4 a[168:171], v2, s[12:15], s28 offen offset:2048 sc1
    v_mfma_f32_16x16x32_bf16 a[104:107], v[128:131], a[180:183], a[32:35]
    s_mov_b32 s36, 645120
    v_add_f32 v54, v54, v58
    v_add_f32 v55, v55, v59
    v_mfma_f32_16x16x32_bf16 a[104:107], v[132:135], a[184:187], a[104:107]
    buffer_load_dwordx4 a[172:175], v2, s[12:15], s36 offen offset:2048 sc1
    v_mfma_f32_16x16x32_bf16 a[108:111], v[132:135], a[180:183], a[36:39]
    v_add_f32 v96, v96, v52
    v_add_f32 v97, v97, v53
    v_mfma_f32_16x16x32_bf16 a[108:111], v[136:139], a[184:187], a[108:111]
    v_add_f32 v98, v98, v54
    v_add_f32 v99, v99, v55
    v_mfma_f32_16x16x32_bf16 a[112:115], v[136:139], a[180:183], a[40:43]
    s_mov_b32 s37, 470016
    v_cndmask_b32 v97, 0, v97, s[76:77]
    v_cndmask_b32 v98, 0, v98, s[76:77]
    v_mfma_f32_16x16x32_bf16 a[112:115], v[140:143], a[184:187], a[112:115]
    buffer_load_dwordx4 a[176:179], v2, s[12:15], s37 offen offset:2048 sc1
    v_mfma_f32_16x16x32_bf16 a[116:119], v[140:143], a[180:183], a[44:47]
    v_cndmask_b32 v99, 0, v99, s[76:77]
    v_add_f32 v35, v35, v96
    v_mfma_f32_16x16x32_bf16 a[116:119], v[144:147], a[184:187], a[116:119]
    s_waitcnt vmcnt(24)
    v_fmac_f32 v38, v96, v96
    v_add_f32 v35, v35, v97
    v_mfma_f32_16x16x32_bf16 a[116:119], v[152:155], a[192:195], a[116:119]
    v_fmac_f32 v38, v97, v97
    v_add_f32 v35, v35, v98
    v_mfma_f32_16x16x32_bf16 a[116:119], v[148:151], a[188:191], a[116:119]
    s_mov_b32 s28, 497664
    v_fmac_f32 v38, v98, v98
    v_add_f32 v35, v35, v99
    v_mfma_f32_16x16x32_bf16 a[112:115], v[148:151], a[192:195], a[112:115]
    buffer_load_dwordx4 a[180:183], v2, s[12:15], s28 offen offset:2048 sc1
    v_mfma_f32_16x16x32_bf16 a[112:115], v[144:147], a[188:191], a[112:115]
    v_fmac_f32 v38, v99, v99
    v_mfma_f32_16x16x32_bf16 a[108:111], v[144:147], a[192:195], a[108:111]
    v_mfma_f32_16x16x32_bf16 a[108:111], v[140:143], a[188:191], a[108:111]
    v_mfma_f32_16x16x32_bf16 a[104:107], v[140:143], a[192:195], a[104:107]
    s_mov_b32 s36, 525312
    v_mfma_f32_16x16x32_bf16 a[104:107], v[136:139], a[188:191], a[104:107]
    buffer_load_dwordx4 a[184:187], v2, s[12:15], s36 offen offset:2048 sc1
    v_mfma_f32_16x16x32_bf16 a[100:103], v[136:139], a[192:195], a[100:103]
    v_mfma_f32_16x16x32_bf16 a[100:103], v[132:135], a[188:191], a[100:103]
    v_mfma_f32_16x16x32_bf16 a[96:99], v[132:135], a[192:195], a[96:99]
    v_mfma_f32_16x16x32_bf16 a[96:99], v[128:131], a[188:191], a[96:99]
    s_waitcnt vmcnt(25)
    s_mov_b32 s37, 457728
    v_mfma_f32_16x16x32_bf16 a[96:99], v[136:139], a[196:199], a[96:99]
    s_waitcnt vmcnt(24)
    buffer_load_dwordx4 a[188:191], v2, s[12:15], s37 offen offset:2048 sc1
    v_mfma_f32_16x16x32_bf16 a[96:99], v[140:143], a[200:203], a[96:99]
    v_mfma_f32_16x16x32_bf16 a[100:103], v[140:143], a[196:199], a[100:103]
    v_mfma_f32_16x16x32_bf16 a[100:103], v[144:147], a[200:203], a[100:103]
    v_mfma_f32_16x16x32_bf16 a[104:107], v[144:147], a[196:199], a[104:107]
    s_mov_b32 s28, 485376
    v_mfma_f32_16x16x32_bf16 a[104:107], v[148:151], a[200:203], a[104:107]
    s_waitcnt lgkmcnt(0)
    s_barrier
    v_mfma_f32_16x16x32_bf16 a[108:111], v[148:151], a[196:199], a[108:111]
    buffer_load_dwordx4 a[192:195], v2, s[12:15], s28 offen offset:2048 sc1
    v_mfma_f32_16x16x32_bf16 a[108:111], v[152:155], a[200:203], a[108:111]
    ds_read2st64_b64 v[104:107], v23 offset0:14 offset1:15
    v_accvgpr_read_b32 v72, a80
    v_mfma_f32_16x16x32_bf16 a[112:115], v[152:155], a[196:199], a[112:115]
    v_accvgpr_read_b32 v73, a81
    v_accvgpr_read_b32 v74, a82
    v_mfma_f32_16x16x32_bf16 a[112:115], v[156:159], a[200:203], a[112:115]
    s_mov_b32 s36, 513024
    ds_read2st64_b64 v[108:111], v23 offset0:16 offset1:17
    v_accvgpr_read_b32 v75, a83
    v_mfma_f32_16x16x32_bf16 a[116:119], v[156:159], a[196:199], a[116:119]
    buffer_load_dwordx4 a[196:199], v2, s[12:15], s36 offen offset:2048 sc1
    v_mfma_f32_16x16x32_bf16 a[116:119], v[160:163], a[200:203], a[116:119]
    s_waitcnt vmcnt(25)
    ds_read2st64_b64 v[112:115], v23 offset0:12 offset1:13
    v_mfma_f32_16x16x32_bf16 a[116:119], v[168:171], a[208:211], a[116:119]
    v_mfma_f32_16x16x32_bf16 a[116:119], v[164:167], a[204:207], a[116:119]
    v_mfma_f32_16x16x32_bf16 a[112:115], v[164:167], a[208:211], a[112:115]
    s_mov_b32 s37, 540672
    v_mfma_f32_16x16x32_bf16 a[112:115], v[160:163], a[204:207], a[112:115]
    buffer_load_dwordx4 a[200:203], v2, s[12:15], s37 offen offset:2048 sc1
    v_mfma_f32_16x16x32_bf16 a[108:111], v[160:163], a[208:211], a[108:111]
    s_waitcnt lgkmcnt(2)
    ds_read2st64_b64 v[48:51], v23 offset0:20 offset1:21
    v_add_f32 v72, v72, v104
    v_mfma_f32_16x16x32_bf16 a[108:111], v[156:159], a[204:207], a[108:111]
    v_add_f32 v73, v73, v105
    v_add_f32 v74, v74, v106
    v_mfma_f32_16x16x32_bf16 a[104:107], v[156:159], a[208:211], a[104:107]
    ds_read2st64_b64 v[52:55], v23 offset0:22 offset1:23
    v_add_f32 v75, v75, v107
    v_mfma_f32_16x16x32_bf16 a[104:107], v[152:155], a[204:207], a[104:107]
    s_waitcnt lgkmcnt(2)
    v_add_f32 v108, v108, v112
    v_add_f32 v109, v109, v113
    v_mfma_f32_16x16x32_bf16 a[100:103], v[152:155], a[208:211], a[100:103]
    ds_read2st64_b64 v[56:59], v23 offset0:18 offset1:19
    v_add_f32 v110, v110, v114
    v_mfma_f32_16x16x32_bf16 a[100:103], v[148:151], a[204:207], a[100:103]
    v_add_f32 v111, v111, v115
    v_sub_f32 v72, -v72, v108
    v_mfma_f32_16x16x32_bf16 a[96:99], v[148:151], a[208:211], a[96:99]
    s_mov_b32 s28, 568320
    v_sub_f32 v73, -v73, v109
    v_sub_f32 v74, -v74, v110
    v_mfma_f32_16x16x32_bf16 a[96:99], v[144:147], a[204:207], a[96:99]
    s_waitcnt vmcnt(25)
    buffer_load_dwordx4 a[204:207], v2, s[12:15], s28 offen offset:2048 sc1
    v_mfma_f32_16x16x32_bf16 a[96:99], v[172:175], a[212:215], a[96:99]
    s_waitcnt vmcnt(25)
    s_mov_b32 s36, 595968
    v_sub_f32 v75, -v75, v111
    v_cndmask_b32 v73, 0, v73, s[76:77]
    v_mfma_f32_16x16x32_bf16 a[96:99], v[176:179], a[216:219], a[96:99]
    buffer_load_dwordx4 a[208:211], v2, s[12:15], s36 offen offset:2048 sc1
    v_mfma_f32_16x16x32_bf16 a[100:103], v[176:179], a[212:215], a[100:103]
    v_cndmask_b32 v74, 0, v74, s[76:77]
    v_cndmask_b32 v75, 0, v75, s[76:77]
    v_mfma_f32_16x16x32_bf16 a[100:103], v[180:183], a[216:219], a[100:103]
    v_add_f32 v33, v33, v72
    v_fmac_f32 v36, v72, v72
    v_mfma_f32_16x16x32_bf16 a[104:107], v[180:183], a[212:215], a[104:107]
    v_add_f32 v33, v33, v73
    v_fmac_f32 v36, v73, v73
    v_mfma_f32_16x16x32_bf16 a[104:107], v[184:187], a[216:219], a[104:107]
    v_add_f32 v33, v33, v74
    v_fmac_f32 v36, v74, v74
    v_mfma_f32_16x16x32_bf16 a[108:111], v[184:187], a[212:215], a[108:111]
    v_add_f32 v33, v33, v75
    v_fmac_f32 v36, v75, v75
    v_mfma_f32_16x16x32_bf16 a[108:111], v[188:191], a[216:219], a[108:111]
    v_accvgpr_read_b32 v76, a84
    v_accvgpr_read_b32 v77, a85
    v_mfma_f32_16x16x32_bf16 a[112:115], v[188:191], a[212:215], a[112:115]
    s_mov_b32 s37, 623616
    v_accvgpr_read_b32 v78, a86
    v_accvgpr_read_b32 v79, a87
    v_mfma_f32_16x16x32_bf16 a[112:115], v[192:195], a[216:219], a[112:115]
    s_waitcnt lgkmcnt(2)
    v_add_f32 v76, v76, v48
    v_add_f32 v77, v77, v49
    v_mfma_f32_16x16x32_bf16 a[116:119], v[192:195], a[212:215], a[116:119]
    buffer_load_dwordx4 a[212:215], v2, s[12:15], s37 offen offset:2048 sc1
    v_mfma_f32_16x16x32_bf16 a[116:119], v[196:199], a[216:219], a[116:119]
    s_waitcnt vmcnt(25)
    s_mov_b32 s28, 651264
    v_add_f32 v78, v78, v50
    v_add_f32 v79, v79, v51
    v_mfma_f32_16x16x32_bf16 a[116:119], v[224:227], a[224:227], a[116:119]
    buffer_load_dwordx4 a[216:219], v2, s[12:15], s28 offen offset:2048 sc1
    v_mfma_f32_16x16x32_bf16 a[116:119], v[200:203], a[220:223], a[116:119]
    s_waitcnt lgkmcnt(0)
    v_add_f32 v52, v52, v56
    v_add_f32 v53, v53, v57
    v_mfma_f32_16x16x32_bf16 a[112:115], v[220:223], a[224:227], a[112:115]
    v_add_f32 v54, v54, v58
    v_add_f32 v55, v55, v59
    v_mfma_f32_16x16x32_bf16 a[112:115], v[196:199], a[220:223], a[112:115]
    v_sub_f32 v76, -v76, v52
    v_sub_f32 v77, -v77, v53
    v_mfma_f32_16x16x32_bf16 a[108:111], v[216:219], a[224:227], a[108:111]
    v_sub_f32 v78, -v78, v54
    v_sub_f32 v79, -v79, v55
    v_mfma_f32_16x16x32_bf16 a[108:111], v[192:195], a[220:223], a[108:111]
    v_cndmask_b32 v77, 0, v77, s[76:77]
    v_cndmask_b32 v78, 0, v78, s[76:77]
    v_mfma_f32_16x16x32_bf16 a[104:107], v[212:215], a[224:227], a[104:107]
    buffer_load_dword v12, v47, s[16:19], 0 offen sc1
    v_mfma_f32_16x16x32_bf16 a[104:107], v[188:191], a[220:223], a[104:107]
    v_cndmask_b32 v79, 0, v79, s[76:77]
    v_add_f32 v33, v33, v76
    v_mfma_f32_16x16x32_bf16 a[100:103], v[208:211], a[224:227], a[100:103]
    v_fmac_f32 v36, v76, v76
    v_add_f32 v33, v33, v77
    v_mfma_f32_16x16x32_bf16 a[100:103], v[184:187], a[220:223], a[100:103]
    v_fmac_f32 v36, v77, v77
    v_add_f32 v33, v33, v78
    v_mfma_f32_16x16x32_bf16 a[96:99], v[204:207], a[224:227], a[96:99]
    v_fmac_f32 v36, v78, v78
    v_add_f32 v33, v33, v79
    v_mfma_f32_16x16x32_bf16 a[96:99], v[180:183], a[220:223], a[96:99]
    s_waitcnt vmcnt(26)
    v_fmac_f32 v36, v79, v79
    v_mfma_f32_16x16x32_bf16 a[96:99], v[208:211], a[228:231], a[96:99]
    s_waitcnt vmcnt(25)
    v_mfma_f32_16x16x32_bf16 a[96:99], v[212:215], a[232:235], a[96:99]
    v_permlane32_swap_b32 v33, v36
    v_add_f32 v33, v33, v36
    v_mfma_f32_16x16x32_bf16 a[100:103], v[212:215], a[228:231], a[100:103]
    ds_write_b32 v24, v33 offset:0
    v_mfma_f32_16x16x32_bf16 a[100:103], v[216:219], a[232:235], a[100:103]
    v_mfma_f32_16x16x32_bf16 a[104:107], v[216:219], a[228:231], a[104:107]
    v_mfma_f32_16x16x32_bf16 a[104:107], v[220:223], a[232:235], a[104:107]
    v_mfma_f32_16x16x32_bf16 a[108:111], v[220:223], a[228:231], a[108:111]
    s_waitcnt lgkmcnt(0)
    s_barrier
    v_mfma_f32_16x16x32_bf16 a[108:111], v[224:227], a[232:235], a[108:111]
    ds_read_b128 v[60:63], v25 offset:0
    ds_read_b128 v[64:67], v25 offset:16
    v_mfma_f32_16x16x32_bf16 a[112:115], v[224:227], a[228:231], a[112:115]
    v_mfma_f32_16x16x32_bf16 a[112:115], v[228:231], a[232:235], a[112:115]
    v_mfma_f32_16x16x32_bf16 a[116:119], v[228:231], a[228:231], a[116:119]
    v_mfma_f32_16x16x32_bf16 a[116:119], v[232:235], a[232:235], a[116:119]
    s_waitcnt vmcnt(24)
    v_mfma_f32_16x16x32_bf16 a[96:99], v[216:219], a[236:239], a[96:99]
    s_waitcnt vmcnt(23)
    v_mfma_f32_16x16x32_bf16 a[96:99], v[220:223], a[240:243], a[96:99]
    s_waitcnt vmcnt(22)
    v_mfma_f32_16x16x32_bf16 a[96:99], v[224:227], a[244:247], a[96:99]
    s_waitcnt vmcnt(21)
    v_mfma_f32_16x16x32_bf16 a[96:99], v[228:231], a[248:251], a[96:99]
    s_waitcnt vmcnt(20) lgkmcnt(1)
    v_add_f32 v60, v60, v61
    v_add_f32 v62, v62, v63
    v_mfma_f32_16x16x32_bf16 a[96:99], v[232:235], a[252:255], a[96:99]
    s_waitcnt lgkmcnt(0)
    v_add_f32 v64, v64, v65
    v_add_f32 v66, v66, v67
    v_mfma_f32_16x16x32_bf16 a[100:103], v[236:239], a[252:255], a[100:103]
    v_add_f32 v60, v60, v62
    v_add_f32 v64, v64, v66
    v_mfma_f32_16x16x32_bf16 a[100:103], v[232:235], a[248:251], a[100:103]
    v_add_f32 v60, v60, v64
    v_min_u32 v60, -2, v60
    v_mfma_f32_16x16x32_bf16 a[100:103], v[228:231], a[244:247], a[100:103]
    ds_write_b64 v23, a[96:97] offset:19456
    v_mfma_f32_16x16x32_bf16 a[100:103], v[224:227], a[240:243], a[100:103]
    buffer_store_dword v60, v27, s[24:27], 0 offen sc1
    v_mfma_f32_16x16x32_bf16 a[100:103], v[220:223], a[236:239], a[100:103]
    ds_write_b64 v23, a[98:99] offset:19968
    v_mfma_f32_16x16x32_bf16 a[112:115], v[232:235], a[236:239], a[112:115]
Lt10:
    s_cbranch_execz Lt11
    v_mfma_f32_16x16x32_bf16 a[112:115], v[236:239], a[240:243], a[112:115]
    v_mfma_f32_16x16x32_bf16 a[112:115], v[240:243], a[244:247], a[112:115]
    ds_write_b64 v23, a[100:101] offset:22528
    v_mfma_f32_16x16x32_bf16 a[112:115], v[244:247], a[248:251], a[112:115]
    v_mfma_f32_16x16x32_bf16 a[112:115], v[248:251], a[252:255], a[112:115]
    ds_write_b64 v23, a[102:103] offset:23040
    v_mfma_f32_16x16x32_bf16 a[116:119], v[252:255], a[252:255], a[116:119]
    v_mfma_f32_16x16x32_bf16 a[116:119], v[248:251], a[248:251], a[116:119]
    v_mfma_f32_16x16x32_bf16 a[116:119], v[244:247], a[244:247], a[116:119]
    ds_write_b64 v23, a[112:113] offset:32768
    v_mfma_f32_16x16x32_bf16 a[116:119], v[240:243], a[240:243], a[116:119]
    v_mfma_f32_16x16x32_bf16 a[116:119], v[236:239], a[236:239], a[116:119]
    ds_write_b64 v23, a[114:115] offset:33280
    v_mfma_f32_16x16x32_bf16 a[104:107], v[224:227], a[236:239], a[104:107]
    v_mfma_f32_16x16x32_bf16 a[104:107], v[228:231], a[240:243], a[104:107]
    v_mfma_f32_16x16x32_bf16 a[104:107], v[232:235], a[244:247], a[104:107]
    ds_write_b64 v23, a[116:117] offset:35840
    v_mfma_f32_16x16x32_bf16 a[104:107], v[236:239], a[248:251], a[104:107]
    v_mfma_f32_16x16x32_bf16 a[104:107], v[240:243], a[252:255], a[104:107]
    ds_write_b64 v23, a[118:119] offset:36352
    v_mfma_f32_16x16x32_bf16 a[108:111], v[244:247], a[252:255], a[108:111]
    v_mov_b32 v27, 2.0
    v_mfma_f32_16x16x32_bf16 a[108:111], v[240:243], a[248:251], a[108:111]
    v_mfma_f32_16x16x32_bf16 a[108:111], v[236:239], a[244:247], a[108:111]
    v_mfma_f32_16x16x32_bf16 a[108:111], v[232:235], a[240:243], a[108:111]
    v_mfma_f32_16x16x32_bf16 a[108:111], v[228:231], a[236:239], a[108:111]
    s_waitcnt vmcnt(20)
    v_mfma_f32_16x16x32_bf16 a[120:123], v[120:123], a[144:147], a[48:51]
    s_waitcnt vmcnt(19)
    v_mfma_f32_16x16x32_bf16 a[120:123], v[124:127], a[148:151], a[120:123]
    v_mfma_f32_16x16x32_bf16 a[124:127], v[124:127], a[144:147], a[52:55]
    v_mfma_f32_16x16x32_bf16 a[124:127], v[128:131], a[148:151], a[124:127]
    v_mfma_f32_16x16x32_bf16 a[128:131], v[128:131], a[144:147], a[56:59]
    v_mfma_f32_16x16x32_bf16 a[128:131], v[132:135], a[148:151], a[128:131]
    v_mfma_f32_16x16x32_bf16 a[132:135], v[132:135], a[144:147], a[60:63]
    v_mfma_f32_16x16x32_bf16 a[132:135], v[136:139], a[148:151], a[132:135]
    v_mfma_f32_16x16x32_bf16 a[140:143], v[140:143], a[144:147], a[68:71]
    v_mfma_f32_16x16x32_bf16 a[140:143], v[144:147], a[148:151], a[140:143]
    s_waitcnt vmcnt(17)
    v_mfma_f32_16x16x32_bf16 a[140:143], v[152:155], a[156:159], a[140:143]
    v_mfma_f32_16x16x32_bf16 a[140:143], v[148:151], a[152:155], a[140:143]
    v_mfma_f32_16x16x32_bf16 a[132:135], v[144:147], a[156:159], a[132:135]
    v_mfma_f32_16x16x32_bf16 a[132:135], v[140:143], a[152:155], a[132:135]
    v_mfma_f32_16x16x32_bf16 a[128:131], v[140:143], a[156:159], a[128:131]
    v_mfma_f32_16x16x32_bf16 a[128:131], v[136:139], a[152:155], a[128:131]
    v_mfma_f32_16x16x32_bf16 a[124:127], v[136:139], a[156:159], a[124:127]
    v_mfma_f32_16x16x32_bf16 a[124:127], v[132:135], a[152:155], a[124:127]
    s_waitcnt lgkmcnt(0)
    s_barrier
    v_mfma_f32_16x16x32_bf16 a[120:123], v[132:135], a[156:159], a[120:123]
    ds_read2st64_b64 v[104:107], v23 offset0:50 offset1:51
    v_accvgpr_read_b32 v84, a104
    v_mfma_f32_16x16x32_bf16 a[120:123], v[128:131], a[152:155], a[120:123]
    s_waitcnt vmcnt(16)
    v_accvgpr_read_b32 v85, a105
    v_accvgpr_read_b32 v86, a106
    v_mfma_f32_16x16x32_bf16 a[120:123], v[136:139], a[160:163], a[120:123]
    s_waitcnt vmcnt(15)
    ds_read2st64_b64 v[108:111], v23 offset0:52 offset1:53
    v_accvgpr_read_b32 v87, a107
    v_mfma_f32_16x16x32_bf16 a[120:123], v[140:143], a[164:167], a[120:123]
    v_mfma_f32_16x16x32_bf16 a[124:127], v[140:143], a[160:163], a[124:127]
    ds_read2st64_b64 v[112:115], v23 offset0:48 offset1:49
    v_mfma_f32_16x16x32_bf16 a[124:127], v[144:147], a[164:167], a[124:127]
    v_mfma_f32_16x16x32_bf16 a[128:131], v[144:147], a[160:163], a[128:131]
    v_mfma_f32_16x16x32_bf16 a[128:131], v[148:151], a[164:167], a[128:131]
    v_mfma_f32_16x16x32_bf16 a[132:135], v[148:151], a[160:163], a[132:135]
    s_waitcnt lgkmcnt(2)
    ds_read2st64_b64 v[48:51], v23 offset0:56 offset1:57
    v_add_f32 v84, v84, v104
    v_mfma_f32_16x16x32_bf16 a[132:135], v[152:155], a[164:167], a[132:135]
    v_add_f32 v85, v85, v105
    v_add_f32 v86, v86, v106
    v_mfma_f32_16x16x32_bf16 a[140:143], v[156:159], a[160:163], a[140:143]
    ds_read2st64_b64 v[52:55], v23 offset0:58 offset1:59
    v_add_f32 v87, v87, v107
    v_mfma_f32_16x16x32_bf16 a[140:143], v[160:163], a[164:167], a[140:143]
    s_waitcnt vmcnt(13) lgkmcnt(2)
    v_add_f32 v108, v108, v112
    v_add_f32 v109, v109, v113
    v_mfma_f32_16x16x32_bf16 a[140:143], v[168:171], a[172:175], a[140:143]
    ds_read2st64_b64 v[56:59], v23 offset0:54 offset1:55
    v_add_f32 v110, v110, v114
    v_mfma_f32_16x16x32_bf16 a[140:143], v[164:167], a[168:171], a[140:143]
    v_add_f32 v111, v111, v115
    v_sub_f32 v84, -v84, v108
    v_mfma_f32_16x16x32_bf16 a[132:135], v[160:163], a[172:175], a[132:135]
    v_sub_f32 v85, -v85, v109
    v_sub_f32 v86, -v86, v110
    v_mfma_f32_16x16x32_bf16 a[132:135], v[156:159], a[168:171], a[132:135]
    v_sub_f32 v87, -v87, v111
    v_cndmask_b32 v85, 0, v85, s[76:77]
    v_mfma_f32_16x16x32_bf16 a[128:131], v[156:159], a[172:175], a[128:131]
    v_cndmask_b32 v86, 0, v86, s[76:77]
    v_cndmask_b32 v87, 0, v87, s[76:77]
    v_mfma_f32_16x16x32_bf16 a[128:131], v[152:155], a[168:171], a[128:131]
    v_add_f32 v34, v34, v84
    v_fmac_f32 v37, v84, v84
    v_mfma_f32_16x16x32_bf16 a[124:127], v[152:155], a[172:175], a[124:127]
    v_add_f32 v34, v34, v85
    v_fmac_f32 v37, v85, v85
    v_mfma_f32_16x16x32_bf16 a[124:127], v[148:151], a[168:171], a[124:127]
    v_add_f32 v34, v34, v86
    v_fmac_f32 v37, v86, v86
    v_mfma_f32_16x16x32_bf16 a[120:123], v[148:151], a[172:175], a[120:123]
    v_add_f32 v34, v34, v87
    v_fmac_f32 v37, v87, v87
    v_mfma_f32_16x16x32_bf16 a[120:123], v[144:147], a[168:171], a[120:123]
    s_waitcnt vmcnt(12)
    v_accvgpr_read_b32 v88, a108
    v_accvgpr_read_b32 v89, a109
    v_mfma_f32_16x16x32_bf16 a[120:123], v[172:175], a[176:179], a[120:123]
    s_waitcnt vmcnt(11)
    buffer_load_dwordx2 v[6:7], v28, s[24:27], 0 offen offset:0 sc1
    v_mfma_f32_16x16x32_bf16 a[120:123], v[176:179], a[180:183], a[120:123]
    v_accvgpr_read_b32 v90, a110
    v_accvgpr_read_b32 v91, a111
    v_mfma_f32_16x16x32_bf16 a[124:127], v[176:179], a[176:179], a[124:127]
    buffer_load_dwordx2 v[8:9], v28, s[24:27], 0 offen offset:2048 sc1
    v_mfma_f32_16x16x32_bf16 a[124:127], v[180:183], a[180:183], a[124:127]
    s_waitcnt lgkmcnt(2)
    v_add_f32 v88, v88, v48
    v_add_f32 v89, v89, v49
    v_mfma_f32_16x16x32_bf16 a[128:131], v[180:183], a[176:179], a[128:131]
    buffer_load_dwordx2 v[10:11], v3, s[24:27], 0 offen offset:0 sc1
    v_mfma_f32_16x16x32_bf16 a[128:131], v[184:187], a[180:183], a[128:131]
    v_add_f32 v90, v90, v50
    v_add_f32 v91, v91, v51
    v_mfma_f32_16x16x32_bf16 a[132:135], v[184:187], a[176:179], a[132:135]
    s_waitcnt lgkmcnt(0)
    v_add_f32 v52, v52, v56
    v_add_f32 v53, v53, v57
    v_mfma_f32_16x16x32_bf16 a[132:135], v[188:191], a[180:183], a[132:135]
    v_add_f32 v54, v54, v58
    v_add_f32 v55, v55, v59
    v_mfma_f32_16x16x32_bf16 a[140:143], v[192:195], a[176:179], a[140:143]
    v_sub_f32 v88, -v88, v52
    v_sub_f32 v89, -v89, v53
    v_mfma_f32_16x16x32_bf16 a[140:143], v[196:199], a[180:183], a[140:143]
    s_waitcnt vmcnt(13)
    v_sub_f32 v90, -v90, v54
    v_sub_f32 v91, -v91, v55
    v_mfma_f32_16x16x32_bf16 a[120:123], v[180:183], a[184:187], a[120:123]
    s_waitcnt vmcnt(12)
    v_cndmask_b32 v89, 0, v89, s[76:77]
    v_cndmask_b32 v90, 0, v90, s[76:77]
    v_mfma_f32_16x16x32_bf16 a[120:123], v[204:207], a[188:191], a[120:123]
    s_waitcnt vmcnt(11)
    v_cndmask_b32 v91, 0, v91, s[76:77]
    v_add_f32 v34, v34, v88
    v_mfma_f32_16x16x32_bf16 a[120:123], v[208:211], a[192:195], a[120:123]
    s_waitcnt vmcnt(10)
    v_fmac_f32 v37, v88, v88
    v_add_f32 v34, v34, v89
    v_mfma_f32_16x16x32_bf16 a[120:123], v[212:215], a[196:199], a[120:123]
    s_waitcnt vmcnt(9)
    v_fmac_f32 v37, v89, v89
    v_add_f32 v34, v34, v90
    v_mfma_f32_16x16x32_bf16 a[120:123], v[216:219], a[200:203], a[120:123]
    s_waitcnt vmcnt(8)
    v_fmac_f32 v37, v90, v90
    v_add_f32 v34, v34, v91
    v_mfma_f32_16x16x32_bf16 a[120:123], v[220:223], a[204:207], a[120:123]
    s_waitcnt vmcnt(7)
    v_fmac_f32 v37, v91, v91
    v_mfma_f32_16x16x32_bf16 a[120:123], v[224:227], a[208:211], a[120:123]
    s_waitcnt vmcnt(6)
    v_mfma_f32_16x16x32_bf16 a[120:123], v[228:231], a[212:215], a[120:123]
    s_waitcnt vmcnt(5)
    v_permlane32_swap_b32 v34, v37
    v_add_f32 v34, v34, v37
    v_mfma_f32_16x16x32_bf16 a[120:123], v[232:235], a[216:219], a[120:123]
    ds_write_b32 v24, v34 offset:1024
    v_mfma_f32_16x16x32_bf16 a[128:131], v[240:243], a[216:219], a[128:131]
    v_mfma_f32_16x16x32_bf16 a[128:131], v[236:239], a[212:215], a[128:131]
    v_mfma_f32_16x16x32_bf16 a[128:131], v[232:235], a[208:211], a[128:131]
    ds_write_b64 v23, a[120:121] offset:37888
    v_mfma_f32_16x16x32_bf16 a[128:131], v[228:231], a[204:207], a[128:131]
    v_mfma_f32_16x16x32_bf16 a[128:131], v[224:227], a[200:203], a[128:131]
    s_waitcnt lgkmcnt(1)
    s_barrier
    v_mfma_f32_16x16x32_bf16 a[128:131], v[220:223], a[196:199], a[128:131]
    ds_write_b64 v23, a[122:123] offset:38400
    v_mfma_f32_16x16x32_bf16 a[128:131], v[216:219], a[192:195], a[128:131]
    v_accvgpr_read_b32 v100, a64
    v_accvgpr_read_b32 v101, a65
    v_mfma_f32_16x16x32_bf16 a[128:131], v[212:215], a[188:191], a[128:131]
    v_accvgpr_read_b32 v102, a66
    v_accvgpr_read_b32 v103, a67
    v_mfma_f32_16x16x32_bf16 a[128:131], v[188:191], a[184:187], a[128:131]
    v_mfma_f32_16x16x32_bf16 a[124:127], v[184:187], a[184:187], a[124:127]
    v_mfma_f32_16x16x32_bf16 a[124:127], v[208:211], a[188:191], a[124:127]
    v_mfma_f32_16x16x32_bf16 a[124:127], v[212:215], a[192:195], a[124:127]
    ds_write_b64 v23, a[128:129] offset:44032
    v_mfma_f32_16x16x32_bf16 a[124:127], v[216:219], a[196:199], a[124:127]
    v_mfma_f32_16x16x32_bf16 a[124:127], v[220:223], a[200:203], a[124:127]
    ds_write_b64 v23, a[130:131] offset:44544
    v_mfma_f32_16x16x32_bf16 a[124:127], v[224:227], a[204:207], a[124:127]
    v_mfma_f32_16x16x32_bf16 a[124:127], v[228:231], a[208:211], a[124:127]
    v_mfma_f32_16x16x32_bf16 a[124:127], v[232:235], a[212:215], a[124:127]
    v_mfma_f32_16x16x32_bf16 a[124:127], v[236:239], a[216:219], a[124:127]
    v_mfma_f32_16x16x32_bf16 a[132:135], v[244:247], a[216:219], a[132:135]
    v_mfma_f32_16x16x32_bf16 a[132:135], v[240:243], a[212:215], a[132:135]
    s_waitcnt lgkmcnt(0)
    s_barrier
    v_mfma_f32_16x16x32_bf16 a[132:135], v[236:239], a[208:211], a[132:135]
    ds_write_b64 v23, a[124:125] offset:40960
    v_mfma_f32_16x16x32_bf16 a[132:135], v[232:235], a[204:207], a[132:135]
    v_mfma_f32_16x16x32_bf16 a[132:135], v[228:231], a[200:203], a[132:135]
    ds_write_b64 v23, a[126:127] offset:41472
    v_mfma_f32_16x16x32_bf16 a[132:135], v[224:227], a[196:199], a[132:135]
    v_mfma_f32_16x16x32_bf16 a[132:135], v[220:223], a[192:195], a[132:135]
    v_mfma_f32_16x16x32_bf16 a[132:135], v[216:219], a[188:191], a[132:135]
    v_mfma_f32_16x16x32_bf16 a[132:135], v[192:195], a[184:187], a[132:135]
    s_waitcnt vmcnt(0)
    v_max3_u32 v39, v6, v7, v8
    v_max3_u32 v39, v39, v10, v11
    v_mfma_f32_16x16x32_bf16 a[140:143], v[200:203], a[184:187], a[140:143]
    v_max_u32 v39, v39, v9
    v_cmp_eq_u32 vcc, -1, v39
    v_mfma_f32_16x16x32_bf16 a[140:143], v[224:227], a[188:191], a[140:143]
    v_mfma_f32_16x16x32_bf16 a[140:143], v[228:231], a[192:195], a[140:143]
    s_cbranch_vccnz Lg2_0
Lh2_0:
    ds_write_b64 v23, a[132:133] offset:47104
    v_mfma_f32_16x16x32_bf16 a[140:143], v[232:235], a[196:199], a[140:143]
    v_add_f32 v6, v6, v8
    v_add_f32 v7, v7, v9
    v_mfma_f32_16x16x32_bf16 a[140:143], v[236:239], a[200:203], a[140:143]
    ds_write_b64 v23, a[134:135] offset:47616
    v_mfma_f32_16x16x32_bf16 a[140:143], v[240:243], a[204:207], a[140:143]
    v_add_f32 v6, v6, v10
    v_add_f32 v7, v7, v11
    v_mfma_f32_16x16x32_bf16 a[140:143], v[244:247], a[208:211], a[140:143]
    v_mfma_f32_16x16x32_bf16 a[140:143], v[248:251], a[212:215], a[140:143]
    v_permlane32_swap_b32 v6, v7
    v_add_f32 v6, v6, v7
    v_mfma_f32_16x16x32_bf16 a[140:143], v[252:255], a[216:219], a[140:143]
    v_mov_b32 v7, v6
    v_mfma_f32_16x16x32_bf16 v[40:43], v[136:139], a[144:147], 0
    v_mfma_f32_16x16x32_bf16 v[40:43], v[140:143], a[148:151], v[40:43]
    s_waitcnt lgkmcnt(0)
    s_barrier
    v_mfma_f32_16x16x32_bf16 v[40:43], v[144:147], a[152:155], v[40:43]
    ds_write_b64 v23, a[140:141] offset:54272
    v_mfma_f32_16x16x32_bf16 v[40:43], v[148:151], a[156:159], v[40:43]
    v_permlane16_swap_b32 v6, v7
    v_add_f32 v6, v6, v7
    v_mfma_f32_16x16x32_bf16 v[40:43], v[152:155], a[160:163], v[40:43]
    ds_write_b64 v23, a[142:143] offset:54784
    v_mfma_f32_16x16x32_bf16 v[40:43], v[156:159], a[164:167], v[40:43]
    ds_write_b32 v117, v6 offset:0
    v_mfma_f32_16x16x32_bf16 v[40:43], v[160:163], a[168:171], v[40:43]
    ds_read2st64_b64 v[52:55], v23 offset0:100 offset1:101
    ds_read2st64_b64 v[56:59], v23 offset0:96 offset1:97
    v_mfma_f32_16x16x32_bf16 v[40:43], v[164:167], a[172:175], v[40:43]
    v_mfma_f32_16x16x32_bf16 v[40:43], v[188:191], a[176:179], v[40:43]
    v_mfma_f32_16x16x32_bf16 v[40:43], v[192:195], a[180:183], v[40:43]
    v_mfma_f32_16x16x32_bf16 v[40:43], v[196:199], a[184:187], v[40:43]
    s_waitcnt lgkmcnt(3)
    s_barrier
    v_mfma_f32_16x16x32_bf16 v[40:43], v[220:223], a[188:191], v[40:43]
    s_waitcnt lgkmcnt(0)
    ds_read2st64_b64 v[48:51], v23 offset0:98 offset1:99
    v_add_f32 v52, v52, v56
    v_mfma_f32_16x16x32_bf16 v[40:43], v[224:227], a[192:195], v[40:43]
    v_add_f32 v53, v53, v57
    v_add_f32 v54, v54, v58
    v_mfma_f32_16x16x32_bf16 v[40:43], v[228:231], a[196:199], v[40:43]
    v_add_f32 v55, v55, v59
    v_add_f32 v100, v100, v52
    v_mfma_f32_16x16x32_bf16 v[40:43], v[232:235], a[200:203], v[40:43]
    v_add_f32 v101, v101, v53
    v_add_f32 v102, v102, v54
    v_mfma_f32_16x16x32_bf16 v[40:43], v[236:239], a[204:207], v[40:43]
    s_waitcnt lgkmcnt(0)
    v_add_f32 v103, v103, v55
    v_add_f32 v100, v100, v48
    v_mfma_f32_16x16x32_bf16 v[40:43], v[240:243], a[208:211], v[40:43]
    v_add_f32 v101, v101, v49
    v_add_f32 v102, v102, v50
    v_mfma_f32_16x16x32_bf16 v[40:43], v[244:247], a[212:215], v[40:43]
    v_add_f32 v103, v103, v51
    v_mfma_f32_16x16x32_bf16 v[40:43], v[248:251], a[216:219], v[40:43]
    s_nop 7
    v_sub_f32 v100, -v100, v40
    v_sub_f32 v101, -v101, v41
    v_sub_f32 v102, -v102, v42
    v_sub_f32 v103, -v103, v43
    v_cndmask_b32 v101, 0, v101, s[76:77]
    v_cndmask_b32 v102, 0, v102, s[76:77]
    v_cndmask_b32 v103, 0, v103, s[76:77]
    v_add_f32 v35, v35, v100
    v_fmac_f32 v38, v100, v100
    v_add_f32 v35, v35, v101
    v_fmac_f32 v38, v101, v101
    v_add_f32 v35, v35, v102
    v_fmac_f32 v38, v102, v102
    v_add_f32 v35, v35, v103
    v_fmac_f32 v38, v103, v103
    s_nop 1
    v_permlane32_swap_b32 v35, v38
    v_add_f32 v35, v35, v38
    ds_write_b32 v24, v35 offset:2048
    buffer_load_dwordx2 v[120:121], v28, s[24:27], s74 offen offset:0 sc1
    buffer_load_dwordx2 v[122:123], v28, s[24:27], s74 offen offset:2048 sc1
    buffer_load_dwordx2 v[124:125], v3, s[24:27], s74 offen offset:0 sc1
    s_waitcnt lgkmcnt(0)
    s_barrier
    s_branch Lepi
Lg2_0:
    s_mov_b64 exec, vcc
    buffer_load_dwordx2 v[6:7], v28, s[24:27], 0 offen offset:0 sc1
    buffer_load_dwordx2 v[8:9], v28, s[24:27], 0 offen offset:2048 sc1
    buffer_load_dwordx2 v[10:11], v3, s[24:27], 0 offen offset:0 sc1
    s_mov_b64 exec, -1
    s_waitcnt vmcnt(0)
    v_max3_u32 v39, v6, v7, v8
    v_max3_u32 v39, v39, v10, v11
    v_max_u32 v39, v39, v9
    v_cmp_eq_u32 vcc, -1, v39
    s_sub_u32 s85, s85, 1
    s_cmp_lt_i32 s85, 0
    s_cbranch_scc1 Lh2_0
    s_cbranch_vccnz Lg2_0
    s_branch Lh2_0
Lt11:
    s_cbranch_execz Lpr2
Lsp3:
    v_mov_b32_dpp v251, v227 row_shl:1 row_mask:0xf bank_mask:0xf
    v_mov_b32_dpp v252, v64 row_shr:9 row_mask:0xf bank_mask:0xf
    v_mfma_f32_16x16x32_bf16 a[24:27], v[80:83], a[176:179], a[24:27]
    s_mov_b32 s28, 457728
    v_mov_b32 v118, 0xbdd2d3e8
    v_mov_b32 v119, 0xc0135761
    v_mfma_f32_16x16x32_bf16 a[24:27], v[76:79], a[180:183], a[24:27]
    s_waitcnt vmcnt(27)
    buffer_load_dwordx4 a[148:151], v2, s[12:15], s28 offen offset:0 sc1
    v_mfma_f32_16x16x32_bf16 a[24:27], v[84:87], a[184:187], a[24:27]
    s_waitcnt vmcnt(27)
    v_mov_b32 v4, 0x39035177
    v_mov_b32 v5, 0x3727c5ac
    v_mfma_f32_16x16x32_bf16 a[24:27], v[88:91], a[188:191], a[24:27]
    s_movk_i32 s48, 2592
    v_mov_b32 v33, 0
    v_mov_b32 v34, 0
    v_mfma_f32_16x16x32_bf16 a[28:31], v[88:91], a[184:187], a[28:31]
    s_lshl_b32 s6, s31, 5
    v_mov_b32 v36, 0
    v_mov_b32 v37, 0
    v_mfma_f32_16x16x32_bf16 a[28:31], v[92:95], a[188:191], a[28:31]
    s_mov_b32 s36, 485376
    v_mov_b32 v38, 0
    v_mov_b32 v35, 0
    v_mfma_f32_16x16x32_bf16 a[32:35], v[92:95], a[184:187], a[32:35]
    buffer_load_dwordx4 a[152:155], v2, s[12:15], s36 offen offset:0 sc1
    v_mfma_f32_16x16x32_bf16 a[32:35], v[96:99], a[188:191], a[32:35]
    s_movk_i32 s47, 2016
    v_mov_b32_dpp v253, v65 row_shr:9 row_mask:0xf bank_mask:0xf
    v_mov_b32_dpp v254, v66 row_shr:9 row_mask:0xf bank_mask:0xf
    v_mfma_f32_16x16x32_bf16 a[36:39], v[96:99], a[184:187], a[36:39]
    s_movk_i32 s46, 2880
    v_mov_b32_dpp v255, v67 row_shr:9 row_mask:0xf bank_mask:0xf
    v_mov_b32_dpp v252, v228 row_shl:1 row_mask:0xf bank_mask:0xf
    v_mfma_f32_16x16x32_bf16 a[36:39], v[100:103], a[188:191], a[36:39]
    s_movk_i32 s39, 2304
    v_mov_b32_dpp v253, v229 row_shl:1 row_mask:0xf bank_mask:0xf
    v_mov_b32_dpp v254, v230 row_shl:1 row_mask:0xf bank_mask:0xf
    v_mfma_f32_16x16x32_bf16 a[40:43], v[100:103], a[184:187], a[40:43]
    s_mov_b32 s37, 513024
    s_movk_i32 s38, 2592
    v_mov_b32_dpp v255, v231 row_shl:1 row_mask:0xf bank_mask:0xf
    v_mfma_f32_16x16x32_bf16 a[40:43], v[104:107], a[188:191], a[40:43]
    buffer_load_dwordx4 a[156:159], v2, s[12:15], s37 offen offset:0 sc1
    v_mfma_f32_16x16x32_bf16 a[44:47], v[104:107], a[184:187], a[44:47]
    ds_write_b32 v22, a4 offset:2048
    v_mfma_f32_16x16x32_bf16 a[44:47], v[108:111], a[188:191], a[44:47]
    s_waitcnt vmcnt(28)
    ds_write_b32 v22, a5 offset:2052
    v_mfma_f32_16x16x32_bf16 a[48:51], v[68:71], a[192:195], a[48:51]
    s_waitcnt vmcnt(27)
    ds_write_b32 v22, a6 offset:2560
    v_mfma_f32_16x16x32_bf16 a[48:51], v[72:75], a[196:199], a[48:51]
    s_mov_b32 s28, 540672
    ds_write_b32 v22, a7 offset:2564
    v_mfma_f32_16x16x32_bf16 a[52:55], v[72:75], a[192:195], a[52:55]
    buffer_load_dwordx4 a[160:163], v2, s[12:15], s28 offen offset:0 sc1
    v_mfma_f32_16x16x32_bf16 a[52:55], v[76:79], a[196:199], a[52:55]
    ds_write_b32 v22, a8 offset:5120
    v_mfma_f32_16x16x32_bf16 a[56:59], v[76:79], a[192:195], a[56:59]
    ds_write_b32 v22, a9 offset:5124
    v_mfma_f32_16x16x32_bf16 a[56:59], v[80:83], a[196:199], a[56:59]
    s_mov_b32 s36, 568320
    ds_write_b32 v22, a10 offset:5632
    v_mfma_f32_16x16x32_bf16 a[60:63], v[80:83], a[192:195], a[60:63]
    buffer_load_dwordx4 a[164:167], v2, s[12:15], s36 offen offset:0 sc1
    v_mfma_f32_16x16x32_bf16 a[60:63], v[84:87], a[196:199], a[60:63]
    ds_write_b32 v22, a11 offset:5636
    v_mfma_f32_16x16x32_bf16 a[64:67], v[84:87], a[192:195], a[64:67]
    ds_write_b32 v22, a12 offset:8192
    v_mfma_f32_16x16x32_bf16 a[64:67], v[88:91], a[196:199], a[64:67]
    ds_write_b32 v22, a13 offset:8196
    v_mfma_f32_16x16x32_bf16 a[68:71], v[88:91], a[192:195], a[68:71]
    s_mov_b32 s37, 595968
    ds_write_b32 v22, a14 offset:8704
    v_mfma_f32_16x16x32_bf16 a[68:71], v[92:95], a[196:199], a[68:71]
    s_waitcnt vmcnt(28)
    buffer_load_dwordx4 a[168:171], v2, s[12:15], s37 offen offset:0 sc1
    v_mfma_f32_16x16x32_bf16 a[68:71], v[100:103], a[200:203], a[68:71]
    s_waitcnt vmcnt(28)
    ds_write_b32 v22, a15 offset:8708
    v_mfma_f32_16x16x32_bf16 a[68:71], v[96:99], a[204:207], a[68:71]
    ds_write_b32 v22, a16 offset:11264
    v_mfma_f32_16x16x32_bf16 a[64:67], v[96:99], a[200:203], a[64:67]
    ds_write_b32 v22, a17 offset:11268
    v_mfma_f32_16x16x32_bf16 a[64:67], v[92:95], a[204:207], a[64:67]
    s_mov_b32 s28, 623616
    ds_write_b32 v22, a18 offset:11776
    v_mfma_f32_16x16x32_bf16 a[60:63], v[92:95], a[200:203], a[60:63]
    buffer_load_dwordx4 a[172:175], v2, s[12:15], s28 offen offset:0 sc1
    v_mfma_f32_16x16x32_bf16 a[60:63], v[88:91], a[204:207], a[60:63]
    ds_write_b32 v22, a19 offset:11780
    v_mfma_f32_16x16x32_bf16 a[56:59], v[88:91], a[200:203], a[56:59]
    ds_write_b32 v22, a0 offset:18820
    v_mfma_f32_16x16x32_bf16 a[56:59], v[84:87], a[204:207], a[56:59]
    ds_write_b32 v22, a1 offset:17920
    v_mfma_f32_16x16x32_bf16 a[52:55], v[84:87], a[200:203], a[52:55]
    s_mov_b32 s36, 651264
    ds_write_b32 v22, a2 offset:17924
    v_mfma_f32_16x16x32_bf16 a[52:55], v[80:83], a[204:207], a[52:55]
    buffer_load_dwordx4 a[176:179], v2, s[12:15], s36 offen offset:0 sc1
    v_mfma_f32_16x16x32_bf16 a[48:51], v[80:83], a[200:203], a[48:51]
    ds_write_b32 v22, a3 offset:18944
    v_mfma_f32_16x16x32_bf16 a[48:51], v[76:79], a[204:207], a[48:51]
    s_waitcnt vmcnt(29)
    s_movk_i32 s49, 2880
    ds_write_b32 v22, a28 offset:21504
    v_mfma_f32_16x16x32_bf16 a[48:51], v[84:87], a[208:211], a[48:51]
    s_waitcnt vmcnt(27)
    ds_write_b32 v22, a29 offset:21508
    v_mfma_f32_16x16x32_bf16 a[48:51], v[88:91], a[212:215], a[48:51]
    s_mov_b32 s37, 451584
    ds_write_b32 v22, a30 offset:22016
    v_mfma_f32_16x16x32_bf16 a[52:55], v[88:91], a[208:211], a[52:55]
    buffer_load_dwordx4 a[180:183], v2, s[12:15], s37 offen offset:1024 sc1
    v_mfma_f32_16x16x32_bf16 a[52:55], v[92:95], a[212:215], a[52:55]
    ds_write_b32 v22, a31 offset:22020
    v_mfma_f32_16x16x32_bf16 a[56:59], v[92:95], a[208:211], a[56:59]
    ds_write_b32 v22, a32 offset:24576
    v_mfma_f32_16x16x32_bf16 a[56:59], v[96:99], a[212:215], a[56:59]
    ds_write_b32 v22, a33 offset:24580
    v_mfma_f32_16x16x32_bf16 a[60:63], v[96:99], a[208:211], a[60:63]
    s_mov_b32 s28, 479232
    ds_write_b32 v22, a34 offset:25088
    v_mfma_f32_16x16x32_bf16 a[60:63], v[100:103], a[212:215], a[60:63]
    buffer_load_dwordx4 a[184:187], v2, s[12:15], s28 offen offset:1024 sc1
    v_mfma_f32_16x16x32_bf16 a[64:67], v[100:103], a[208:211], a[64:67]
    ds_write_b32 v22, a35 offset:25092
    v_mfma_f32_16x16x32_bf16 a[64:67], v[104:107], a[212:215], a[64:67]
    ds_write_b32 v22, a36 offset:27648
    v_mfma_f32_16x16x32_bf16 a[68:71], v[104:107], a[208:211], a[68:71]
    ds_write_b32 v22, a37 offset:27652
    v_mfma_f32_16x16x32_bf16 a[68:71], v[108:111], a[212:215], a[68:71]
    s_waitcnt vmcnt(27)
    s_mov_b32 s36, 506880
    ds_write_b32 v22, a38 offset:28160
    v_mfma_f32_16x16x32_bf16 a[72:75], v[120:123], a[216:219], a[0:3]
    s_waitcnt vmcnt(25)
    buffer_load_dwordx4 a[188:191], v2, s[12:15], s36 offen offset:1024 sc1
    v_mfma_f32_16x16x32_bf16 a[72:75], v[124:127], a[220:223], a[72:75]
    ds_write_b32 v22, a39 offset:28164
    v_mfma_f32_16x16x32_bf16 a[76:79], v[124:127], a[216:219], a[4:7]
    ds_write_b32 v22, a40 offset:30720
    v_mfma_f32_16x16x32_bf16 a[76:79], v[128:131], a[220:223], a[76:79]
    ds_write_b32 v22, a41 offset:30724
    v_mfma_f32_16x16x32_bf16 a[80:83], v[128:131], a[216:219], a[8:11]
    s_mov_b32 s37, 534528
    ds_write_b32 v22, a42 offset:31232
    v_mfma_f32_16x16x32_bf16 a[80:83], v[132:135], a[220:223], a[80:83]
    buffer_load_dwordx4 a[192:195], v2, s[12:15], s37 offen offset:1024 sc1
    v_mfma_f32_16x16x32_bf16 a[84:87], v[132:135], a[216:219], a[12:15]
    ds_write_b32 v22, a43 offset:31236
    v_mfma_f32_16x16x32_bf16 a[84:87], v[136:139], a[220:223], a[84:87]
    ds_write_b32 v22, a24 offset:38276
    v_mfma_f32_16x16x32_bf16 a[88:91], v[136:139], a[216:219], a[16:19]
    ds_write_b32 v22, a25 offset:37376
    v_mfma_f32_16x16x32_bf16 a[88:91], v[140:143], a[220:223], a[88:91]
    s_mov_b32 s28, 562176
    ds_write_b32 v22, a26 offset:37380
    v_mfma_f32_16x16x32_bf16 a[92:95], v[140:143], a[216:219], a[20:23]
    buffer_load_dwordx4 a[196:199], v2, s[12:15], s28 offen offset:1024 sc1
    v_mfma_f32_16x16x32_bf16 a[92:95], v[144:147], a[220:223], a[92:95]
    s_waitcnt vmcnt(24)
    ds_write_b32 v22, a27 offset:38400
    v_mfma_f32_16x16x32_bf16 a[92:95], v[152:155], a[228:231], a[92:95]
    ds_write_b32 v22, a52 offset:40960
    v_mfma_f32_16x16x32_bf16 a[92:95], v[148:151], a[224:227], a[92:95]
    ds_write_b32 v22, a53 offset:40964
    v_mfma_f32_16x16x32_bf16 a[88:91], v[148:151], a[228:231], a[88:91]
    s_mov_b32 s36, 589824
    ds_write_b32 v22, a54 offset:41472
    v_mfma_f32_16x16x32_bf16 a[88:91], v[144:147], a[224:227], a[88:91]
    buffer_load_dwordx4 a[200:203], v2, s[12:15], s36 offen offset:1024 sc1
    v_mfma_f32_16x16x32_bf16 a[84:87], v[144:147], a[228:231], a[84:87]
    ds_write_b32 v22, a55 offset:41476
    v_mfma_f32_16x16x32_bf16 a[84:87], v[140:143], a[224:227], a[84:87]
    ds_write_b32 v22, a56 offset:44032
    v_mfma_f32_16x16x32_bf16 a[80:83], v[140:143], a[228:231], a[80:83]
    ds_write_b32 v22, a57 offset:44036
    v_mfma_f32_16x16x32_bf16 a[80:83], v[136:139], a[224:227], a[80:83]
    s_mov_b32 s37, 617472
    ds_write_b32 v22, a58 offset:44544
    v_mfma_f32_16x16x32_bf16 a[76:79], v[136:139], a[228:231], a[76:79]
    buffer_load_dwordx4 a[204:207], v2, s[12:15], s37 offen offset:1024 sc1
    v_mfma_f32_16x16x32_bf16 a[76:79], v[132:135], a[224:227], a[76:79]
    ds_write_b32 v22, a59 offset:44548
    v_mfma_f32_16x16x32_bf16 a[72:75], v[132:135], a[228:231], a[72:75]
    ds_write_b32 v22, a60 offset:47104
    v_mfma_f32_16x16x32_bf16 a[72:75], v[128:131], a[224:227], a[72:75]
    s_waitcnt vmcnt(24)
    ds_write_b32 v22, a61 offset:47108
    v_mfma_f32_16x16x32_bf16 a[72:75], v[136:139], a[232:235], a[72:75]
    s_waitcnt vmcnt(23)
    s_mov_b32 s28, 645120
    ds_write_b32 v22, a62 offset:47616
    v_mfma_f32_16x16x32_bf16 a[72:75], v[140:143], a[236:239], a[72:75]
    buffer_load_dwordx4 a[208:211], v2, s[12:15], s28 offen offset:1024 sc1
    v_mfma_f32_16x16x32_bf16 a[76:79], v[140:143], a[232:235], a[76:79]
    ds_write_b32 v22, a63 offset:47620
    v_mfma_f32_16x16x32_bf16 a[76:79], v[144:147], a[236:239], a[76:79]
    ds_write_b32 v22, a48 offset:57732
    v_mfma_f32_16x16x32_bf16 a[80:83], v[144:147], a[232:235], a[80:83]
    s_waitcnt lgkmcnt(13)
    s_barrier
    v_mfma_f32_16x16x32_bf16 a[80:83], v[148:151], a[236:239], a[80:83]
    s_mov_b32 s36, 577536
    ds_write_b32 v22, a49 offset:56832
    v_mfma_f32_16x16x32_bf16 a[84:87], v[148:151], a[232:235], a[84:87]
    buffer_load_dwordx4 a[212:215], v2, s[12:15], s36 offen offset:1024 sc1
    v_mfma_f32_16x16x32_bf16 a[84:87], v[152:155], a[236:239], a[84:87]
    ds_write_b32 v22, a50 offset:56836
    v_mfma_f32_16x16x32_bf16 a[88:91], v[152:155], a[232:235], a[88:91]
    ds_write_b32 v22, a51 offset:57856
    v_mfma_f32_16x16x32_bf16 a[88:91], v[156:159], a[236:239], a[88:91]
    v_min_u32 v47, 35, v1
    v_add_u32 v47, 108, v47
    v_mfma_f32_16x16x32_bf16 a[92:95], v[156:159], a[232:235], a[92:95]
    s_mov_b32 s37, 605184
    v_mul_u32_u24 v47, 384, v47
    v_add_u32 v47, s6, v47
    v_mfma_f32_16x16x32_bf16 a[92:95], v[160:163], a[236:239], a[92:95]
    s_waitcnt vmcnt(21)
    buffer_load_dwordx4 a[216:219], v2, s[12:15], s37 offen offset:1024 sc1
    v_mfma_f32_16x16x32_bf16 a[92:95], v[168:171], a[244:247], a[92:95]
    ds_read2st64_b64 v[104:107], v22 offset0:28 offset1:29
    v_accvgpr_read_b32 v68, a20
    v_mfma_f32_16x16x32_bf16 a[92:95], v[164:167], a[240:243], a[92:95]
    v_accvgpr_read_b32 v69, a21
    v_accvgpr_read_b32 v70, a22
    v_mfma_f32_16x16x32_bf16 a[88:91], v[164:167], a[244:247], a[88:91]
    s_mov_b32 s28, 632832
    ds_read2st64_b64 v[108:111], v22 offset0:24 offset1:25
    v_accvgpr_read_b32 v71, a23
    v_mfma_f32_16x16x32_bf16 a[88:91], v[160:163], a[240:243], a[88:91]
    buffer_load_dwordx4 a[220:223], v2, s[12:15], s28 offen offset:1024 sc1
    v_mfma_f32_16x16x32_bf16 a[84:87], v[160:163], a[244:247], a[84:87]
    ds_read2st64_b64 v[112:115], v22 offset0:26 offset1:27
    v_lshrrev_b32 v45, 5, v1
    v_mfma_f32_16x16x32_bf16 a[84:87], v[156:159], a[240:243], a[84:87]
    v_mul_i32_i24 v46, 4608, v45
    v_add_u32 v46, -3072, v46
    v_mfma_f32_16x16x32_bf16 a[80:83], v[156:159], a[244:247], a[80:83]
    v_add_u32 v30, v116, v46
    v_mul_i32_i24 v46, 512, v45
    v_mfma_f32_16x16x32_bf16 a[80:83], v[152:155], a[240:243], a[80:83]
    s_mov_b32 s36, 457728
    v_add_u32 v46, 1536, v46
    v_add_u32 v32, v116, v46
    v_mfma_f32_16x16x32_bf16 a[76:79], v[152:155], a[244:247], a[76:79]
    buffer_load_dwordx4 a[224:227], v2, s[12:15], s36 offen offset:1024 sc1
    v_mfma_f32_16x16x32_bf16 a[76:79], v[148:151], a[240:243], a[76:79]
    s_waitcnt lgkmcnt(2)
    ds_read2st64_b64 v[48:51], v22 offset0:66 offset1:67
    v_add_f32 v68, v68, v104
    v_mfma_f32_16x16x32_bf16 a[72:75], v[148:151], a[244:247], a[72:75]
    s_mov_b32 s37, 485376
    v_add_f32 v69, v69, v105
    v_add_f32 v70, v70, v106
    v_mfma_f32_16x16x32_bf16 a[72:75], v[144:147], a[240:243], a[72:75]
Lq3:
    s_cbranch_execz Lt13
    s_waitcnt vmcnt(22)
    ds_read2st64_b64 v[52:55], v22 offset0:62 offset1:63
    v_add_f32 v71, v71, v107
    v_mfma_f32_16x16x32_bf16 a[72:75], v[172:175], a[248:251], a[72:75]
    s_waitcnt vmcnt(21) lgkmcnt(2)
    v_add_f32 v108, v108, v112
    v_add_f32 v109, v109, v113
    v_mfma_f32_16x16x32_bf16 a[72:75], v[176:179], a[252:255], a[72:75]
    buffer_load_dwordx4 a[228:231], v2, s[12:15], s37 offen offset:1024 sc1
    v_mfma_f32_16x16x32_bf16 a[76:79], v[176:179], a[248:251], a[76:79]
    ds_read2st64_b64 v[56:59], v22 offset0:64 offset1:65
    v_add_f32 v110, v110, v114
    v_mfma_f32_16x16x32_bf16 a[76:79], v[180:183], a[252:255], a[76:79]
    v_add_f32 v111, v111, v115
    v_add_f32 v68, v68, v108
    v_mfma_f32_16x16x32_bf16 a[80:83], v[180:183], a[248:251], a[80:83]
    v_add_f32 v69, v69, v109
    v_add_f32 v70, v70, v110
    v_mfma_f32_16x16x32_bf16 a[80:83], v[184:187], a[252:255], a[80:83]
    s_mov_b32 s28, 513024
    v_add_f32 v71, v71, v111
    v_cndmask_b32 v69, 0, v69, s[76:77]
    v_mfma_f32_16x16x32_bf16 a[84:87], v[184:187], a[248:251], a[84:87]
    buffer_load_dwordx4 a[232:235], v2, s[12:15], s28 offen offset:1024 sc1
    v_mfma_f32_16x16x32_bf16 a[84:87], v[188:191], a[252:255], a[84:87]
    v_cndmask_b32 v70, 0, v70, s[76:77]
    v_cndmask_b32 v71, 0, v71, s[76:77]
    v_mfma_f32_16x16x32_bf16 a[88:91], v[188:191], a[248:251], a[88:91]
    v_add_f32 v33, v33, v68
    v_fmac_f32 v36, v68, v68
    v_mfma_f32_16x16x32_bf16 a[88:91], v[192:195], a[252:255], a[88:91]
    v_add_f32 v33, v33, v69
    v_fmac_f32 v36, v69, v69
    v_mfma_f32_16x16x32_bf16 a[92:95], v[192:195], a[248:251], a[92:95]
    s_mov_b32 s36, 540672
    v_add_f32 v33, v33, v70
    v_fmac_f32 v36, v70, v70
    v_mfma_f32_16x16x32_bf16 a[92:95], v[196:199], a[252:255], a[92:95]
    s_waitcnt vmcnt(21)
    buffer_load_dwordx4 a[236:239], v2, s[12:15], s36 offen offset:1024 sc1
    v_mfma_f32_16x16x32_bf16 a[92:95], v[224:227], a[148:151], a[92:95]
    v_add_f32 v33, v33, v71
    v_fmac_f32 v36, v71, v71
    v_mfma_f32_16x16x32_bf16 a[92:95], v[200:203], a[144:147], a[92:95]
    v_accvgpr_read_b32 v80, a44
    v_accvgpr_read_b32 v81, a45
    v_mfma_f32_16x16x32_bf16 a[88:91], v[220:223], a[148:151], a[88:91]
    s_mov_b32 s37, 568320
    v_accvgpr_read_b32 v82, a46
    v_accvgpr_read_b32 v83, a47
    v_mfma_f32_16x16x32_bf16 a[88:91], v[196:199], a[144:147], a[88:91]
    s_waitcnt lgkmcnt(2)
    v_add_f32 v80, v80, v48
    v_add_f32 v81, v81, v49
    v_mfma_f32_16x16x32_bf16 a[84:87], v[216:219], a[148:151], a[84:87]
    buffer_load_dwordx4 a[240:243], v2, s[12:15], s37 offen offset:1024 sc1
    v_mfma_f32_16x16x32_bf16 a[84:87], v[192:195], a[144:147], a[84:87]
    v_add_f32 v82, v82, v50
    v_add_f32 v83, v83, v51
    v_mfma_f32_16x16x32_bf16 a[80:83], v[212:215], a[148:151], a[80:83]
    s_waitcnt lgkmcnt(0)
    v_add_f32 v52, v52, v56
    v_add_f32 v53, v53, v57
    v_mfma_f32_16x16x32_bf16 a[80:83], v[188:191], a[144:147], a[80:83]
    s_mov_b32 s28, 595968
    v_add_f32 v54, v54, v58
    v_add_f32 v55, v55, v59
    v_mfma_f32_16x16x32_bf16 a[76:79], v[208:211], a[148:151], a[76:79]
    s_barrier
    v_mfma_f32_16x16x32_bf16 a[76:79], v[184:187], a[144:147], a[76:79]
    buffer_load_dwordx4 a[244:247], v2, s[12:15], s28 offen offset:1024 sc1
    v_mfma_f32_16x16x32_bf16 a[72:75], v[204:207], a[148:151], a[72:75]
    v_add_f32 v80, v80, v52
    v_add_f32 v81, v81, v53
    v_mfma_f32_16x16x32_bf16 a[72:75], v[180:183], a[144:147], a[72:75]
    s_waitcnt vmcnt(23)
    v_add_f32 v82, v82, v54
    v_add_f32 v83, v83, v55
    v_mfma_f32_16x16x32_bf16 a[72:75], v[208:211], a[152:155], a[72:75]
    s_waitcnt vmcnt(22)
    v_cndmask_b32 v81, 0, v81, s[76:77]
    v_cndmask_b32 v82, 0, v82, s[76:77]
    v_mfma_f32_16x16x32_bf16 a[72:75], v[212:215], a[156:159], a[72:75]
    s_mov_b32 s36, 623616
    v_cndmask_b32 v83, 0, v83, s[76:77]
    v_add_f32 v34, v34, v80
    v_mfma_f32_16x16x32_bf16 a[76:79], v[212:215], a[152:155], a[76:79]
    buffer_load_dwordx4 a[248:251], v2, s[12:15], s36 offen offset:1024 sc1
    v_mfma_f32_16x16x32_bf16 a[76:79], v[216:219], a[156:159], a[76:79]
    v_fmac_f32 v37, v80, v80
    v_add_f32 v34, v34, v81
    v_mfma_f32_16x16x32_bf16 a[80:83], v[216:219], a[152:155], a[80:83]
    v_fmac_f32 v37, v81, v81
    v_add_f32 v34, v34, v82
    v_mfma_f32_16x16x32_bf16 a[80:83], v[220:223], a[156:159], a[80:83]
    v_fmac_f32 v37, v82, v82
    v_add_f32 v34, v34, v83
    v_mfma_f32_16x16x32_bf16 a[84:87], v[220:223], a[152:155], a[84:87]
    s_mov_b32 s37, 651264
    ds_read2st64_b64 v[104:107], v22 offset0:98 offset1:99
    v_fmac_f32 v37, v83, v83
    v_mfma_f32_16x16x32_bf16 a[84:87], v[224:227], a[156:159], a[84:87]
    buffer_load_dwordx4 a[252:255], v2, s[12:15], s37 offen offset:1024 sc1
    v_mfma_f32_16x16x32_bf16 a[88:91], v[224:227], a[152:155], a[88:91]
    v_accvgpr_read_b32 v92, a64
    v_accvgpr_read_b32 v93, a65
    v_mfma_f32_16x16x32_bf16 a[88:91], v[228:231], a[156:159], a[88:91]
    ds_read2st64_b64 v[108:111], v22 offset0:94 offset1:95
    v_accvgpr_read_b32 v94, a66
    v_mfma_f32_16x16x32_bf16 a[92:95], v[228:231], a[152:155], a[92:95]
    s_mov_b32 s28, 451584
    v_accvgpr_read_b32 v95, a67
    v_mul_i32_i24 v46, 0, v45
    v_mfma_f32_16x16x32_bf16 a[92:95], v[232:235], a[156:159], a[92:95]
    s_waitcnt vmcnt(23)
    ds_read2st64_b64 v[112:115], v22 offset0:96 offset1:97
    v_add_u32 v46, 2560, v46
    v_mfma_f32_16x16x32_bf16 a[72:75], v[216:219], a[160:163], a[72:75]
    s_waitcnt vmcnt(22)
    buffer_load_dwordx4 a[144:147], v2, s[12:15], s28 offen offset:2048 sc1
    v_mfma_f32_16x16x32_bf16 a[72:75], v[220:223], a[164:167], a[72:75]
    s_waitcnt vmcnt(22)
    v_add_u32 v44, v116, v46
    v_mfma_f32_16x16x32_bf16 a[72:75], v[224:227], a[168:171], a[72:75]
    s_waitcnt vmcnt(21) lgkmcnt(2)
    ds_read2st64_b64 v[48:51], v22 offset0:104 offset1:105
    v_add_f32 v92, v92, v104
    v_mfma_f32_16x16x32_bf16 a[72:75], v[228:231], a[172:175], a[72:75]
    s_waitcnt vmcnt(20)
    v_add_f32 v93, v93, v105
    v_add_f32 v94, v94, v106
    v_mfma_f32_16x16x32_bf16 a[72:75], v[232:235], a[176:179], a[72:75]
    s_mov_b32 s36, 479232
    ds_read2st64_b64 v[52:55], v22 offset0:100 offset1:101
    v_add_f32 v95, v95, v107
    v_mfma_f32_16x16x32_bf16 a[76:79], v[236:239], a[176:179], a[76:79]
    buffer_load_dwordx4 a[148:151], v2, s[12:15], s36 offen offset:2048 sc1
    v_mfma_f32_16x16x32_bf16 a[76:79], v[232:235], a[172:175], a[76:79]
    s_waitcnt lgkmcnt(2)
    v_add_f32 v108, v108, v112
    v_add_f32 v109, v109, v113
    v_mfma_f32_16x16x32_bf16 a[76:79], v[228:231], a[168:171], a[76:79]
    ds_write_b64 v23, a[72:73] offset:2048
    v_mfma_f32_16x16x32_bf16 a[76:79], v[224:227], a[164:167], a[76:79]
    s_mov_b32 s37, 506880
    ds_read2st64_b64 v[56:59], v22 offset0:102 offset1:103
    v_add_f32 v110, v110, v114
    v_mfma_f32_16x16x32_bf16 a[76:79], v[220:223], a[160:163], a[76:79]
    ds_write_b64 v23, a[74:75] offset:2560
    v_mfma_f32_16x16x32_bf16 a[80:83], v[224:227], a[160:163], a[80:83]
    buffer_load_dwordx4 a[152:155], v2, s[12:15], s37 offen offset:2048 sc1
    v_mfma_f32_16x16x32_bf16 a[80:83], v[228:231], a[164:167], a[80:83]
    v_add_f32 v111, v111, v115
    v_add_f32 v92, v92, v108
    v_mfma_f32_16x16x32_bf16 a[80:83], v[232:235], a[168:171], a[80:83]
    ds_write_b64 v23, a[76:77] offset:5120
    v_mfma_f32_16x16x32_bf16 a[80:83], v[236:239], a[172:175], a[80:83]
    s_mov_b32 s28, 534528
    v_add_f32 v93, v93, v109
    v_add_f32 v94, v94, v110
    v_mfma_f32_16x16x32_bf16 a[80:83], v[240:243], a[176:179], a[80:83]
    ds_write_b64 v23, a[78:79] offset:5632
    v_mfma_f32_16x16x32_bf16 a[84:87], v[244:247], a[176:179], a[84:87]
    buffer_load_dwordx4 a[156:159], v2, s[12:15], s28 offen offset:2048 sc1
    v_mfma_f32_16x16x32_bf16 a[84:87], v[240:243], a[172:175], a[84:87]
    v_add_f32 v95, v95, v111
    v_cndmask_b32 v93, 0, v93, s[76:77]
    v_mfma_f32_16x16x32_bf16 a[84:87], v[236:239], a[168:171], a[84:87]
    ds_write_b64 v23, a[80:81] offset:8192
    v_mfma_f32_16x16x32_bf16 a[84:87], v[232:235], a[164:167], a[84:87]
    v_cndmask_b32 v94, 0, v94, s[76:77]
    v_cndmask_b32 v95, 0, v95, s[76:77]
    v_mfma_f32_16x16x32_bf16 a[84:87], v[228:231], a[160:163], a[84:87]
    ds_write_b64 v23, a[82:83] offset:8704
    v_mfma_f32_16x16x32_bf16 a[88:91], v[232:235], a[160:163], a[88:91]
    v_add_f32 v35, v35, v92
    v_fmac_f32 v38, v92, v92
    v_mfma_f32_16x16x32_bf16 a[88:91], v[236:239], a[164:167], a[88:91]
    v_add_f32 v35, v35, v93
    v_fmac_f32 v38, v93, v93
    v_mfma_f32_16x16x32_bf16 a[88:91], v[240:243], a[168:171], a[88:91]
    ds_write_b64 v23, a[84:85] offset:11264
    v_mfma_f32_16x16x32_bf16 a[88:91], v[244:247], a[172:175], a[88:91]
    v_add_f32 v35, v35, v94
    v_fmac_f32 v38, v94, v94
    v_mfma_f32_16x16x32_bf16 a[88:91], v[248:251], a[176:179], a[88:91]
    ds_write_b64 v23, a[86:87] offset:11776
    v_mfma_f32_16x16x32_bf16 a[92:95], v[252:255], a[176:179], a[92:95]
    v_add_f32 v35, v35, v95
    v_fmac_f32 v38, v95, v95
    v_mfma_f32_16x16x32_bf16 a[92:95], v[248:251], a[172:175], a[92:95]
    v_accvgpr_read_b32 v96, a68
    v_accvgpr_read_b32 v97, a69
    v_mfma_f32_16x16x32_bf16 a[92:95], v[244:247], a[168:171], a[92:95]
    s_mov_b32 s36, 562176
    v_accvgpr_read_b32 v98, a70
    v_accvgpr_read_b32 v99, a71
    v_mfma_f32_16x16x32_bf16 a[92:95], v[240:243], a[164:167], a[92:95]
    s_waitcnt lgkmcnt(10)
    v_add_f32 v96, v96, v48
    v_add_f32 v97, v97, v49
    v_mfma_f32_16x16x32_bf16 a[92:95], v[236:239], a[160:163], a[92:95]
    s_waitcnt vmcnt(22)
    buffer_load_dwordx4 a[160:163], v2, s[12:15], s36 offen offset:2048 sc1
    v_mfma_f32_16x16x32_bf16 a[96:99], v[120:123], a[180:183], a[24:27]
    s_waitcnt vmcnt(22)
    s_mov_b32 s37, 589824
    v_add_f32 v98, v98, v50
    v_add_f32 v99, v99, v51
    v_mfma_f32_16x16x32_bf16 a[96:99], v[124:127], a[184:187], a[96:99]
    buffer_load_dwordx4 a[164:167], v2, s[12:15], s37 offen offset:2048 sc1
    v_mfma_f32_16x16x32_bf16 a[100:103], v[124:127], a[180:183], a[28:31]
    s_waitcnt lgkmcnt(7)
    s_mov_b32 s28, 617472
    v_add_f32 v52, v52, v56
    v_add_f32 v53, v53, v57
    v_mfma_f32_16x16x32_bf16 a[100:103], v[128:131], a[184:187], a[100:103]
    buffer_load_dwordx4 a[168:171], v2, s[12:15], s28 offen offset:2048 sc1
    v_mfma_f32_16x16x32_bf16 a[104:107], v[128:131], a[180:183], a[32:35]
    s_mov_b32 s36, 645120
    v_add_f32 v54, v54, v58
    v_add_f32 v55, v55, v59
    v_mfma_f32_16x16x32_bf16 a[104:107], v[132:135], a[184:187], a[104:107]
    buffer_load_dwordx4 a[172:175], v2, s[12:15], s36 offen offset:2048 sc1
    v_mfma_f32_16x16x32_bf16 a[108:111], v[132:135], a[180:183], a[36:39]
    v_add_f32 v96, v96, v52
    v_add_f32 v97, v97, v53
    v_mfma_f32_16x16x32_bf16 a[108:111], v[136:139], a[184:187], a[108:111]
    v_add_f32 v98, v98, v54
    v_add_f32 v99, v99, v55
    v_mfma_f32_16x16x32_bf16 a[112:115], v[136:139], a[180:183], a[40:43]
    s_mov_b32 s37, 577536
    v_cndmask_b32 v97, 0, v97, s[76:77]
    v_cndmask_b32 v98, 0, v98, s[76:77]
    v_mfma_f32_16x16x32_bf16 a[112:115], v[140:143], a[184:187], a[112:115]
    buffer_load_dwordx4 a[176:179], v2, s[12:15], s37 offen offset:2048 sc1
    v_mfma_f32_16x16x32_bf16 a[116:119], v[140:143], a[180:183], a[44:47]
    v_cndmask_b32 v99, 0, v99, s[76:77]
    v_add_f32 v35, v35, v96
    v_mfma_f32_16x16x32_bf16 a[116:119], v[144:147], a[184:187], a[116:119]
    s_waitcnt vmcnt(24)
    v_fmac_f32 v38, v96, v96
    v_add_f32 v35, v35, v97
    v_mfma_f32_16x16x32_bf16 a[116:119], v[152:155], a[192:195], a[116:119]
    v_fmac_f32 v38, v97, v97
    v_add_f32 v35, v35, v98
    v_mfma_f32_16x16x32_bf16 a[116:119], v[148:151], a[188:191], a[116:119]
    s_mov_b32 s28, 605184
    v_fmac_f32 v38, v98, v98
    v_add_f32 v35, v35, v99
    v_mfma_f32_16x16x32_bf16 a[112:115], v[148:151], a[192:195], a[112:115]
    buffer_load_dwordx4 a[180:183], v2, s[12:15], s28 offen offset:2048 sc1
    v_mfma_f32_16x16x32_bf16 a[112:115], v[144:147], a[188:191], a[112:115]
    v_fmac_f32 v38, v99, v99
    v_mfma_f32_16x16x32_bf16 a[108:111], v[144:147], a[192:195], a[108:111]
    v_mfma_f32_16x16x32_bf16 a[108:111], v[140:143], a[188:191], a[108:111]
    v_mfma_f32_16x16x32_bf16 a[104:107], v[140:143], a[192:195], a[104:107]
    s_mov_b32 s36, 632832
    v_mfma_f32_16x16x32_bf16 a[104:107], v[136:139], a[188:191], a[104:107]
    buffer_load_dwordx4 a[184:187], v2, s[12:15], s36 offen offset:2048 sc1
    v_mfma_f32_16x16x32_bf16 a[100:103], v[136:139], a[192:195], a[100:103]
    v_mfma_f32_16x16x32_bf16 a[100:103], v[132:135], a[188:191], a[100:103]
    v_mfma_f32_16x16x32_bf16 a[96:99], v[132:135], a[192:195], a[96:99]
    v_mfma_f32_16x16x32_bf16 a[96:99], v[128:131], a[188:191], a[96:99]
    s_waitcnt vmcnt(25)
    s_mov_b32 s37, 457728
    v_mfma_f32_16x16x32_bf16 a[96:99], v[136:139], a[196:199], a[96:99]
    s_waitcnt vmcnt(24)
    buffer_load_dwordx4 a[188:191], v2, s[12:15], s37 offen offset:2048 sc1
    v_mfma_f32_16x16x32_bf16 a[96:99], v[140:143], a[200:203], a[96:99]
    v_mfma_f32_16x16x32_bf16 a[100:103], v[140:143], a[196:199], a[100:103]
    v_mfma_f32_16x16x32_bf16 a[100:103], v[144:147], a[200:203], a[100:103]
    v_mfma_f32_16x16x32_bf16 a[104:107], v[144:147], a[196:199], a[104:107]
    s_mov_b32 s28, 485376
    v_mfma_f32_16x16x32_bf16 a[104:107], v[148:151], a[200:203], a[104:107]
    s_waitcnt lgkmcnt(0)
    s_barrier
    v_mfma_f32_16x16x32_bf16 a[108:111], v[148:151], a[196:199], a[108:111]
    buffer_load_dwordx4 a[192:195], v2, s[12:15], s28 offen offset:2048 sc1
    v_mfma_f32_16x16x32_bf16 a[108:111], v[152:155], a[200:203], a[108:111]
    ds_read2st64_b64 v[104:107], v23 offset0:28 offset1:29
    v_accvgpr_read_b32 v72, a88
    v_mfma_f32_16x16x32_bf16 a[112:115], v[152:155], a[196:199], a[112:115]
    v_accvgpr_read_b32 v73, a89
    v_accvgpr_read_b32 v74, a90
    v_mfma_f32_16x16x32_bf16 a[112:115], v[156:159], a[200:203], a[112:115]
    s_mov_b32 s36, 513024
    ds_read2st64_b64 v[108:111], v23 offset0:24 offset1:25
    v_accvgpr_read_b32 v75, a91
    v_mfma_f32_16x16x32_bf16 a[116:119], v[156:159], a[196:199], a[116:119]
    buffer_load_dwordx4 a[196:199], v2, s[12:15], s36 offen offset:2048 sc1
    v_mfma_f32_16x16x32_bf16 a[116:119], v[160:163], a[200:203], a[116:119]
    s_waitcnt vmcnt(25)
    ds_read2st64_b64 v[112:115], v23 offset0:26 offset1:27
    v_mfma_f32_16x16x32_bf16 a[116:119], v[168:171], a[208:211], a[116:119]
    v_mfma_f32_16x16x32_bf16 a[116:119], v[164:167], a[204:207], a[116:119]
    v_mfma_f32_16x16x32_bf16 a[112:115], v[164:167], a[208:211], a[112:115]
    s_mov_b32 s37, 540672
    v_mfma_f32_16x16x32_bf16 a[112:115], v[160:163], a[204:207], a[112:115]
    buffer_load_dwordx4 a[200:203], v2, s[12:15], s37 offen offset:2048 sc1
    v_mfma_f32_16x16x32_bf16 a[108:111], v[160:163], a[208:211], a[108:111]
    s_waitcnt lgkmcnt(2)
    ds_read2st64_b64 v[48:51], v23 offset0:34 offset1:35
    v_add_f32 v72, v72, v104
    v_mfma_f32_16x16x32_bf16 a[108:111], v[156:159], a[204:207], a[108:111]
    v_add_f32 v73, v73, v105
    v_add_f32 v74, v74, v106
    v_mfma_f32_16x16x32_bf16 a[104:107], v[156:159], a[208:211], a[104:107]
    ds_read2st64_b64 v[52:55], v23 offset0:30 offset1:31
    v_add_f32 v75, v75, v107
    v_mfma_f32_16x16x32_bf16 a[104:107], v[152:155], a[204:207], a[104:107]
    s_waitcnt lgkmcnt(2)
    v_add_f32 v108, v108, v112
    v_add_f32 v109, v109, v113
    v_mfma_f32_16x16x32_bf16 a[100:103], v[152:155], a[208:211], a[100:103]
    ds_read2st64_b64 v[56:59], v23 offset0:32 offset1:33
    v_add_f32 v110, v110, v114
    v_mfma_f32_16x16x32_bf16 a[100:103], v[148:151], a[204:207], a[100:103]
    v_add_f32 v111, v111, v115
    v_sub_f32 v72, -v72, v108
    v_mfma_f32_16x16x32_bf16 a[96:99], v[148:151], a[208:211], a[96:99]
    s_mov_b32 s28, 568320
    v_sub_f32 v73, -v73, v109
    v_sub_f32 v74, -v74, v110
    v_mfma_f32_16x16x32_bf16 a[96:99], v[144:147], a[204:207], a[96:99]
    s_waitcnt vmcnt(25)
    buffer_load_dwordx4 a[204:207], v2, s[12:15], s28 offen offset:2048 sc1
    v_mfma_f32_16x16x32_bf16 a[96:99], v[172:175], a[212:215], a[96:99]
    s_waitcnt vmcnt(25)
    s_mov_b32 s36, 595968
    v_sub_f32 v75, -v75, v111
    v_cndmask_b32 v73, 0, v73, s[76:77]
    v_mfma_f32_16x16x32_bf16 a[96:99], v[176:179], a[216:219], a[96:99]
    buffer_load_dwordx4 a[208:211], v2, s[12:15], s36 offen offset:2048 sc1
    v_mfma_f32_16x16x32_bf16 a[100:103], v[176:179], a[212:215], a[100:103]
    v_cndmask_b32 v74, 0, v74, s[76:77]
    v_cndmask_b32 v75, 0, v75, s[76:77]
    v_mfma_f32_16x16x32_bf16 a[100:103], v[180:183], a[216:219], a[100:103]
    v_add_f32 v33, v33, v72
    v_fmac_f32 v36, v72, v72
    v_mfma_f32_16x16x32_bf16 a[104:107], v[180:183], a[212:215], a[104:107]
    v_add_f32 v33, v33, v73
    v_fmac_f32 v36, v73, v73
    v_mfma_f32_16x16x32_bf16 a[104:107], v[184:187], a[216:219], a[104:107]
    v_add_f32 v33, v33, v74
    v_fmac_f32 v36, v74, v74
    v_mfma_f32_16x16x32_bf16 a[108:111], v[184:187], a[212:215], a[108:111]
    v_add_f32 v33, v33, v75
    v_fmac_f32 v36, v75, v75
    v_mfma_f32_16x16x32_bf16 a[108:111], v[188:191], a[216:219], a[108:111]
    v_accvgpr_read_b32 v76, a92
    v_accvgpr_read_b32 v77, a93
    v_mfma_f32_16x16x32_bf16 a[112:115], v[188:191], a[212:215], a[112:115]
    s_mov_b32 s37, 623616
    v_accvgpr_read_b32 v78, a94
    v_accvgpr_read_b32 v79, a95
    v_mfma_f32_16x16x32_bf16 a[112:115], v[192:195], a[216:219], a[112:115]
    s_waitcnt lgkmcnt(2)
    v_add_f32 v76, v76, v48
    v_add_f32 v77, v77, v49
    v_mfma_f32_16x16x32_bf16 a[116:119], v[192:195], a[212:215], a[116:119]
    buffer_load_dwordx4 a[212:215], v2, s[12:15], s37 offen offset:2048 sc1
    v_mfma_f32_16x16x32_bf16 a[116:119], v[196:199], a[216:219], a[116:119]
    s_waitcnt vmcnt(25)
    s_mov_b32 s28, 651264
    v_add_f32 v78, v78, v50
    v_add_f32 v79, v79, v51
    v_mfma_f32_16x16x32_bf16 a[116:119], v[224:227], a[224:227], a[116:119]
    buffer_load_dwordx4 a[216:219], v2, s[12:15], s28 offen offset:2048 sc1
    v_mfma_f32_16x16x32_bf16 a[116:119], v[200:203], a[220:223], a[116:119]
    s_waitcnt lgkmcnt(0)
    v_add_f32 v52, v52, v56
    v_add_f32 v53, v53, v57
    v_mfma_f32_16x16x32_bf16 a[112:115], v[220:223], a[224:227], a[112:115]
    v_add_f32 v54, v54, v58
    v_add_f32 v55, v55, v59
    v_mfma_f32_16x16x32_bf16 a[112:115], v[196:199], a[220:223], a[112:115]
    v_sub_f32 v76, -v76, v52
    v_sub_f32 v77, -v77, v53
    v_mfma_f32_16x16x32_bf16 a[108:111], v[216:219], a[224:227], a[108:111]
    v_sub_f32 v78, -v78, v54
    v_sub_f32 v79, -v79, v55
    v_mfma_f32_16x16x32_bf16 a[108:111], v[192:195], a[220:223], a[108:111]
    v_cndmask_b32 v76, 0, v76, s[76:77]
    v_cndmask_b32 v77, 0, v77, s[76:77]
    v_mfma_f32_16x16x32_bf16 a[104:107], v[212:215], a[224:227], a[104:107]
    buffer_load_dword v12, v47, s[16:19], 0 offen sc1
    v_mfma_f32_16x16x32_bf16 a[104:107], v[188:191], a[220:223], a[104:107]
    v_cndmask_b32 v78, 0, v78, s[76:77]
    v_cndmask_b32 v79, 0, v79, s[76:77]
    v_mfma_f32_16x16x32_bf16 a[100:103], v[208:211], a[224:227], a[100:103]
    v_add_f32 v33, v33, v76
    v_fmac_f32 v36, v76, v76
    v_mfma_f32_16x16x32_bf16 a[100:103], v[184:187], a[220:223], a[100:103]
    v_add_f32 v33, v33, v77
    v_fmac_f32 v36, v77, v77
    v_mfma_f32_16x16x32_bf16 a[96:99], v[204:207], a[224:227], a[96:99]
    v_add_f32 v33, v33, v78
    v_fmac_f32 v36, v78, v78
    v_mfma_f32_16x16x32_bf16 a[96:99], v[180:183], a[220:223], a[96:99]
    s_waitcnt vmcnt(26)
    v_add_f32 v33, v33, v79
    v_fmac_f32 v36, v79, v79
    v_mfma_f32_16x16x32_bf16 a[96:99], v[208:211], a[228:231], a[96:99]
    s_waitcnt vmcnt(25)
    v_mfma_f32_16x16x32_bf16 a[96:99], v[212:215], a[232:235], a[96:99]
    v_permlane32_swap_b32 v33, v36
    v_add_f32 v33, v33, v36
    v_mfma_f32_16x16x32_bf16 a[100:103], v[212:215], a[228:231], a[100:103]
    ds_write_b32 v24, v33 offset:0
    v_mfma_f32_16x16x32_bf16 a[100:103], v[216:219], a[232:235], a[100:103]
    v_mfma_f32_16x16x32_bf16 a[104:107], v[216:219], a[228:231], a[104:107]
    v_mfma_f32_16x16x32_bf16 a[104:107], v[220:223], a[232:235], a[104:107]
    v_mfma_f32_16x16x32_bf16 a[108:111], v[220:223], a[228:231], a[108:111]
    s_waitcnt lgkmcnt(0)
    s_barrier
    v_mfma_f32_16x16x32_bf16 a[108:111], v[224:227], a[232:235], a[108:111]
    v_mfma_f32_16x16x32_bf16 a[112:115], v[224:227], a[228:231], a[112:115]
    v_mfma_f32_16x16x32_bf16 a[112:115], v[228:231], a[232:235], a[112:115]
    v_mfma_f32_16x16x32_bf16 a[116:119], v[228:231], a[228:231], a[116:119]
    v_mfma_f32_16x16x32_bf16 a[116:119], v[232:235], a[232:235], a[116:119]
    s_waitcnt vmcnt(24)
    v_mfma_f32_16x16x32_bf16 a[96:99], v[216:219], a[236:239], a[96:99]
    s_waitcnt vmcnt(23)
    v_mfma_f32_16x16x32_bf16 a[96:99], v[220:223], a[240:243], a[96:99]
    s_waitcnt vmcnt(22)
    v_mfma_f32_16x16x32_bf16 a[96:99], v[224:227], a[244:247], a[96:99]
    s_waitcnt vmcnt(21)
    v_mfma_f32_16x16x32_bf16 a[96:99], v[228:231], a[248:251], a[96:99]
    s_waitcnt vmcnt(20)
    v_mfma_f32_16x16x32_bf16 a[96:99], v[232:235], a[252:255], a[96:99]
    v_mfma_f32_16x16x32_bf16 a[100:103], v[236:239], a[252:255], a[100:103]
    v_mfma_f32_16x16x32_bf16 a[100:103], v[232:235], a[248:251], a[100:103]
    v_mfma_f32_16x16x32_bf16 a[100:103], v[228:231], a[244:247], a[100:103]
    ds_write_b64 v23, a[96:97] offset:20480
    v_mfma_f32_16x16x32_bf16 a[100:103], v[224:227], a[240:243], a[100:103]
    v_mfma_f32_16x16x32_bf16 a[100:103], v[220:223], a[236:239], a[100:103]
    ds_write_b64 v23, a[98:99] offset:20992
    v_mfma_f32_16x16x32_bf16 a[104:107], v[224:227], a[236:239], a[104:107]
    v_mfma_f32_16x16x32_bf16 a[104:107], v[228:231], a[240:243], a[104:107]
    v_mfma_f32_16x16x32_bf16 a[104:107], v[232:235], a[244:247], a[104:107]
    ds_write_b64 v23, a[100:101] offset:23552
    v_mfma_f32_16x16x32_bf16 a[104:107], v[236:239], a[248:251], a[104:107]
    v_mfma_f32_16x16x32_bf16 a[104:107], v[240:243], a[252:255], a[104:107]
    ds_write_b64 v23, a[102:103] offset:24064
    v_mfma_f32_16x16x32_bf16 a[108:111], v[244:247], a[252:255], a[108:111]
    v_mfma_f32_16x16x32_bf16 a[108:111], v[240:243], a[248:251], a[108:111]
    v_mfma_f32_16x16x32_bf16 a[108:111], v[236:239], a[244:247], a[108:111]
    ds_write_b64 v23, a[104:105] offset:26624
    v_mfma_f32_16x16x32_bf16 a[108:111], v[232:235], a[240:243], a[108:111]
    v_mfma_f32_16x16x32_bf16 a[108:111], v[228:231], a[236:239], a[108:111]
    ds_write_b64 v23, a[106:107] offset:27136
    v_mfma_f32_16x16x32_bf16 a[112:115], v[232:235], a[236:239], a[112:115]
    v_mfma_f32_16x16x32_bf16 a[112:115], v[236:239], a[240:243], a[112:115]
    v_mfma_f32_16x16x32_bf16 a[112:115], v[240:243], a[244:247], a[112:115]
    ds_write_b64 v23, a[108:109] offset:29696
    v_mfma_f32_16x16x32_bf16 a[112:115], v[244:247], a[248:251], a[112:115]
    v_mfma_f32_16x16x32_bf16 a[112:115], v[248:251], a[252:255], a[112:115]
    ds_write_b64 v23, a[110:111] offset:30208
    v_mfma_f32_16x16x32_bf16 a[116:119], v[252:255], a[252:255], a[116:119]
    v_mfma_f32_16x16x32_bf16 a[116:119], v[248:251], a[248:251], a[116:119]
    v_mfma_f32_16x16x32_bf16 a[116:119], v[244:247], a[244:247], a[116:119]
    v_mfma_f32_16x16x32_bf16 a[116:119], v[240:243], a[240:243], a[116:119]
    v_mfma_f32_16x16x32_bf16 a[116:119], v[236:239], a[236:239], a[116:119]
    s_waitcnt vmcnt(19)
    v_mfma_f32_16x16x32_bf16 a[120:123], v[120:123], a[144:147], a[48:51]
    s_waitcnt vmcnt(18)
    v_mfma_f32_16x16x32_bf16 a[120:123], v[124:127], a[148:151], a[120:123]
    v_mfma_f32_16x16x32_bf16 a[124:127], v[124:127], a[144:147], a[52:55]
    v_mfma_f32_16x16x32_bf16 a[124:127], v[128:131], a[148:151], a[124:127]
    v_mfma_f32_16x16x32_bf16 a[128:131], v[128:131], a[144:147], a[56:59]
    v_mfma_f32_16x16x32_bf16 a[128:131], v[132:135], a[148:151], a[128:131]
    v_mfma_f32_16x16x32_bf16 a[132:135], v[132:135], a[144:147], a[60:63]
    v_mfma_f32_16x16x32_bf16 a[132:135], v[136:139], a[148:151], a[132:135]
    v_mfma_f32_16x16x32_bf16 a[136:139], v[136:139], a[144:147], a[64:67]
    v_mfma_f32_16x16x32_bf16 a[136:139], v[140:143], a[148:151], a[136:139]
    s_waitcnt vmcnt(16)
    v_mfma_f32_16x16x32_bf16 a[136:139], v[148:151], a[156:159], a[136:139]
    v_mfma_f32_16x16x32_bf16 a[136:139], v[144:147], a[152:155], a[136:139]
    v_mfma_f32_16x16x32_bf16 a[132:135], v[144:147], a[156:159], a[132:135]
    v_mfma_f32_16x16x32_bf16 a[132:135], v[140:143], a[152:155], a[132:135]
    v_mfma_f32_16x16x32_bf16 a[128:131], v[140:143], a[156:159], a[128:131]
    v_mfma_f32_16x16x32_bf16 a[128:131], v[136:139], a[152:155], a[128:131]
    v_mfma_f32_16x16x32_bf16 a[124:127], v[136:139], a[156:159], a[124:127]
    v_mfma_f32_16x16x32_bf16 a[124:127], v[132:135], a[152:155], a[124:127]
    s_waitcnt lgkmcnt(0)
    s_barrier
    v_mfma_f32_16x16x32_bf16 a[120:123], v[132:135], a[156:159], a[120:123]
    ds_read2st64_b64 v[104:107], v23 offset0:64 offset1:65
    v_accvgpr_read_b32 v84, a112
    v_mfma_f32_16x16x32_bf16 a[120:123], v[128:131], a[152:155], a[120:123]
    s_waitcnt vmcnt(15)
    v_accvgpr_read_b32 v85, a113
    v_accvgpr_read_b32 v86, a114
    v_mfma_f32_16x16x32_bf16 a[120:123], v[136:139], a[160:163], a[120:123]
    s_waitcnt vmcnt(14)
    ds_read2st64_b64 v[108:111], v23 offset0:60 offset1:61
    v_accvgpr_read_b32 v87, a115
    v_mfma_f32_16x16x32_bf16 a[120:123], v[140:143], a[164:167], a[120:123]
    v_mfma_f32_16x16x32_bf16 a[124:127], v[140:143], a[160:163], a[124:127]
    ds_read2st64_b64 v[112:115], v23 offset0:62 offset1:63
    v_mfma_f32_16x16x32_bf16 a[124:127], v[144:147], a[164:167], a[124:127]
    v_mfma_f32_16x16x32_bf16 a[128:131], v[144:147], a[160:163], a[128:131]
    v_mfma_f32_16x16x32_bf16 a[128:131], v[148:151], a[164:167], a[128:131]
    v_mfma_f32_16x16x32_bf16 a[132:135], v[148:151], a[160:163], a[132:135]
    s_waitcnt lgkmcnt(2)
    ds_read2st64_b64 v[48:51], v23 offset0:70 offset1:71
    v_add_f32 v84, v84, v104
    v_mfma_f32_16x16x32_bf16 a[132:135], v[152:155], a[164:167], a[132:135]
    v_add_f32 v85, v85, v105
    v_add_f32 v86, v86, v106
    v_mfma_f32_16x16x32_bf16 a[136:139], v[152:155], a[160:163], a[136:139]
    ds_read2st64_b64 v[52:55], v23 offset0:66 offset1:67
    v_add_f32 v87, v87, v107
    v_mfma_f32_16x16x32_bf16 a[136:139], v[156:159], a[164:167], a[136:139]
    s_waitcnt vmcnt(12) lgkmcnt(2)
    v_add_f32 v108, v108, v112
    v_add_f32 v109, v109, v113
    v_mfma_f32_16x16x32_bf16 a[136:139], v[164:167], a[172:175], a[136:139]
    ds_read2st64_b64 v[56:59], v23 offset0:68 offset1:69
    v_add_f32 v110, v110, v114
    v_mfma_f32_16x16x32_bf16 a[136:139], v[160:163], a[168:171], a[136:139]
    v_add_f32 v111, v111, v115
    v_sub_f32 v84, -v84, v108
    v_mfma_f32_16x16x32_bf16 a[132:135], v[160:163], a[172:175], a[132:135]
    v_sub_f32 v85, -v85, v109
    v_sub_f32 v86, -v86, v110
    v_mfma_f32_16x16x32_bf16 a[132:135], v[156:159], a[168:171], a[132:135]
    v_sub_f32 v87, -v87, v111
    v_cndmask_b32 v85, 0, v85, s[76:77]
    v_mfma_f32_16x16x32_bf16 a[128:131], v[156:159], a[172:175], a[128:131]
    v_cndmask_b32 v86, 0, v86, s[76:77]
    v_cndmask_b32 v87, 0, v87, s[76:77]
    v_mfma_f32_16x16x32_bf16 a[128:131], v[152:155], a[168:171], a[128:131]
    v_add_f32 v34, v34, v84
    v_fmac_f32 v37, v84, v84
    v_mfma_f32_16x16x32_bf16 a[124:127], v[152:155], a[172:175], a[124:127]
    v_add_f32 v34, v34, v85
    v_fmac_f32 v37, v85, v85
    v_mfma_f32_16x16x32_bf16 a[124:127], v[148:151], a[168:171], a[124:127]
    v_add_f32 v34, v34, v86
    v_fmac_f32 v37, v86, v86
    v_mfma_f32_16x16x32_bf16 a[120:123], v[148:151], a[172:175], a[120:123]
    v_add_f32 v34, v34, v87
    v_fmac_f32 v37, v87, v87
    v_mfma_f32_16x16x32_bf16 a[120:123], v[144:147], a[168:171], a[120:123]
    s_waitcnt vmcnt(11)
    v_accvgpr_read_b32 v88, a116
    v_accvgpr_read_b32 v89, a117
    v_mfma_f32_16x16x32_bf16 a[120:123], v[172:175], a[176:179], a[120:123]
    s_waitcnt vmcnt(10)
    buffer_load_dwordx2 v[6:7], v28, s[24:27], 0 offen offset:0 sc1
    v_mfma_f32_16x16x32_bf16 a[120:123], v[176:179], a[180:183], a[120:123]
    v_accvgpr_read_b32 v90, a118
    v_accvgpr_read_b32 v91, a119
    v_mfma_f32_16x16x32_bf16 a[124:127], v[176:179], a[176:179], a[124:127]
    buffer_load_dwordx2 v[8:9], v28, s[24:27], 0 offen offset:2048 sc1
    v_mfma_f32_16x16x32_bf16 a[124:127], v[180:183], a[180:183], a[124:127]
    s_waitcnt lgkmcnt(2)
    v_add_f32 v88, v88, v48
    v_add_f32 v89, v89, v49
    v_mfma_f32_16x16x32_bf16 a[128:131], v[180:183], a[176:179], a[128:131]
    buffer_load_dwordx2 v[10:11], v3, s[24:27], 0 offen offset:0 sc1
    v_mfma_f32_16x16x32_bf16 a[128:131], v[184:187], a[180:183], a[128:131]
    v_add_f32 v90, v90, v50
    v_add_f32 v91, v91, v51
    v_mfma_f32_16x16x32_bf16 a[132:135], v[184:187], a[176:179], a[132:135]
    s_waitcnt lgkmcnt(0)
    v_add_f32 v52, v52, v56
    v_add_f32 v53, v53, v57
    v_mfma_f32_16x16x32_bf16 a[132:135], v[188:191], a[180:183], a[132:135]
    v_add_f32 v54, v54, v58
    v_add_f32 v55, v55, v59
    v_mfma_f32_16x16x32_bf16 a[136:139], v[188:191], a[176:179], a[136:139]
    v_sub_f32 v88, -v88, v52
    v_sub_f32 v89, -v89, v53
    v_mfma_f32_16x16x32_bf16 a[136:139], v[192:195], a[180:183], a[136:139]
    s_waitcnt vmcnt(12)
    v_sub_f32 v90, -v90, v54
    v_sub_f32 v91, -v91, v55
    v_mfma_f32_16x16x32_bf16 a[120:123], v[180:183], a[184:187], a[120:123]
    s_waitcnt vmcnt(11)
    v_cndmask_b32 v88, 0, v88, s[76:77]
    v_cndmask_b32 v89, 0, v89, s[76:77]
    v_mfma_f32_16x16x32_bf16 a[120:123], v[204:207], a[188:191], a[120:123]
    s_waitcnt vmcnt(10)
    v_cndmask_b32 v90, 0, v90, s[76:77]
    v_cndmask_b32 v91, 0, v91, s[76:77]
    v_mfma_f32_16x16x32_bf16 a[120:123], v[208:211], a[192:195], a[120:123]
    s_waitcnt vmcnt(9)
    v_add_f32 v34, v34, v88
    v_fmac_f32 v37, v88, v88
    v_mfma_f32_16x16x32_bf16 a[120:123], v[212:215], a[196:199], a[120:123]
    s_waitcnt vmcnt(8)
    v_add_f32 v34, v34, v89
    v_fmac_f32 v37, v89, v89
    v_mfma_f32_16x16x32_bf16 a[120:123], v[216:219], a[200:203], a[120:123]
    s_waitcnt vmcnt(7)
    v_add_f32 v34, v34, v90
    v_fmac_f32 v37, v90, v90
    v_mfma_f32_16x16x32_bf16 a[120:123], v[220:223], a[204:207], a[120:123]
    s_waitcnt vmcnt(6)
    v_add_f32 v34, v34, v91
    v_fmac_f32 v37, v91, v91
    v_mfma_f32_16x16x32_bf16 a[120:123], v[224:227], a[208:211], a[120:123]
    s_waitcnt vmcnt(5)
    v_mfma_f32_16x16x32_bf16 a[120:123], v[228:231], a[212:215], a[120:123]
    s_waitcnt vmcnt(4)
    v_permlane32_swap_b32 v34, v37
    v_add_f32 v34, v34, v37
    v_mfma_f32_16x16x32_bf16 a[120:123], v[232:235], a[216:219], a[120:123]
    ds_write_b32 v24, v34 offset:1024
    v_mfma_f32_16x16x32_bf16 a[128:131], v[240:243], a[216:219], a[128:131]
    v_mfma_f32_16x16x32_bf16 a[128:131], v[236:239], a[212:215], a[128:131]
    v_mfma_f32_16x16x32_bf16 a[128:131], v[232:235], a[208:211], a[128:131]
    ds_write_b64 v23, a[120:121] offset:38912
    v_mfma_f32_16x16x32_bf16 a[128:131], v[228:231], a[204:207], a[128:131]
Lt13:
    s_cbranch_execz Lt14
    v_mfma_f32_16x16x32_bf16 a[128:131], v[224:227], a[200:203], a[128:131]
    s_waitcnt lgkmcnt(1)
    s_barrier
    v_mfma_f32_16x16x32_bf16 a[128:131], v[220:223], a[196:199], a[128:131]
    ds_write_b64 v23, a[122:123] offset:39424
    v_mfma_f32_16x16x32_bf16 a[128:131], v[216:219], a[192:195], a[128:131]
    v_accvgpr_read_b32 v100, a68
    v_accvgpr_read_b32 v101, a69
    v_mfma_f32_16x16x32_bf16 a[128:131], v[212:215], a[188:191], a[128:131]
    v_accvgpr_read_b32 v102, a70
    v_accvgpr_read_b32 v103, a71
    v_mfma_f32_16x16x32_bf16 a[128:131], v[188:191], a[184:187], a[128:131]
    v_mfma_f32_16x16x32_bf16 a[132:135], v[192:195], a[184:187], a[132:135]
    v_mfma_f32_16x16x32_bf16 a[132:135], v[216:219], a[188:191], a[132:135]
    v_mfma_f32_16x16x32_bf16 a[132:135], v[220:223], a[192:195], a[132:135]
    ds_write_b64 v23, a[128:129] offset:45056
    v_mfma_f32_16x16x32_bf16 a[132:135], v[224:227], a[196:199], a[132:135]
    v_mfma_f32_16x16x32_bf16 a[132:135], v[228:231], a[200:203], a[132:135]
    ds_write_b64 v23, a[130:131] offset:45568
    v_mfma_f32_16x16x32_bf16 a[132:135], v[232:235], a[204:207], a[132:135]
    v_mfma_f32_16x16x32_bf16 a[132:135], v[236:239], a[208:211], a[132:135]
    v_mfma_f32_16x16x32_bf16 a[132:135], v[240:243], a[212:215], a[132:135]
    v_mfma_f32_16x16x32_bf16 a[132:135], v[244:247], a[216:219], a[132:135]
    v_mfma_f32_16x16x32_bf16 a[136:139], v[248:251], a[216:219], a[136:139]
    v_mfma_f32_16x16x32_bf16 a[136:139], v[244:247], a[212:215], a[136:139]
    s_waitcnt lgkmcnt(0)
    s_barrier
    v_mfma_f32_16x16x32_bf16 a[136:139], v[240:243], a[208:211], a[136:139]
    ds_write_b64 v23, a[132:133] offset:48128
    v_mfma_f32_16x16x32_bf16 a[136:139], v[236:239], a[204:207], a[136:139]
    v_mfma_f32_16x16x32_bf16 a[136:139], v[232:235], a[200:203], a[136:139]
    ds_write_b64 v23, a[134:135] offset:48640
    v_mfma_f32_16x16x32_bf16 a[136:139], v[228:231], a[196:199], a[136:139]
    v_mfma_f32_16x16x32_bf16 a[136:139], v[224:227], a[192:195], a[136:139]
    v_mfma_f32_16x16x32_bf16 a[136:139], v[220:223], a[188:191], a[136:139]
    v_mfma_f32_16x16x32_bf16 a[136:139], v[196:199], a[184:187], a[136:139]
    s_waitcnt vmcnt(0)
    v_max3_u32 v39, v6, v7, v8
    v_max3_u32 v39, v39, v10, v11
    v_mfma_f32_16x16x32_bf16 a[124:127], v[184:187], a[184:187], a[124:127]
    v_max_u32 v39, v39, v9
    v_cmp_eq_u32 vcc, -1, v39
    v_mfma_f32_16x16x32_bf16 a[124:127], v[208:211], a[188:191], a[124:127]
    v_mfma_f32_16x16x32_bf16 a[124:127], v[212:215], a[192:195], a[124:127]
    s_cbranch_vccnz Lg3_0
Lh3_0:
    ds_write_b64 v23, a[136:137] offset:51200
    v_mfma_f32_16x16x32_bf16 a[124:127], v[216:219], a[196:199], a[124:127]
    v_add_f32 v6, v6, v8
    v_add_f32 v7, v7, v9
    v_mfma_f32_16x16x32_bf16 a[124:127], v[220:223], a[200:203], a[124:127]
    ds_write_b64 v23, a[138:139] offset:51712
    v_mfma_f32_16x16x32_bf16 a[124:127], v[224:227], a[204:207], a[124:127]
    v_add_f32 v6, v6, v10
    v_add_f32 v7, v7, v11
    v_mfma_f32_16x16x32_bf16 a[124:127], v[228:231], a[208:211], a[124:127]
    v_mfma_f32_16x16x32_bf16 a[124:127], v[232:235], a[212:215], a[124:127]
    v_permlane32_swap_b32 v6, v7
    v_add_f32 v6, v6, v7
    v_mfma_f32_16x16x32_bf16 a[124:127], v[236:239], a[216:219], a[124:127]
    v_mov_b32 v7, v6
    v_mfma_f32_16x16x32_bf16 v[40:43], v[140:143], a[144:147], 0
    v_mfma_f32_16x16x32_bf16 v[40:43], v[144:147], a[148:151], v[40:43]
    s_waitcnt lgkmcnt(0)
    s_barrier
    v_mfma_f32_16x16x32_bf16 v[40:43], v[148:151], a[152:155], v[40:43]
    ds_write_b64 v23, a[124:125] offset:41984
    v_mfma_f32_16x16x32_bf16 v[40:43], v[152:155], a[156:159], v[40:43]
    v_permlane16_swap_b32 v6, v7
    v_add_f32 v6, v6, v7
    v_mfma_f32_16x16x32_bf16 v[40:43], v[156:159], a[160:163], v[40:43]
    ds_write_b64 v23, a[126:127] offset:42496
    v_mfma_f32_16x16x32_bf16 v[40:43], v[160:163], a[164:167], v[40:43]
    ds_write_b32 v117, v6 offset:0
    v_mfma_f32_16x16x32_bf16 v[40:43], v[164:167], a[168:171], v[40:43]
    ds_read2st64_b64 v[52:55], v23 offset0:102 offset1:103
    ds_read2st64_b64 v[56:59], v23 offset0:104 offset1:105
    v_mfma_f32_16x16x32_bf16 v[40:43], v[168:171], a[172:175], v[40:43]
    v_mfma_f32_16x16x32_bf16 v[40:43], v[192:195], a[176:179], v[40:43]
    v_mfma_f32_16x16x32_bf16 v[40:43], v[196:199], a[180:183], v[40:43]
    v_mfma_f32_16x16x32_bf16 v[40:43], v[200:203], a[184:187], v[40:43]
    s_waitcnt lgkmcnt(3)
    s_barrier
    v_mfma_f32_16x16x32_bf16 v[40:43], v[224:227], a[188:191], v[40:43]
    s_waitcnt lgkmcnt(0)
    ds_read2st64_b64 v[48:51], v23 offset0:106 offset1:107
    v_add_f32 v52, v52, v56
    v_mfma_f32_16x16x32_bf16 v[40:43], v[228:231], a[192:195], v[40:43]
    v_add_f32 v53, v53, v57
    v_add_f32 v54, v54, v58
    v_mfma_f32_16x16x32_bf16 v[40:43], v[232:235], a[196:199], v[40:43]
    v_add_f32 v55, v55, v59
    v_add_f32 v100, v100, v52
    v_mfma_f32_16x16x32_bf16 v[40:43], v[236:239], a[200:203], v[40:43]
    v_add_f32 v101, v101, v53
    v_add_f32 v102, v102, v54
    v_mfma_f32_16x16x32_bf16 v[40:43], v[240:243], a[204:207], v[40:43]
    s_waitcnt lgkmcnt(0)
    v_add_f32 v103, v103, v55
    v_add_f32 v100, v100, v48
    v_mfma_f32_16x16x32_bf16 v[40:43], v[244:247], a[208:211], v[40:43]
    v_add_f32 v101, v101, v49
    v_add_f32 v102, v102, v50
    v_mfma_f32_16x16x32_bf16 v[40:43], v[248:251], a[212:215], v[40:43]
    v_add_f32 v103, v103, v51
    v_mfma_f32_16x16x32_bf16 v[40:43], v[252:255], a[216:219], v[40:43]
    s_nop 7
    v_sub_f32 v100, -v100, v40
    v_sub_f32 v101, -v101, v41
    v_sub_f32 v102, -v102, v42
    v_sub_f32 v103, -v103, v43
    v_cndmask_b32 v100, 0, v100, s[76:77]
    v_cndmask_b32 v101, 0, v101, s[76:77]
    v_cndmask_b32 v102, 0, v102, s[76:77]
    v_cndmask_b32 v103, 0, v103, s[76:77]
    v_add_f32 v35, v35, v100
    v_fmac_f32 v38, v100, v100
    v_add_f32 v35, v35, v101
    v_fmac_f32 v38, v101, v101
    v_add_f32 v35, v35, v102
    v_fmac_f32 v38, v102, v102
    v_add_f32 v35, v35, v103
    v_fmac_f32 v38, v103, v103
    s_nop 1
    v_permlane32_swap_b32 v35, v38
    v_add_f32 v35, v35, v38
    ds_write_b32 v24, v35 offset:2048
    buffer_load_dwordx2 v[120:121], v28, s[24:27], s74 offen offset:0 sc1
    buffer_load_dwordx2 v[122:123], v28, s[24:27], s74 offen offset:2048 sc1
    buffer_load_dwordx2 v[124:125], v3, s[24:27], s74 offen offset:0 sc1
    s_waitcnt lgkmcnt(0)
    s_barrier
    ds_read_b128 v[200:203], v25 offset:2048
    ds_read_b128 v[204:207], v25 offset:2064
    s_waitcnt lgkmcnt(1)
    v_add_f32 v200, v200, v201
    v_add_f32 v202, v202, v203
    s_waitcnt lgkmcnt(0)
    v_add_f32 v204, v204, v205
    v_add_f32 v206, v206, v207
    v_add_f32 v200, v200, v202
    v_add_f32 v204, v204, v206
    v_add_f32 v200, v200, v204
    v_min_u32 v200, -2, v200
Lt14:
    s_cbranch_execz Lpr3
Lepi:
    buffer_store_dword v200, v27, s[24:27], s75 offen sc1
    ds_read_b128 v[128:131], v26 offset:0
    ds_read_b128 v[132:135], v26 offset:16
    s_waitcnt lgkmcnt(1)
    v_pk_add_f32 v[128:129], v[128:129], v[130:131]
    s_waitcnt lgkmcnt(0)
    v_pk_add_f32 v[132:133], v[132:133], v[134:135]
    v_pk_add_f32 v[128:129], v[128:129], v[132:133]
    v_mul_f32 v128, v4, v128
    v_fma_f32 v129, v129, v4, v5
    v_fma_f32 v129, -v128, v128, v129
    v_max_f32 v129, v5, v129
    v_rsq_f32 v129, v129
    v_add_f32 v128, v128, v13
    v_sub_f32 v128, v13, v128
    v_mul_f32 v160, v129, v16
    v_fma_f32 v161, v128, v160, v19
    v_pk_fma_f32 v[68:69], v[68:69], v[160:161], v[160:161] op_sel:[0,0,1] op_sel_hi:[1,0,1]
    v_pk_fma_f32 v[70:71], v[70:71], v[160:161], v[160:161] op_sel:[0,0,1] op_sel_hi:[1,0,1]
    v_pk_mul_f32 v[144:145], v[68:69], v[68:69]
    v_pk_mul_f32 v[146:147], v[70:71], v[70:71]
    v_pk_fma_f32 v[144:145], v[144:145], v[118:119], v[118:119] op_sel:[0,0,1] op_sel_hi:[1,0,1]
    v_pk_fma_f32 v[146:147], v[146:147], v[118:119], v[118:119] op_sel:[0,0,1] op_sel_hi:[1,0,1]
    v_pk_mul_f32 v[144:145], v[144:145], v[68:69]
    v_pk_mul_f32 v[146:147], v[146:147], v[70:71]
    v_exp_f32 v144, v144
    v_exp_f32 v145, v145
    v_pk_fma_f32 v[72:73], v[72:73], v[160:161], v[160:161] op_sel:[0,0,1] op_sel_hi:[1,0,1]
    v_exp_f32 v146, v146
    v_pk_fma_f32 v[74:75], v[74:75], v[160:161], v[160:161] op_sel:[0,0,1] op_sel_hi:[1,0,1]
    v_exp_f32 v147, v147
    v_pk_mul_f32 v[148:149], v[72:73], v[72:73]
    v_pk_add_f32 v[144:145], v[144:145], 1.0 op_sel_hi:[1,0]
    v_pk_mul_f32 v[150:151], v[74:75], v[74:75]
    v_pk_add_f32 v[146:147], v[146:147], 1.0 op_sel_hi:[1,0]
    v_rcp_f32 v144, v144
    v_pk_fma_f32 v[148:149], v[148:149], v[118:119], v[118:119] op_sel:[0,0,1] op_sel_hi:[1,0,1]
    v_rcp_f32 v145, v145
    v_pk_fma_f32 v[150:151], v[150:151], v[118:119], v[118:119] op_sel:[0,0,1] op_sel_hi:[1,0,1]
    v_rcp_f32 v146, v146
    v_pk_mul_f32 v[148:149], v[148:149], v[72:73]
    v_rcp_f32 v147, v147
    v_pk_mul_f32 v[150:151], v[150:151], v[74:75]
    v_pk_mul_f32 v[68:69], v[68:69], v[144:145]
    v_exp_f32 v148, v148
    v_pk_mul_f32 v[70:71], v[70:71], v[146:147]
    v_exp_f32 v149, v149
    v_cvt_pk_bf16_f32 v144, v68, v69
    v_exp_f32 v150, v150
    v_cvt_pk_bf16_f32 v145, v70, v71
    ds_write_b64 v29, v[144:145] offset:0
    v_exp_f32 v151, v151
    v_pk_fma_f32 v[76:77], v[76:77], v[160:161], v[160:161] op_sel:[0,0,1] op_sel_hi:[1,0,1]
    v_pk_add_f32 v[148:149], v[148:149], 1.0 op_sel_hi:[1,0]
    v_pk_fma_f32 v[78:79], v[78:79], v[160:161], v[160:161] op_sel:[0,0,1] op_sel_hi:[1,0,1]
    v_pk_add_f32 v[150:151], v[150:151], 1.0 op_sel_hi:[1,0]
    v_pk_mul_f32 v[152:153], v[76:77], v[76:77]
    v_pk_mul_f32 v[154:155], v[78:79], v[78:79]
    v_rcp_f32 v148, v148
    v_pk_fma_f32 v[152:153], v[152:153], v[118:119], v[118:119] op_sel:[0,0,1] op_sel_hi:[1,0,1]
    v_rcp_f32 v149, v149
    v_pk_fma_f32 v[154:155], v[154:155], v[118:119], v[118:119] op_sel:[0,0,1] op_sel_hi:[1,0,1]
    v_rcp_f32 v150, v150
    v_pk_mul_f32 v[152:153], v[152:153], v[76:77]
    s_waitcnt vmcnt(2)
    v_max3_u32 v39, v120, v121, v122
    s_waitcnt vmcnt(1)
    v_max3_u32 v39, v39, v124, v125
    v_max_u32 v39, v39, v123
    v_cmp_eq_u32 vcc, -1, v39
    s_cbranch_vccnz Lgs_1
Lhs_1:
    v_add_f32 v120, v120, v122
    v_add_f32 v121, v121, v123
    v_add_f32 v120, v120, v124
    v_add_f32 v121, v121, v125
    s_nop 1
    v_permlane32_swap_b32 v120, v121
    v_add_f32 v120, v120, v121
    v_mov_b32 v121, v120
    s_nop 1
    v_permlane16_swap_b32 v120, v121
    v_add_f32 v120, v120, v121
    ds_write_b32 v117, v120 offset:1280
    v_rcp_f32 v151, v151
    v_pk_mul_f32 v[154:155], v[154:155], v[78:79]
    v_exp_f32 v152, v152
    v_exp_f32 v153, v153
    v_pk_mul_f32 v[72:73], v[72:73], v[148:149]
    v_exp_f32 v154, v154
    v_exp_f32 v155, v155
    v_pk_mul_f32 v[74:75], v[74:75], v[150:151]
    s_waitcnt lgkmcnt(0)
    s_barrier
    ds_read_b128 v[128:131], v26 offset:1280
    ds_read_b128 v[132:135], v26 offset:1296
    v_pk_add_f32 v[152:153], v[152:153], 1.0 op_sel_hi:[1,0]
    v_pk_add_f32 v[154:155], v[154:155], 1.0 op_sel_hi:[1,0]
    v_cvt_pk_bf16_f32 v148, v72, v73
    v_rcp_f32 v152, v152
    v_rcp_f32 v153, v153
    v_cvt_pk_bf16_f32 v149, v74, v75
    v_rcp_f32 v154, v154
    v_rcp_f32 v155, v155
    ds_write_b64 v29, v[148:149] offset:512
    v_pk_mul_f32 v[76:77], v[76:77], v[152:153]
    v_pk_mul_f32 v[78:79], v[78:79], v[154:155]
    v_cvt_pk_bf16_f32 v152, v76, v77
    v_cvt_pk_bf16_f32 v153, v78, v79
    ds_write_b64 v29, v[152:153] offset:1024
    s_waitcnt lgkmcnt(3)
    v_pk_add_f32 v[128:129], v[128:129], v[130:131]
    s_waitcnt lgkmcnt(2)
    v_pk_add_f32 v[132:133], v[132:133], v[134:135]
    v_pk_add_f32 v[128:129], v[128:129], v[132:133]
    v_mul_f32 v128, v4, v128
    v_fma_f32 v129, v129, v4, v5
    v_fma_f32 v129, -v128, v128, v129
    v_max_f32 v129, v5, v129
    v_rsq_f32 v129, v129
    v_add_f32 v128, v128, v14
    v_sub_f32 v128, v14, v128
    v_mul_f32 v162, v129, v17
    v_fma_f32 v163, v128, v162, v20
    buffer_load_dwordx2 v[188:189], v28, s[24:27], s75 offen offset:0 sc1
    buffer_load_dwordx2 v[190:191], v28, s[24:27], s75 offen offset:2048 sc1
    buffer_load_dwordx2 v[192:193], v3, s[24:27], s75 offen offset:0 sc1
    v_pk_fma_f32 v[80:81], v[80:81], v[162:163], v[162:163] op_sel:[0,0,1] op_sel_hi:[1,0,1]
    v_pk_fma_f32 v[82:83], v[82:83], v[162:163], v[162:163] op_sel:[0,0,1] op_sel_hi:[1,0,1]
    v_pk_mul_f32 v[144:145], v[80:81], v[80:81]
    v_pk_mul_f32 v[146:147], v[82:83], v[82:83]
    v_pk_fma_f32 v[144:145], v[144:145], v[118:119], v[118:119] op_sel:[0,0,1] op_sel_hi:[1,0,1]
    v_pk_fma_f32 v[146:147], v[146:147], v[118:119], v[118:119] op_sel:[0,0,1] op_sel_hi:[1,0,1]
    v_pk_mul_f32 v[144:145], v[144:145], v[80:81]
    v_pk_mul_f32 v[146:147], v[146:147], v[82:83]
    v_exp_f32 v144, v144
    v_exp_f32 v145, v145
    v_pk_fma_f32 v[84:85], v[84:85], v[162:163], v[162:163] op_sel:[0,0,1] op_sel_hi:[1,0,1]
    v_exp_f32 v146, v146
    v_pk_fma_f32 v[86:87], v[86:87], v[162:163], v[162:163] op_sel:[0,0,1] op_sel_hi:[1,0,1]
    v_exp_f32 v147, v147
    v_pk_mul_f32 v[148:149], v[84:85], v[84:85]
    v_pk_add_f32 v[144:145], v[144:145], 1.0 op_sel_hi:[1,0]
    v_pk_mul_f32 v[150:151], v[86:87], v[86:87]
    v_pk_add_f32 v[146:147], v[146:147], 1.0 op_sel_hi:[1,0]
    v_rcp_f32 v144, v144
    v_pk_fma_f32 v[148:149], v[148:149], v[118:119], v[118:119] op_sel:[0,0,1] op_sel_hi:[1,0,1]
    v_rcp_f32 v145, v145
    v_pk_fma_f32 v[150:151], v[150:151], v[118:119], v[118:119] op_sel:[0,0,1] op_sel_hi:[1,0,1]
    v_rcp_f32 v146, v146
    v_pk_mul_f32 v[148:149], v[148:149], v[84:85]
    v_rcp_f32 v147, v147
    v_pk_mul_f32 v[150:151], v[150:151], v[86:87]
    v_pk_mul_f32 v[80:81], v[80:81], v[144:145]
    v_exp_f32 v148, v148
    v_pk_mul_f32 v[82:83], v[82:83], v[146:147]
    v_exp_f32 v149, v149
    v_cvt_pk_bf16_f32 v144, v80, v81
    v_cvt_pk_bf16_f32 v145, v82, v83
    v_exp_f32 v150, v150
    ds_write_b64 v29, v[144:145] offset:1536
    v_exp_f32 v151, v151
    ds_read_b64_tr_b16 v[164:165], v116 offset:0
    ds_read_b64_tr_b16 v[166:167], v116 offset:256
    v_pk_add_f32 v[148:149], v[148:149], 1.0 op_sel_hi:[1,0]
    v_pk_fma_f32 v[88:89], v[88:89], v[162:163], v[162:163] op_sel:[0,0,1] op_sel_hi:[1,0,1]
    v_pk_add_f32 v[150:151], v[150:151], 1.0 op_sel_hi:[1,0]
    v_pk_fma_f32 v[90:91], v[90:91], v[162:163], v[162:163] op_sel:[0,0,1] op_sel_hi:[1,0,1]
    v_pk_mul_f32 v[152:153], v[88:89], v[88:89]
    v_rcp_f32 v148, v148
    v_pk_mul_f32 v[154:155], v[90:91], v[90:91]
    v_rcp_f32 v149, v149
    v_pk_fma_f32 v[152:153], v[152:153], v[118:119], v[118:119] op_sel:[0,0,1] op_sel_hi:[1,0,1]
    v_pk_fma_f32 v[154:155], v[154:155], v[118:119], v[118:119] op_sel:[0,0,1] op_sel_hi:[1,0,1]
    v_rcp_f32 v150, v150
    v_pk_mul_f32 v[152:153], v[152:153], v[88:89]
    v_rcp_f32 v151, v151
    v_pk_mul_f32 v[154:155], v[154:155], v[90:91]
    v_exp_f32 v152, v152
    v_exp_f32 v153, v153
    v_pk_mul_f32 v[84:85], v[84:85], v[148:149]
    v_exp_f32 v154, v154
    v_pk_mul_f32 v[86:87], v[86:87], v[150:151]
    v_exp_f32 v155, v155
    v_pk_add_f32 v[152:153], v[152:153], 1.0 op_sel_hi:[1,0]
    v_cvt_pk_bf16_f32 v148, v84, v85
    v_pk_add_f32 v[154:155], v[154:155], 1.0 op_sel_hi:[1,0]
    v_cvt_pk_bf16_f32 v149, v86, v87
    v_rcp_f32 v152, v152
    v_rcp_f32 v153, v153
    ds_write_b64 v29, v[148:149] offset:2048
    v_rcp_f32 v154, v154
    ds_read_b64_tr_b16 v[168:169], v116 offset:512
    v_rcp_f32 v155, v155
    ds_read_b64_tr_b16 v[170:171], v116 offset:768
    s_mov_b32 exec_hi, s66
    s_waitcnt lgkmcnt(3)
    buffer_store_dwordx4 v[164:167], v31, s[16:19], s38 offen sc1
    s_mov_b32 exec_hi, -1
    v_pk_mul_f32 v[88:89], v[88:89], v[152:153]
    v_pk_mul_f32 v[90:91], v[90:91], v[154:155]
    v_cvt_pk_bf16_f32 v152, v88, v89
    v_cvt_pk_bf16_f32 v153, v90, v91
    ds_write_b64 v29, v[152:153] offset:2560
    ds_read_b64_tr_b16 v[172:173], v116 offset:1024
    ds_read_b64_tr_b16 v[174:175], v116 offset:1280
    s_waitcnt vmcnt(2)
    v_max3_u32 v39, v188, v189, v190
    s_waitcnt vmcnt(1)
    v_max3_u32 v39, v39, v192, v193
    v_max_u32 v39, v39, v191
    v_cmp_eq_u32 vcc, -1, v39
    s_cbranch_vccnz Lgs_2
Lhs_2:
    v_add_f32 v188, v188, v190
    v_add_f32 v189, v189, v191
    v_add_f32 v188, v188, v192
    v_add_f32 v189, v189, v193
    s_nop 1
    v_permlane32_swap_b32 v188, v189
    v_add_f32 v188, v188, v189
    v_mov_b32 v189, v188
    s_nop 1
    v_permlane16_swap_b32 v188, v189
    v_add_f32 v188, v188, v189
    ds_write_b32 v117, v188 offset:2560
    s_mov_b32 exec_hi, s67
    s_waitcnt lgkmcnt(4)
    buffer_store_dwordx4 v[168:171], v31, s[16:19], s39 offen sc1
    s_mov_b32 exec_hi, -1
    s_waitcnt lgkmcnt(0)
    s_barrier
    ds_read_b128 v[128:131], v26 offset:2560
    ds_read_b128 v[132:135], v26 offset:2576
    s_mov_b32 exec_hi, s68
    buffer_store_dwordx4 v[172:175], v31, s[16:19], s46 offen sc1
    s_mov_b32 exec_hi, -1
    s_waitcnt lgkmcnt(1)
    v_pk_add_f32 v[128:129], v[128:129], v[130:131]
    s_waitcnt lgkmcnt(0)
    v_pk_add_f32 v[132:133], v[132:133], v[134:135]
    v_pk_add_f32 v[128:129], v[128:129], v[132:133]
    v_mul_f32 v128, v4, v128
    v_fma_f32 v129, v129, v4, v5
    v_fma_f32 v129, -v128, v128, v129
    v_max_f32 v129, v5, v129
    v_rsq_f32 v129, v129
    v_add_f32 v128, v128, v15
    v_sub_f32 v128, v15, v128
    v_mul_f32 v160, v129, v18
    v_fma_f32 v161, v128, v160, v21
    v_pk_fma_f32 v[92:93], v[92:93], v[160:161], v[160:161] op_sel:[0,0,1] op_sel_hi:[1,0,1]
    v_pk_fma_f32 v[94:95], v[94:95], v[160:161], v[160:161] op_sel:[0,0,1] op_sel_hi:[1,0,1]
    v_pk_mul_f32 v[144:145], v[92:93], v[92:93]
    v_pk_mul_f32 v[146:147], v[94:95], v[94:95]
    v_pk_fma_f32 v[144:145], v[144:145], v[118:119], v[118:119] op_sel:[0,0,1] op_sel_hi:[1,0,1]
    v_pk_fma_f32 v[146:147], v[146:147], v[118:119], v[118:119] op_sel:[0,0,1] op_sel_hi:[1,0,1]
    v_pk_mul_f32 v[144:145], v[144:145], v[92:93]
    v_pk_mul_f32 v[146:147], v[146:147], v[94:95]
    v_exp_f32 v144, v144
    v_exp_f32 v145, v145
    v_pk_fma_f32 v[96:97], v[96:97], v[160:161], v[160:161] op_sel:[0,0,1] op_sel_hi:[1,0,1]
    v_exp_f32 v146, v146
    v_pk_fma_f32 v[98:99], v[98:99], v[160:161], v[160:161] op_sel:[0,0,1] op_sel_hi:[1,0,1]
    v_exp_f32 v147, v147
    v_pk_mul_f32 v[148:149], v[96:97], v[96:97]
    v_pk_add_f32 v[144:145], v[144:145], 1.0 op_sel_hi:[1,0]
    v_pk_mul_f32 v[150:151], v[98:99], v[98:99]
    v_pk_add_f32 v[146:147], v[146:147], 1.0 op_sel_hi:[1,0]
    v_rcp_f32 v144, v144
    v_pk_fma_f32 v[148:149], v[148:149], v[118:119], v[118:119] op_sel:[0,0,1] op_sel_hi:[1,0,1]
    v_rcp_f32 v145, v145
    v_pk_fma_f32 v[150:151], v[150:151], v[118:119], v[118:119] op_sel:[0,0,1] op_sel_hi:[1,0,1]
    v_rcp_f32 v146, v146
    v_pk_mul_f32 v[148:149], v[148:149], v[96:97]
    v_rcp_f32 v147, v147
    v_pk_mul_f32 v[150:151], v[150:151], v[98:99]
    v_pk_mul_f32 v[92:93], v[92:93], v[144:145]
    v_exp_f32 v148, v148
    v_pk_mul_f32 v[94:95], v[94:95], v[146:147]
    v_exp_f32 v149, v149
    v_cvt_pk_bf16_f32 v144, v92, v93
    v_cvt_pk_bf16_f32 v145, v94, v95
    v_exp_f32 v150, v150
    ds_write_b64 v29, v[144:145] offset:3072
    v_exp_f32 v151, v151
    ds_read_b64_tr_b16 v[220:221], v30 offset:0
    ds_read_b64_tr_b16 v[222:223], v30 offset:256
    v_pk_add_f32 v[148:149], v[148:149], 1.0 op_sel_hi:[1,0]
    v_pk_fma_f32 v[100:101], v[100:101], v[160:161], v[160:161] op_sel:[0,0,1] op_sel_hi:[1,0,1]
    v_pk_add_f32 v[150:151], v[150:151], 1.0 op_sel_hi:[1,0]
    v_pk_fma_f32 v[102:103], v[102:103], v[160:161], v[160:161] op_sel:[0,0,1] op_sel_hi:[1,0,1]
    v_pk_mul_f32 v[152:153], v[100:101], v[100:101]
    v_rcp_f32 v148, v148
    v_pk_mul_f32 v[154:155], v[102:103], v[102:103]
    v_rcp_f32 v149, v149
    v_pk_fma_f32 v[152:153], v[152:153], v[118:119], v[118:119] op_sel:[0,0,1] op_sel_hi:[1,0,1]
    v_pk_fma_f32 v[154:155], v[154:155], v[118:119], v[118:119] op_sel:[0,0,1] op_sel_hi:[1,0,1]
    v_rcp_f32 v150, v150
    v_pk_mul_f32 v[152:153], v[152:153], v[100:101]
    v_rcp_f32 v151, v151
    v_pk_mul_f32 v[154:155], v[154:155], v[102:103]
    v_exp_f32 v152, v152
    v_exp_f32 v153, v153
    v_pk_mul_f32 v[96:97], v[96:97], v[148:149]
    v_exp_f32 v154, v154
    v_pk_mul_f32 v[98:99], v[98:99], v[150:151]
    v_exp_f32 v155, v155
    v_pk_add_f32 v[152:153], v[152:153], 1.0 op_sel_hi:[1,0]
    v_cvt_pk_bf16_f32 v148, v96, v97
    v_pk_add_f32 v[154:155], v[154:155], 1.0 op_sel_hi:[1,0]
    v_cvt_pk_bf16_f32 v149, v98, v99
    v_rcp_f32 v152, v152
    v_rcp_f32 v153, v153
    ds_write_b64 v29, v[148:149] offset:3584
    v_rcp_f32 v154, v154
    ds_read_b64_tr_b16 v[224:225], v32 offset:0
    v_rcp_f32 v155, v155
    ds_read_b64_tr_b16 v[226:227], v32 offset:256
    s_mov_b32 exec_lo, s69
    s_waitcnt lgkmcnt(3)
    buffer_store_dwordx4 v[220:223], v31, s[16:19], s47 offen offset:32 sc1
    s_mov_b32 exec_lo, -1
    v_pk_mul_f32 v[100:101], v[100:101], v[152:153]
    v_pk_mul_f32 v[102:103], v[102:103], v[154:155]
    v_cvt_pk_bf16_f32 v152, v100, v101
    v_cvt_pk_bf16_f32 v153, v102, v103
    ds_write_b64 v29, v[152:153] offset:4096
    ds_read_b64_tr_b16 v[228:229], v44 offset:0
    ds_read_b64_tr_b16 v[230:231], v44 offset:256
    s_mov_b32 exec_lo, s70
    s_waitcnt lgkmcnt(3)
    buffer_store_dwordx4 v[224:227], v31, s[16:19], s48 offen offset:32 sc1
    s_mov_b32 exec_lo, -1
    s_mov_b32 exec_lo, s71
    s_waitcnt lgkmcnt(0)
    buffer_store_dwordx4 v[228:231], v31, s[16:19], s49 offen offset:32 sc1
    s_mov_b32 exec_lo, -1
    s_endpgm
Lgs_1:
    s_mov_b64 exec, vcc
    buffer_load_dwordx2 v[120:121], v28, s[24:27], s74 offen offset:0 sc1
    buffer_load_dwordx2 v[122:123], v28, s[24:27], s74 offen offset:2048 sc1
    buffer_load_dwordx2 v[124:125], v3, s[24:27], s74 offen offset:0 sc1
    s_mov_b64 exec, -1
    s_waitcnt vmcnt(0)
    v_max3_u32 v39, v120, v121, v122
    v_max3_u32 v39, v39, v124, v125
    v_max_u32 v39, v39, v123
    v_cmp_eq_u32 vcc, -1, v39
    s_sub_u32 s85, s85, 1
    s_cmp_lt_i32 s85, 0
    s_cbranch_scc1 Lhs_1
    s_cbranch_vccnz Lgs_1
    s_branch Lhs_1
Lgs_2:
    s_mov_b64 exec, vcc
    buffer_load_dwordx2 v[188:189], v28, s[24:27], s75 offen offset:0 sc1
    buffer_load_dwordx2 v[190:191], v28, s[24:27], s75 offen offset:2048 sc1
    buffer_load_dwordx2 v[192:193], v3, s[24:27], s75 offen offset:0 sc1
    s_mov_b64 exec, -1
    s_waitcnt vmcnt(0)
    v_max3_u32 v39, v188, v189, v190
    v_max3_u32 v39, v39, v192, v193
    v_max_u32 v39, v39, v191
    v_cmp_eq_u32 vcc, -1, v39
    s_sub_u32 s85, s85, 1
    s_cmp_lt_i32 s85, 0
    s_cbranch_scc1 Lhs_2
    s_cbranch_vccnz Lgs_2
    s_branch Lhs_2
Lg3_0:
    s_mov_b64 exec, vcc
    buffer_load_dwordx2 v[6:7], v28, s[24:27], 0 offen offset:0 sc1
    buffer_load_dwordx2 v[8:9], v28, s[24:27], 0 offen offset:2048 sc1
    buffer_load_dwordx2 v[10:11], v3, s[24:27], 0 offen offset:0 sc1
    s_mov_b64 exec, -1
    s_waitcnt vmcnt(0)
    v_max3_u32 v39, v6, v7, v8
    v_max3_u32 v39, v39, v10, v11
    v_max_u32 v39, v39, v9
    v_cmp_eq_u32 vcc, -1, v39
    s_sub_u32 s85, s85, 1
    s_cmp_lt_i32 s85, 0
    s_cbranch_scc1 Lh3_0
    s_cbranch_vccnz Lg3_0
    s_branch Lh3_0
Lend:
    s_endpgm
.section .rodata,"a"
.p2align 6
.amdhsa_kernel standalone__self_sup_conv_stem_hubert__speech_kernel
  .amdhsa_next_free_vgpr 512
  .amdhsa_next_free_sgpr 102
  .amdhsa_accum_offset 256
  .amdhsa_group_segment_fixed_size 0
  .amdhsa_kernarg_size 64
  .amdhsa_user_sgpr_count 2
  .amdhsa_user_sgpr_kernarg_segment_ptr 1
  .amdhsa_system_sgpr_workgroup_id_x 1
  .amdhsa_float_denorm_mode_32 3
.end_amdhsa_kernel
```
